```python
import torch

def _softmax(x, axis=-1):
    return torch.softmax(x, dim=axis)
def _gelu(x):
    return torch.nn.functional.gelu(x, approximate="tanh")
def _silu(x):
    return torch.nn.functional.silu(x)
def _sigmoid(x):
    return torch.sigmoid(x)
def _layernorm(x, axis=-1, eps=1e-5):
    m = x.mean(dim=axis, keepdim=True)
    v = x.var(dim=axis, keepdim=True, unbiased=False)
    return (x - m) / torch.sqrt(v + eps)
def _scatter_add(tgt, idx, src, axis=0):
    return tgt.clone().index_add_(axis, idx, src)
def _segment_sum(src, seg, n):
    out = torch.zeros((n,) + src.shape[1:], dtype=src.dtype)
    return out.index_add_(0, seg, src)
def _pad(x, pw):
    flat = tuple(v for pair in reversed(pw) for v in pair)
    return torch.nn.functional.pad(x, flat)

kernel_name = 'gated_mix__sliding_block__geglu_ffn__prompt'

def setup_inputs():

    _w = (lambda a: (lambda t: t.to(torch.bfloat16) if t.is_floating_point() else t)(torch.as_tensor(a)))
    def _A_setup():
        B, S, D = 1, 2048, 1024
        return {
            "x": _w((lambda *s: torch.randn(*s, dtype=torch.bfloat16) * 0.05)(B, S, D)),
            "wqkv": _w((lambda *s: torch.randn(*s, dtype=torch.bfloat16) * 1.6)(D, 3 * D)),
            "wo": _w((lambda *s: torch.randn(*s, dtype=torch.bfloat16) * 0.1)(D, D)),
        }
    _A_in = _A_setup()

    def _B_setup():
        B, S, D, F = 1, 2048, 1024, 3584
        return {
            "x": _w((lambda *s: torch.randn(*s, dtype=torch.bfloat16) * 0.05)(B, S, D)),
            "w_gate": _w((lambda *s: torch.randn(*s, dtype=torch.bfloat16) * 0.4)(D, F)),
            "w_up": _w((lambda *s: torch.randn(*s, dtype=torch.bfloat16) * 0.4)(D, F)),
            "w_down": _w((lambda *s: torch.randn(*s, dtype=torch.bfloat16) * 0.4)(F, D)),
        }
    _B_in = _B_setup()

    return {
        "A_x": _A_in["x"],
        "A_wqkv": _A_in["wqkv"],
        "A_wo": _A_in["wo"],
        "B_x": _B_in["x"],
        "B_w_gate": _B_in["w_gate"],
        "B_w_up": _B_in["w_up"],
        "B_w_down": _B_in["w_down"],
        "gate_w": _w((lambda *s: torch.randn(*s, dtype=torch.bfloat16) * 0.05)(1024) * 16.0),
    }

def reference(A_x, A_wqkv, A_wo, B_x, B_w_gate, B_w_up, B_w_down, gate_w):
    def _A_ref(x, wqkv, wo):
        B, S, D = x.shape
        H = 32; Dh = D // H; W = 256
        qkv = (lambda x, *d: x.permute(*d))((x @ wqkv).reshape(B, S, 3, H, Dh), 2, 0, 3, 1, 4)
        q, k, v = qkv[0], qkv[1], qkv[2]
        scores = torch.einsum("bhqd,bhkd->bhqk", q, k) * (Dh ** -0.5)
        idx = torch.arange(S)
        mask = (idx[:, None] - idx[None, :] >= 0) & (idx[:, None] - idx[None, :] < W)
        scores = torch.where(mask[None, None], scores, -1e9)
        p = _softmax(scores, axis=-1)
        o = torch.einsum("bhqk,bhkd->bhqd", p, v)
        return (lambda x, *d: x.permute(*d))(o, 0, 2, 1, 3).reshape(B, S, D) @ wo

    def _B_ref(x, w_gate, w_up, w_down):
        return (_gelu(x @ w_gate) * (x @ w_up)) @ w_down

    x = A_x
    g = _sigmoid((x * gate_w).sum(-1, keepdims=True))
    a = _A_ref(x, A_wqkv, A_wo)
    b = _B_ref(x, B_w_gate, B_w_up, B_w_down)
    return g * a + (1 - g) * b
```

```asm
; @launch kernel=gemm1_kernel grid=(256,1,1) block=(512,1,1) lds=147456
; @launch kernel=fused_kernel grid=(256,1,1) block=(1024,1,1) lds=163840
.amdgcn_target "amdgcn-amd-amdhsa--gfx950"
.text
.globl gemm1_kernel
.p2align 8
.type gemm1_kernel,@function
gemm1_kernel:
    s_cmp_ge_u32 s2, 256
    s_cbranch_scc1 L1_end
    s_load_dwordx4 s[4:7], s[0:1], 0
    s_load_dwordx4 s[8:11], s[0:1], 32
    s_load_dwordx2 s[12:13], s[0:1], 80
    s_load_dwordx2 s[54:55], s[0:1], 56
    s_load_dwordx2 s[56:57], s[0:1], 16
    s_load_dwordx2 s[58:59], s[0:1], 48
    v_lshrrev_b32 v1, 6, v0
    v_and_b32 v0, 63, v0
    s_nop 0
    v_readfirstlane_b32 s14, v1
    s_and_b32 s33, s2, 7
    s_lshr_b32 s34, s2, 3
    s_and_b32 s35, s34, 3
    s_lshl_b32 s15, s33, 2
    s_add_u32 s15, s15, s35
    s_lshr_b32 s16, s34, 2
    v_lshrrev_b32 v2, 3, v0
    v_and_b32 v3, 7, v0
    s_lshl_b32 s33, s14, 5
    s_add_u32 s34, s33, 0
    v_add_u32 v4, s34, v2
    v_bfe_u32 v5, v4, 1, 3
    v_xor_b32 v5, v5, v3
    v_lshlrev_b32 v5, 4, v5
    v_lshl_add_u32 v10, v4, 11, v5
    s_add_u32 s34, s33, 8
    v_add_u32 v4, s34, v2
    v_bfe_u32 v5, v4, 1, 3
    v_xor_b32 v5, v5, v3
    v_lshlrev_b32 v5, 4, v5
    v_lshl_add_u32 v11, v4, 11, v5
    s_add_u32 s34, s33, 16
    v_add_u32 v4, s34, v2
    v_bfe_u32 v5, v4, 1, 3
    v_xor_b32 v5, v5, v3
    v_lshlrev_b32 v5, 4, v5
    v_lshl_add_u32 v12, v4, 11, v5
    s_add_u32 s34, s33, 24
    v_add_u32 v4, s34, v2
    v_bfe_u32 v5, v4, 1, 3
    v_xor_b32 v5, v5, v3
    v_lshlrev_b32 v5, 4, v5
    v_lshl_add_u32 v13, v4, 11, v5
    s_lshl_b32 s20, s14, 12
    s_mul_i32 s21, s14, 5120
    s_add_u32 s21, s21, 65536
    s_waitcnt lgkmcnt(0)
    s_lshl_b32 s33, s16, 19
    s_add_u32 s18, s4, s33
    s_addc_u32 s19, s5, 0
    s_add_u32 m0, s20, 0
    s_nop 0
    global_load_lds_dwordx4 v10, s[18:19]
    s_add_u32 m0, s20, 1024
    s_nop 0
    global_load_lds_dwordx4 v11, s[18:19]
    s_add_u32 m0, s20, 2048
    s_nop 0
    global_load_lds_dwordx4 v12, s[18:19]
    s_add_u32 m0, s20, 3072
    s_nop 0
    global_load_lds_dwordx4 v13, s[18:19]
    s_add_u32 s18, s18, 128
    s_addc_u32 s19, s19, 0
    s_mul_i32 s33, s15, 192
    s_add_u32 s36, s6, s33
    s_addc_u32 s37, s7, 0
    s_mul_i32 s33, s15, 224
    s_add_u32 s38, s8, s33
    s_addc_u32 s39, s9, 0
    s_add_u32 s40, s10, s33
    s_addc_u32 s41, s11, 0
    s_sub_u32 s40, s40, 224
    s_subb_u32 s41, s41, 0
    s_mul_i32 s42, s14, 5
    s_mov_b32 s52, 37450
    s_mov_b32 s53, 7168
    s_add_u32 s43, s42, 0
    s_cmp_lt_u32 s43, 12
    s_cselect_b32 s44, 0, 12
    s_cselect_b32 s45, 43691, s52
    s_cselect_b32 s46, 19, 20
    s_cselect_b32 s47, 12, 28
    s_cselect_b32 s48, 6144, s53
    s_cselect_b32 s50, s36, s38
    s_cselect_b32 s51, s37, s39
    s_sub_u32 s43, s43, s44
    s_lshl_b32 s43, s43, 6
    v_add_u32 v4, s43, v0
    v_mul_u32_u24 v5, s45, v4
    v_lshrrev_b32 v5, s46, v5
    v_mul_u32_u24 v6, s47, v5
    v_sub_u32 v6, v4, v6
    v_bfe_u32 v7, v5, 3, 1
    v_lshlrev_b32 v7, 1, v7
    v_xor_b32 v6, v6, v7
    v_mul_u32_u24 v7, s48, v5
    v_lshl_add_u32 v7, v6, 4, v7
    v_cmp_le_u32 vcc, 14, v6
    v_mov_b32 v8, s50
    v_mov_b32 v9, s51
    v_mov_b32 v4, s40
    v_mov_b32 v5, s41
    v_cndmask_b32 v8, v8, v4, vcc
    v_cndmask_b32 v9, v9, v5, vcc
    v_add_co_u32 v14, vcc, v8, v7
    s_nop 1
    v_addc_co_u32 v15, vcc, 0, v9, vcc
    s_lshl_b32 s22, s48, 6
    s_mov_b32 s23, 0
    s_add_u32 m0, s21, 0
    s_nop 0
    global_load_lds_dwordx4 v[14:15], off
    v_lshl_add_u64 v[14:15], v[14:15], 0, s[22:23]
    s_add_u32 s43, s42, 1
    s_cmp_lt_u32 s43, 12
    s_cselect_b32 s44, 0, 12
    s_cselect_b32 s45, 43691, s52
    s_cselect_b32 s46, 19, 20
    s_cselect_b32 s47, 12, 28
    s_cselect_b32 s48, 6144, s53
    s_cselect_b32 s50, s36, s38
    s_cselect_b32 s51, s37, s39
    s_sub_u32 s43, s43, s44
    s_lshl_b32 s43, s43, 6
    v_add_u32 v4, s43, v0
    v_mul_u32_u24 v5, s45, v4
    v_lshrrev_b32 v5, s46, v5
    v_mul_u32_u24 v6, s47, v5
    v_sub_u32 v6, v4, v6
    v_bfe_u32 v7, v5, 3, 1
    v_lshlrev_b32 v7, 1, v7
    v_xor_b32 v6, v6, v7
    v_mul_u32_u24 v7, s48, v5
    v_lshl_add_u32 v7, v6, 4, v7
    v_cmp_le_u32 vcc, 14, v6
    v_mov_b32 v8, s50
    v_mov_b32 v9, s51
    v_mov_b32 v4, s40
    v_mov_b32 v5, s41
    v_cndmask_b32 v8, v8, v4, vcc
    v_cndmask_b32 v9, v9, v5, vcc
    v_add_co_u32 v16, vcc, v8, v7
    s_nop 1
    v_addc_co_u32 v17, vcc, 0, v9, vcc
    s_lshl_b32 s24, s48, 6
    s_mov_b32 s25, 0
    s_add_u32 m0, s21, 1024
    s_nop 0
    global_load_lds_dwordx4 v[16:17], off
    v_lshl_add_u64 v[16:17], v[16:17], 0, s[24:25]
    s_add_u32 s43, s42, 2
    s_cmp_lt_u32 s43, 12
    s_cselect_b32 s44, 0, 12
    s_cselect_b32 s45, 43691, s52
    s_cselect_b32 s46, 19, 20
    s_cselect_b32 s47, 12, 28
    s_cselect_b32 s48, 6144, s53
    s_cselect_b32 s50, s36, s38
    s_cselect_b32 s51, s37, s39
    s_sub_u32 s43, s43, s44
    s_lshl_b32 s43, s43, 6
    v_add_u32 v4, s43, v0
    v_mul_u32_u24 v5, s45, v4
    v_lshrrev_b32 v5, s46, v5
    v_mul_u32_u24 v6, s47, v5
    v_sub_u32 v6, v4, v6
    v_bfe_u32 v7, v5, 3, 1
    v_lshlrev_b32 v7, 1, v7
    v_xor_b32 v6, v6, v7
    v_mul_u32_u24 v7, s48, v5
    v_lshl_add_u32 v7, v6, 4, v7
    v_cmp_le_u32 vcc, 14, v6
    v_mov_b32 v8, s50
    v_mov_b32 v9, s51
    v_mov_b32 v4, s40
    v_mov_b32 v5, s41
    v_cndmask_b32 v8, v8, v4, vcc
    v_cndmask_b32 v9, v9, v5, vcc
    v_add_co_u32 v18, vcc, v8, v7
    s_nop 1
    v_addc_co_u32 v19, vcc, 0, v9, vcc
    s_lshl_b32 s26, s48, 6
    s_mov_b32 s27, 0
    s_add_u32 m0, s21, 2048
    s_nop 0
    global_load_lds_dwordx4 v[18:19], off
    v_lshl_add_u64 v[18:19], v[18:19], 0, s[26:27]
    s_add_u32 s43, s42, 3
    s_cmp_lt_u32 s43, 12
    s_cselect_b32 s44, 0, 12
    s_cselect_b32 s45, 43691, s52
    s_cselect_b32 s46, 19, 20
    s_cselect_b32 s47, 12, 28
    s_cselect_b32 s48, 6144, s53
    s_cselect_b32 s50, s36, s38
    s_cselect_b32 s51, s37, s39
    s_sub_u32 s43, s43, s44
    s_lshl_b32 s43, s43, 6
    v_add_u32 v4, s43, v0
    v_mul_u32_u24 v5, s45, v4
    v_lshrrev_b32 v5, s46, v5
    v_mul_u32_u24 v6, s47, v5
    v_sub_u32 v6, v4, v6
    v_bfe_u32 v7, v5, 3, 1
    v_lshlrev_b32 v7, 1, v7
    v_xor_b32 v6, v6, v7
    v_mul_u32_u24 v7, s48, v5
    v_lshl_add_u32 v7, v6, 4, v7
    v_cmp_le_u32 vcc, 14, v6
    v_mov_b32 v8, s50
    v_mov_b32 v9, s51
    v_mov_b32 v4, s40
    v_mov_b32 v5, s41
    v_cndmask_b32 v8, v8, v4, vcc
    v_cndmask_b32 v9, v9, v5, vcc
    v_add_co_u32 v20, vcc, v8, v7
    s_nop 1
    v_addc_co_u32 v21, vcc, 0, v9, vcc
    s_lshl_b32 s28, s48, 6
    s_mov_b32 s29, 0
    s_add_u32 m0, s21, 3072
    s_nop 0
    global_load_lds_dwordx4 v[20:21], off
    v_lshl_add_u64 v[20:21], v[20:21], 0, s[28:29]
    s_add_u32 s43, s42, 4
    s_cmp_lt_u32 s43, 12
    s_cselect_b32 s44, 0, 12
    s_cselect_b32 s45, 43691, s52
    s_cselect_b32 s46, 19, 20
    s_cselect_b32 s47, 12, 28
    s_cselect_b32 s48, 6144, s53
    s_cselect_b32 s50, s36, s38
    s_cselect_b32 s51, s37, s39
    s_sub_u32 s43, s43, s44
    s_lshl_b32 s43, s43, 6
    v_add_u32 v4, s43, v0
    v_mul_u32_u24 v5, s45, v4
    v_lshrrev_b32 v5, s46, v5
    v_mul_u32_u24 v6, s47, v5
    v_sub_u32 v6, v4, v6
    v_bfe_u32 v7, v5, 3, 1
    v_lshlrev_b32 v7, 1, v7
    v_xor_b32 v6, v6, v7
    v_mul_u32_u24 v7, s48, v5
    v_lshl_add_u32 v7, v6, 4, v7
    v_cmp_le_u32 vcc, 14, v6
    v_mov_b32 v8, s50
    v_mov_b32 v9, s51
    v_mov_b32 v4, s40
    v_mov_b32 v5, s41
    v_cndmask_b32 v8, v8, v4, vcc
    v_cndmask_b32 v9, v9, v5, vcc
    v_add_co_u32 v22, vcc, v8, v7
    s_nop 1
    v_addc_co_u32 v23, vcc, 0, v9, vcc
    s_lshl_b32 s30, s48, 6
    s_mov_b32 s31, 0
    s_add_u32 m0, s21, 4096
    s_nop 0
    global_load_lds_dwordx4 v[22:23], off
    v_lshl_add_u64 v[22:23], v[22:23], 0, s[30:31]
    s_and_b32 s43, s15, 3
    s_lshl_b32 s43, s43, 6
    s_lshl_b32 s44, s14, 3
    s_add_u32 s43, s43, s44
    v_add_u32 v4, s43, v0
    v_lshlrev_b32 v4, 11, v4
    v_mov_b32 v5, 128
    s_sub_u32 s46, s18, 128
    s_subb_u32 s47, s19, 0
    v_mov_b32 v8, s46
    v_mov_b32 v9, s47
    s_lshl_b32 s43, s16, 3
    s_add_u32 s43, s43, s14
    s_mul_i32 s44, s43, 6144
    s_mul_i32 s45, s43, 7168
    v_subrev_u32 v6, 8, v0
    v_lshlrev_b32 v7, 6, v6
    v_cmp_le_u32 vcc, 8, v0
    v_add_u32 v1, s44, v7
    v_cndmask_b32 v4, v4, v1, vcc
    v_mov_b32 v1, 393216
    v_cndmask_b32 v5, v5, v1, vcc
    v_mov_b32 v1, s36
    v_cndmask_b32 v8, v8, v1, vcc
    v_mov_b32 v1, s37
    v_cndmask_b32 v9, v9, v1, vcc
    v_cmp_le_u32 vcc, 11, v0
    v_add_u32 v1, s45, v7
    v_subrev_u32 v1, 192, v1
    v_cndmask_b32 v4, v4, v1, vcc
    v_mov_b32 v1, 458752
    v_cndmask_b32 v5, v5, v1, vcc
    v_mov_b32 v1, s38
    v_cndmask_b32 v8, v8, v1, vcc
    v_mov_b32 v1, s39
    v_cndmask_b32 v9, v9, v1, vcc
    v_cmp_le_u32 vcc, 15, v0
    v_add_u32 v1, s45, v7
    v_subrev_u32 v1, 224, v1
    v_cndmask_b32 v4, v4, v1, vcc
    v_mov_b32 v1, s40
    v_cndmask_b32 v8, v8, v1, vcc
    v_mov_b32 v1, s41
    v_cndmask_b32 v9, v9, v1, vcc
    v_cmp_le_u32 vcc, 19, v0
    s_and_b32 s43, s15, 3
    s_lshl_b32 s43, s43, 6
    s_lshl_b32 s44, s14, 3
    s_add_u32 s43, s43, s44
    s_lshl_b32 s43, s43, 11
    v_mov_b32 v1, s43
    v_cndmask_b32 v4, v4, v1, vcc
    v_mov_b32 v1, 128
    v_cndmask_b32 v5, v5, v1, vcc
    v_mov_b32 v1, s46
    v_cndmask_b32 v8, v8, v1, vcc
    v_mov_b32 v1, s47
    v_cndmask_b32 v9, v9, v1, vcc
    v_lshl_add_u32 v4, v5, 1, v4
    v_add_co_u32 v88, vcc, v8, v4
    s_nop 1
    v_addc_co_u32 v89, vcc, 0, v9, vcc
    v_mov_b32 v90, v5
    v_mov_b32 v91, 0
    v_and_b32 v2, 15, v0
    v_lshrrev_b32 v3, 4, v0
    s_and_b32 s33, s14, 3
    s_lshl_b32 s33, s33, 13
    v_lshrrev_b32 v4, 1, v2
    v_xor_b32 v4, v4, v3
    v_lshlrev_b32 v4, 4, v4
    v_lshl_add_u32 v4, v2, 7, v4
    v_add_u32 v24, s33, v4
    v_xor_b32 v25, 64, v24
    v_bfe_u32 v4, v0, 2, 2
    v_lshl_add_u32 v4, v3, 3, v4
    v_and_b32 v5, 3, v0
    v_lshlrev_b32 v5, 3, v5
    v_and_b32 v6, 1, v3
    v_lshlrev_b32 v6, 5, v6
    v_mul_u32_u24 v7, 192, v4
    v_add_u32 v7, v7, v5
    v_add_u32 v7, 65536, v7
    v_add_u32 v26, v7, v6
    v_sub_u32 v27, v7, v6
    v_mul_u32_u24 v7, 448, v4
    v_add_u32 v7, v7, v5
    v_add_u32 v7, 77824, v7
    v_add_u32 v28, v7, v6
    v_sub_u32 v29, v7, v6
    s_lshl_b32 s33, s2, 3
    s_add_u32 s17, s33, s14
    s_lshl_b32 s33, s17, 11
    s_add_u32 s44, s4, s33
    s_addc_u32 s45, s5, 0
    v_lshlrev_b32 v6, 5, v0
    global_load_dwordx4 v[100:103], v6, s[44:45]
    global_load_dwordx4 v[104:107], v6, s[44:45] offset:16
    global_load_dwordx4 v[108:111], v6, s[54:55]
    global_load_dwordx4 v[112:115], v6, s[54:55] offset:16
    v_mov_b32 v116, 0
    s_waitcnt vmcnt(0)
    v_lshlrev_b32 v118, 16, v100
    v_and_b32 v119, 0xffff0000, v100
    v_lshlrev_b32 v120, 16, v108
    v_and_b32 v121, 0xffff0000, v108
    v_pk_mul_f32 v[118:119], v[118:119], v[120:121]
    v_cvt_pk_bf16_f32 v118, 0, v118
    v_cvt_pk_bf16_f32 v119, 0, v119
    v_add_f32 v116, v116, v118
    v_add_f32 v116, v116, v119
    v_lshlrev_b32 v118, 16, v101
    v_and_b32 v119, 0xffff0000, v101
    v_lshlrev_b32 v120, 16, v109
    v_and_b32 v121, 0xffff0000, v109
    v_pk_mul_f32 v[118:119], v[118:119], v[120:121]
    v_cvt_pk_bf16_f32 v118, 0, v118
    v_cvt_pk_bf16_f32 v119, 0, v119
    v_add_f32 v116, v116, v118
    v_add_f32 v116, v116, v119
    v_lshlrev_b32 v118, 16, v102
    v_and_b32 v119, 0xffff0000, v102
    v_lshlrev_b32 v120, 16, v110
    v_and_b32 v121, 0xffff0000, v110
    v_pk_mul_f32 v[118:119], v[118:119], v[120:121]
    v_cvt_pk_bf16_f32 v118, 0, v118
    v_cvt_pk_bf16_f32 v119, 0, v119
    v_add_f32 v116, v116, v118
    v_add_f32 v116, v116, v119
    v_lshlrev_b32 v118, 16, v103
    v_and_b32 v119, 0xffff0000, v103
    v_lshlrev_b32 v120, 16, v111
    v_and_b32 v121, 0xffff0000, v111
    v_pk_mul_f32 v[118:119], v[118:119], v[120:121]
    v_cvt_pk_bf16_f32 v118, 0, v118
    v_cvt_pk_bf16_f32 v119, 0, v119
    v_add_f32 v116, v116, v118
    v_add_f32 v116, v116, v119
    v_lshlrev_b32 v118, 16, v104
    v_and_b32 v119, 0xffff0000, v104
    v_lshlrev_b32 v120, 16, v112
    v_and_b32 v121, 0xffff0000, v112
    v_pk_mul_f32 v[118:119], v[118:119], v[120:121]
    v_cvt_pk_bf16_f32 v118, 0, v118
    v_cvt_pk_bf16_f32 v119, 0, v119
    v_add_f32 v116, v116, v118
    v_add_f32 v116, v116, v119
    v_lshlrev_b32 v118, 16, v105
    v_and_b32 v119, 0xffff0000, v105
    v_lshlrev_b32 v120, 16, v113
    v_and_b32 v121, 0xffff0000, v113
    v_pk_mul_f32 v[118:119], v[118:119], v[120:121]
    v_cvt_pk_bf16_f32 v118, 0, v118
    v_cvt_pk_bf16_f32 v119, 0, v119
    v_add_f32 v116, v116, v118
    v_add_f32 v116, v116, v119
    v_lshlrev_b32 v118, 16, v106
    v_and_b32 v119, 0xffff0000, v106
    v_lshlrev_b32 v120, 16, v114
    v_and_b32 v121, 0xffff0000, v114
    v_pk_mul_f32 v[118:119], v[118:119], v[120:121]
    v_cvt_pk_bf16_f32 v118, 0, v118
    v_cvt_pk_bf16_f32 v119, 0, v119
    v_add_f32 v116, v116, v118
    v_add_f32 v116, v116, v119
    v_lshlrev_b32 v118, 16, v107
    v_and_b32 v119, 0xffff0000, v107
    v_lshlrev_b32 v120, 16, v115
    v_and_b32 v121, 0xffff0000, v115
    v_pk_mul_f32 v[118:119], v[118:119], v[120:121]
    v_cvt_pk_bf16_f32 v118, 0, v118
    v_cvt_pk_bf16_f32 v119, 0, v119
    v_add_f32 v116, v116, v118
    v_add_f32 v116, v116, v119
    ds_swizzle_b32 v118, v116 offset:0x41f
    s_waitcnt lgkmcnt(0)
    v_add_f32 v116, v116, v118
    ds_swizzle_b32 v118, v116 offset:0x81f
    s_waitcnt lgkmcnt(0)
    v_add_f32 v116, v116, v118
    ds_swizzle_b32 v118, v116 offset:0x101f
    s_waitcnt lgkmcnt(0)
    v_add_f32 v116, v116, v118
    ds_swizzle_b32 v118, v116 offset:0x201f
    s_waitcnt lgkmcnt(0)
    v_add_f32 v116, v116, v118
    v_mov_b32 v118, v116
    s_nop 1
    v_permlane16_swap_b32 v118, v116
    s_nop 1
    v_add_f32 v116, v116, v118
    v_mov_b32 v118, v116
    s_nop 1
    v_permlane32_swap_b32 v118, v116
    s_nop 1
    v_add_f32 v116, v116, v118
    v_cvt_pk_bf16_f32 v116, 0, v116
    v_mul_f32 v116, 0xbfb8aa3b, v116
    v_exp_f32 v116, v116
    s_nop 0
    v_add_f32 v116, 1.0, v116
    v_rcp_f32 v116, v116
    s_nop 0
    v_cvt_pk_bf16_f32 v116, 0, v116
    s_lshl_b32 s33, s17, 2
    s_add_u32 s33, s33, 41943040
    v_mov_b32 v118, s33
    s_lshl_b32 s33, s2, 8
    s_add_u32 s33, s33, 46137344
    v_mov_b32 v119, s33
    v_mov_b32 v120, 0
    v_cmp_eq_u32 vcc, 0, v0
    s_and_saveexec_b64 s[44:45], vcc
    global_store_dword v118, v116, s[12:13]
    global_store_dword v119, v120, s[12:13]
    global_store_dword v119, v120, s[12:13] offset:128
    s_mov_b64 exec, s[44:45]
    s_nop 1
    s_mul_i32 s42, s14, 5
    s_add_u32 s43, s42, 8
    s_lshl_b32 s43, s43, 6
    v_add_u32 v100, s43, v0
    v_mul_u32_u24 v101, s52, v100
    v_lshrrev_b32 v101, 20, v101
    v_mul_u32_u24 v102, 28, v101
    v_sub_u32 v102, v100, v102
    v_bfe_u32 v103, v101, 3, 1
    v_lshlrev_b32 v103, 1, v103
    v_xor_b32 v102, v102, v103
    v_add_u32 v101, 64, v101
    v_mul_u32_u24 v103, s53, v101
    v_lshl_add_u32 v103, v102, 4, v103
    v_cmp_le_u32 vcc, 14, v102
    v_mov_b32 v104, s38
    v_mov_b32 v105, s39
    v_mov_b32 v100, s40
    v_mov_b32 v101, s41
    v_cndmask_b32 v104, v104, v100, vcc
    v_cndmask_b32 v105, v105, v101, vcc
    v_add_co_u32 v2, vcc, v104, v103
    s_nop 1
    v_addc_co_u32 v3, vcc, 0, v105, vcc
    s_add_u32 s43, s42, 9
    s_lshl_b32 s43, s43, 6
    v_add_u32 v100, s43, v0
    v_mul_u32_u24 v101, s52, v100
    v_lshrrev_b32 v101, 20, v101
    v_mul_u32_u24 v102, 28, v101
    v_sub_u32 v102, v100, v102
    v_bfe_u32 v103, v101, 3, 1
    v_lshlrev_b32 v103, 1, v103
    v_xor_b32 v102, v102, v103
    v_add_u32 v101, 64, v101
    v_mul_u32_u24 v103, s53, v101
    v_lshl_add_u32 v103, v102, 4, v103
    v_cmp_le_u32 vcc, 14, v102
    v_mov_b32 v104, s38
    v_mov_b32 v105, s39
    v_mov_b32 v100, s40
    v_mov_b32 v101, s41
    v_cndmask_b32 v104, v104, v100, vcc
    v_cndmask_b32 v105, v105, v101, vcc
    v_add_co_u32 v4, vcc, v104, v103
    s_nop 1
    v_addc_co_u32 v5, vcc, 0, v105, vcc
    s_add_u32 s43, s42, 10
    s_lshl_b32 s43, s43, 6
    v_add_u32 v100, s43, v0
    v_mul_u32_u24 v101, s52, v100
    v_lshrrev_b32 v101, 20, v101
    v_mul_u32_u24 v102, 28, v101
    v_sub_u32 v102, v100, v102
    v_bfe_u32 v103, v101, 3, 1
    v_lshlrev_b32 v103, 1, v103
    v_xor_b32 v102, v102, v103
    v_add_u32 v101, 64, v101
    v_mul_u32_u24 v103, s53, v101
    v_lshl_add_u32 v103, v102, 4, v103
    v_cmp_le_u32 vcc, 14, v102
    v_mov_b32 v104, s38
    v_mov_b32 v105, s39
    v_mov_b32 v100, s40
    v_mov_b32 v101, s41
    v_cndmask_b32 v104, v104, v100, vcc
    v_cndmask_b32 v105, v105, v101, vcc
    v_add_co_u32 v6, vcc, v104, v103
    s_nop 1
    v_addc_co_u32 v7, vcc, 0, v105, vcc
    s_add_u32 s43, s42, 11
    s_lshl_b32 s43, s43, 6
    v_add_u32 v100, s43, v0
    v_mul_u32_u24 v101, s52, v100
    v_lshrrev_b32 v101, 20, v101
    v_mul_u32_u24 v102, 28, v101
    v_sub_u32 v102, v100, v102
    v_bfe_u32 v103, v101, 3, 1
    v_lshlrev_b32 v103, 1, v103
    v_xor_b32 v102, v102, v103
    v_add_u32 v101, 64, v101
    v_mul_u32_u24 v103, s53, v101
    v_lshl_add_u32 v103, v102, 4, v103
    v_cmp_le_u32 vcc, 14, v102
    v_mov_b32 v104, s38
    v_mov_b32 v105, s39
    v_mov_b32 v100, s40
    v_mov_b32 v101, s41
    v_cndmask_b32 v104, v104, v100, vcc
    v_cndmask_b32 v105, v105, v101, vcc
    v_add_co_u32 v8, vcc, v104, v103
    s_nop 1
    v_addc_co_u32 v9, vcc, 0, v105, vcc
    s_add_u32 s43, s42, 12
    s_lshl_b32 s43, s43, 6
    v_add_u32 v100, s43, v0
    v_mul_u32_u24 v101, s52, v100
    v_lshrrev_b32 v101, 20, v101
    v_mul_u32_u24 v102, 28, v101
    v_sub_u32 v102, v100, v102
    v_bfe_u32 v103, v101, 3, 1
    v_lshlrev_b32 v103, 1, v103
    v_xor_b32 v102, v102, v103
    v_add_u32 v101, 64, v101
    v_mul_u32_u24 v103, s53, v101
    v_lshl_add_u32 v103, v102, 4, v103
    v_cmp_le_u32 vcc, 14, v102
    v_mov_b32 v104, s38
    v_mov_b32 v105, s39
    v_mov_b32 v100, s40
    v_mov_b32 v101, s41
    v_cndmask_b32 v104, v104, v100, vcc
    v_cndmask_b32 v105, v105, v101, vcc
    v_add_co_u32 v30, vcc, v104, v103
    s_nop 1
    v_addc_co_u32 v31, vcc, 0, v105, vcc
    s_mov_b32 s78, 458752
    s_mov_b32 s79, 0
    s_add_u32 s76, s18, 262144
    s_addc_u32 s77, s19, 0
    s_cmp_ge_u32 s14, 4
    s_cbranch_scc1 L1_h1
    s_waitcnt vmcnt(0)
    s_barrier
    ds_read_b128 v[56:59], v24 offset:0
    ds_read_b128 v[60:63], v24 offset:2048
    ds_read_b128 v[64:67], v24 offset:4096
    ds_read_b128 v[68:71], v24 offset:6144
    ds_read_b64_tr_b16 v[32:33], v28 offset:0
    ds_read_b64_tr_b16 v[34:35], v28 offset:1792
    ds_read_b64_tr_b16 v[36:37], v29 offset:32
    ds_read_b64_tr_b16 v[38:39], v29 offset:1824
    ds_read_b64_tr_b16 v[40:41], v28 offset:64
    ds_read_b64_tr_b16 v[42:43], v28 offset:1856
    ds_read_b64_tr_b16 v[44:45], v29 offset:96
    ds_read_b64_tr_b16 v[46:47], v29 offset:1888
    s_mov_b32 s32, 6
    ds_read_b64_tr_b16 v[48:49], v29 offset:224
    ds_read_b64_tr_b16 v[50:51], v29 offset:2016
    s_waitcnt lgkmcnt(8)
    v_mfma_f32_16x16x32_bf16 v[96:99], v[32:35], v[56:59], 0
    s_add_u32 m0, s21, 40960
    s_nop 0
    global_load_lds_dwordx4 v[14:15], off
    v_lshl_add_u64 v[14:15], v[14:15], 0, s[22:23]
    v_mfma_f32_16x16x32_bf16 v[136:139], v[32:35], v[60:63], 0
    s_add_u32 m0, s20, 32768
    s_nop 0
    global_load_lds_dwordx4 v10, s[18:19]
    v_mfma_f32_16x16x32_bf16 v[176:179], v[32:35], v[64:67], 0
    v_mfma_f32_16x16x32_bf16 v[216:219], v[32:35], v[68:71], 0
    ds_read_b64_tr_b16 v[32:33], v28 offset:256
    ds_read_b64_tr_b16 v[34:35], v28 offset:2048
    s_waitcnt lgkmcnt(8)
    v_mfma_f32_16x16x32_bf16 v[100:103], v[36:39], v[56:59], 0
    s_add_u32 m0, s21, 41984
    s_nop 0
    global_load_lds_dwordx4 v[16:17], off
    v_lshl_add_u64 v[16:17], v[16:17], 0, s[24:25]
    v_mfma_f32_16x16x32_bf16 v[140:143], v[36:39], v[60:63], 0
    s_add_u32 m0, s20, 33792
    s_nop 0
    global_load_lds_dwordx4 v11, s[18:19]
    v_mfma_f32_16x16x32_bf16 v[180:183], v[36:39], v[64:67], 0
    v_mfma_f32_16x16x32_bf16 v[220:223], v[36:39], v[68:71], 0
    ds_read_b64_tr_b16 v[36:37], v29 offset:288
    ds_read_b64_tr_b16 v[38:39], v29 offset:2080
    ds_read_b128 v[72:75], v25 offset:0
    s_waitcnt lgkmcnt(9)
    v_mfma_f32_16x16x32_bf16 v[104:107], v[40:43], v[56:59], 0
    s_add_u32 m0, s21, 43008
    s_nop 0
    global_load_lds_dwordx4 v[18:19], off
    v_lshl_add_u64 v[18:19], v[18:19], 0, s[26:27]
    v_mfma_f32_16x16x32_bf16 v[144:147], v[40:43], v[60:63], 0
    s_add_u32 m0, s20, 34816
    s_nop 0
    global_load_lds_dwordx4 v12, s[18:19]
    v_mfma_f32_16x16x32_bf16 v[184:187], v[40:43], v[64:67], 0
    v_mfma_f32_16x16x32_bf16 v[224:227], v[40:43], v[68:71], 0
    ds_read_b64_tr_b16 v[40:41], v28 offset:320
    ds_read_b64_tr_b16 v[42:43], v28 offset:2112
    ds_read_b128 v[76:79], v25 offset:2048
    s_waitcnt lgkmcnt(10)
    v_mfma_f32_16x16x32_bf16 v[108:111], v[44:47], v[56:59], 0
    s_add_u32 m0, s21, 44032
    s_nop 0
    global_load_lds_dwordx4 v[20:21], off
    v_lshl_add_u64 v[20:21], v[20:21], 0, s[28:29]
    v_mfma_f32_16x16x32_bf16 v[148:151], v[44:47], v[60:63], 0
    s_add_u32 m0, s20, 35840
    s_nop 0
    global_load_lds_dwordx4 v13, s[18:19]
    s_add_u32 s18, s18, 128
    s_addc_u32 s19, s19, 0
    v_mfma_f32_16x16x32_bf16 v[188:191], v[44:47], v[64:67], 0
    v_mfma_f32_16x16x32_bf16 v[228:231], v[44:47], v[68:71], 0
    ds_read_b64_tr_b16 v[44:45], v26 offset:0
    ds_read_b64_tr_b16 v[46:47], v26 offset:768
    ds_read_b128 v[80:83], v25 offset:4096
    s_waitcnt lgkmcnt(11)
    v_mfma_f32_16x16x32_bf16 v[112:115], v[48:51], v[56:59], 0
    s_add_u32 m0, s21, 45056
    s_nop 0
    global_load_lds_dwordx4 v[22:23], off
    v_lshl_add_u64 v[22:23], v[22:23], 0, s[30:31]
    v_mfma_f32_16x16x32_bf16 v[152:155], v[48:51], v[60:63], 0
    s_add_u32 m0, s21, 61440
    s_nop 0
    global_load_lds_dwordx4 v[2:3], off
    v_lshl_add_u64 v[2:3], v[2:3], 0, s[78:79]
    v_mfma_f32_16x16x32_bf16 v[192:195], v[48:51], v[64:67], 0
    v_mfma_f32_16x16x32_bf16 v[232:235], v[48:51], v[68:71], 0
    ds_read_b64_tr_b16 v[48:49], v27 offset:32
    ds_read_b64_tr_b16 v[50:51], v27 offset:800
    ds_read_b128 v[84:87], v25 offset:6144
    s_waitcnt lgkmcnt(12)
    v_mfma_f32_16x16x32_bf16 v[116:119], v[32:35], v[56:59], 0
    s_add_u32 m0, s20, 49152
    s_nop 0
    global_load_lds_dwordx4 v10, s[76:77]
    v_mfma_f32_16x16x32_bf16 v[156:159], v[32:35], v[60:63], 0
    s_add_u32 m0, s21, 62464
    s_nop 0
    global_load_lds_dwordx4 v[4:5], off
    v_lshl_add_u64 v[4:5], v[4:5], 0, s[78:79]
    v_mfma_f32_16x16x32_bf16 v[196:199], v[32:35], v[64:67], 0
    v_mfma_f32_16x16x32_bf16 v[236:239], v[32:35], v[68:71], 0
    ds_read_b64_tr_b16 v[32:33], v28 offset:14336
    ds_read_b64_tr_b16 v[34:35], v28 offset:16128
    s_waitcnt lgkmcnt(12)
    v_mfma_f32_16x16x32_bf16 v[120:123], v[36:39], v[56:59], 0
    s_add_u32 m0, s20, 50176
    s_nop 0
    global_load_lds_dwordx4 v11, s[76:77]
    v_mfma_f32_16x16x32_bf16 v[160:163], v[36:39], v[60:63], 0
    s_add_u32 m0, s21, 63488
    s_nop 0
    global_load_lds_dwordx4 v[6:7], off
    v_lshl_add_u64 v[6:7], v[6:7], 0, s[78:79]
    v_mfma_f32_16x16x32_bf16 v[200:203], v[36:39], v[64:67], 0
    v_mfma_f32_16x16x32_bf16 v[240:243], v[36:39], v[68:71], 0
    ds_read_b64_tr_b16 v[36:37], v29 offset:14368
    ds_read_b64_tr_b16 v[38:39], v29 offset:16160
    s_waitcnt lgkmcnt(11)
    v_mfma_f32_16x16x32_bf16 v[124:127], v[40:43], v[56:59], 0
    s_add_u32 m0, s20, 51200
    s_nop 0
    global_load_lds_dwordx4 v12, s[76:77]
    v_mfma_f32_16x16x32_bf16 v[164:167], v[40:43], v[60:63], 0
    s_add_u32 m0, s21, 64512
    s_nop 0
    global_load_lds_dwordx4 v[8:9], off
    v_lshl_add_u64 v[8:9], v[8:9], 0, s[78:79]
    v_mfma_f32_16x16x32_bf16 v[204:207], v[40:43], v[64:67], 0
    v_mfma_f32_16x16x32_bf16 v[244:247], v[40:43], v[68:71], 0
    ds_read_b64_tr_b16 v[40:41], v28 offset:14400
    ds_read_b64_tr_b16 v[42:43], v28 offset:16192
    s_waitcnt lgkmcnt(10)
    v_mfma_f32_16x16x32_bf16 v[128:131], v[44:47], v[56:59], 0
    s_add_u32 m0, s20, 52224
    s_nop 0
    global_load_lds_dwordx4 v13, s[76:77]
    s_add_u32 s76, s76, 128
    s_addc_u32 s77, s77, 0
    v_mfma_f32_16x16x32_bf16 v[168:171], v[44:47], v[60:63], 0
    s_add_u32 m0, s21, 65536
    s_nop 0
    global_load_lds_dwordx4 v[30:31], off
    v_lshl_add_u64 v[30:31], v[30:31], 0, s[78:79]
    v_mfma_f32_16x16x32_bf16 v[208:211], v[44:47], v[64:67], 0
    v_mfma_f32_16x16x32_bf16 v[248:251], v[44:47], v[68:71], 0
    ds_read_b64_tr_b16 v[44:45], v29 offset:14432
    ds_read_b64_tr_b16 v[46:47], v29 offset:16224
    s_waitcnt lgkmcnt(9)
    v_mfma_f32_16x16x32_bf16 v[132:135], v[48:51], v[56:59], 0
    global_load_dword v92, v[88:89], off
    v_lshl_add_u64 v[88:89], v[88:89], 0, v[90:91]
    v_mfma_f32_16x16x32_bf16 v[172:175], v[48:51], v[60:63], 0
    global_load_dword v92, v[88:89], off
    v_lshl_add_u64 v[88:89], v[88:89], 0, v[90:91]
    v_mfma_f32_16x16x32_bf16 v[212:215], v[48:51], v[64:67], 0
    v_mfma_f32_16x16x32_bf16 v[252:255], v[48:51], v[68:71], 0
    ds_read_b64_tr_b16 v[48:49], v29 offset:14560
    ds_read_b64_tr_b16 v[50:51], v29 offset:16352
    s_waitcnt lgkmcnt(8)
    v_mfma_f32_16x16x32_bf16 v[96:99], v[32:35], v[72:75], v[96:99]
    v_mfma_f32_16x16x32_bf16 v[136:139], v[32:35], v[76:79], v[136:139]
    v_mfma_f32_16x16x32_bf16 v[176:179], v[32:35], v[80:83], v[176:179]
    v_mfma_f32_16x16x32_bf16 v[216:219], v[32:35], v[84:87], v[216:219]
    ds_read_b64_tr_b16 v[32:33], v28 offset:14592
    ds_read_b64_tr_b16 v[34:35], v28 offset:16384
    s_waitcnt lgkmcnt(8)
    v_mfma_f32_16x16x32_bf16 v[100:103], v[36:39], v[72:75], v[100:103]
    v_mfma_f32_16x16x32_bf16 v[140:143], v[36:39], v[76:79], v[140:143]
    v_mfma_f32_16x16x32_bf16 v[180:183], v[36:39], v[80:83], v[180:183]
    v_mfma_f32_16x16x32_bf16 v[220:223], v[36:39], v[84:87], v[220:223]
    ds_read_b64_tr_b16 v[36:37], v29 offset:14624
    ds_read_b64_tr_b16 v[38:39], v29 offset:16416
    s_waitcnt lgkmcnt(8)
    v_mfma_f32_16x16x32_bf16 v[104:107], v[40:43], v[72:75], v[104:107]
    v_mfma_f32_16x16x32_bf16 v[144:147], v[40:43], v[76:79], v[144:147]
    v_mfma_f32_16x16x32_bf16 v[184:187], v[40:43], v[80:83], v[184:187]
    v_mfma_f32_16x16x32_bf16 v[224:227], v[40:43], v[84:87], v[224:227]
    ds_read_b64_tr_b16 v[40:41], v28 offset:14656
    ds_read_b64_tr_b16 v[42:43], v28 offset:16448
    s_waitcnt lgkmcnt(8)
    v_mfma_f32_16x16x32_bf16 v[108:111], v[44:47], v[72:75], v[108:111]
    v_mfma_f32_16x16x32_bf16 v[148:151], v[44:47], v[76:79], v[148:151]
    v_mfma_f32_16x16x32_bf16 v[188:191], v[44:47], v[80:83], v[188:191]
    v_mfma_f32_16x16x32_bf16 v[228:231], v[44:47], v[84:87], v[228:231]
    ds_read_b64_tr_b16 v[44:45], v26 offset:6144
    ds_read_b64_tr_b16 v[46:47], v26 offset:6912
    s_waitcnt lgkmcnt(8)
    v_mfma_f32_16x16x32_bf16 v[112:115], v[48:51], v[72:75], v[112:115]
    v_mfma_f32_16x16x32_bf16 v[152:155], v[48:51], v[76:79], v[152:155]
    v_mfma_f32_16x16x32_bf16 v[192:195], v[48:51], v[80:83], v[192:195]
    v_mfma_f32_16x16x32_bf16 v[232:235], v[48:51], v[84:87], v[232:235]
    ds_read_b64_tr_b16 v[48:49], v27 offset:6176
    ds_read_b64_tr_b16 v[50:51], v27 offset:6944
    s_waitcnt lgkmcnt(8)
    v_mfma_f32_16x16x32_bf16 v[116:119], v[32:35], v[72:75], v[116:119]
    v_mfma_f32_16x16x32_bf16 v[156:159], v[32:35], v[76:79], v[156:159]
    v_mfma_f32_16x16x32_bf16 v[196:199], v[32:35], v[80:83], v[196:199]
    v_mfma_f32_16x16x32_bf16 v[236:239], v[32:35], v[84:87], v[236:239]
    s_waitcnt lgkmcnt(0) vmcnt(0)
    s_barrier
    ds_read_b128 v[56:59], v24 offset:32768
    ds_read_b128 v[60:63], v24 offset:34816
    ds_read_b128 v[64:67], v24 offset:36864
    ds_read_b128 v[68:71], v24 offset:38912
    ds_read_b64_tr_b16 v[32:33], v28 offset:40960
    ds_read_b64_tr_b16 v[34:35], v28 offset:42752
    v_mfma_f32_16x16x32_bf16 v[120:123], v[36:39], v[72:75], v[120:123]
    s_add_u32 m0, s21, 0
    s_nop 0
    global_load_lds_dwordx4 v[14:15], off
    v_lshl_add_u64 v[14:15], v[14:15], 0, s[22:23]
    v_mfma_f32_16x16x32_bf16 v[160:163], v[36:39], v[76:79], v[160:163]
    s_add_u32 m0, s20, 0
    s_nop 0
    global_load_lds_dwordx4 v10, s[18:19]
    v_mfma_f32_16x16x32_bf16 v[200:203], v[36:39], v[80:83], v[200:203]
    v_mfma_f32_16x16x32_bf16 v[240:243], v[36:39], v[84:87], v[240:243]
    ds_read_b64_tr_b16 v[36:37], v29 offset:40992
    ds_read_b64_tr_b16 v[38:39], v29 offset:42784
    v_mfma_f32_16x16x32_bf16 v[124:127], v[40:43], v[72:75], v[124:127]
    s_add_u32 m0, s21, 1024
    s_nop 0
    global_load_lds_dwordx4 v[16:17], off
    v_lshl_add_u64 v[16:17], v[16:17], 0, s[24:25]
    v_mfma_f32_16x16x32_bf16 v[164:167], v[40:43], v[76:79], v[164:167]
    s_add_u32 m0, s20, 1024
    s_nop 0
    global_load_lds_dwordx4 v11, s[18:19]
    v_mfma_f32_16x16x32_bf16 v[204:207], v[40:43], v[80:83], v[204:207]
    v_mfma_f32_16x16x32_bf16 v[244:247], v[40:43], v[84:87], v[244:247]
    ds_read_b64_tr_b16 v[40:41], v28 offset:41024
    ds_read_b64_tr_b16 v[42:43], v28 offset:42816
    v_mfma_f32_16x16x32_bf16 v[128:131], v[44:47], v[72:75], v[128:131]
    s_add_u32 m0, s21, 2048
    s_nop 0
    global_load_lds_dwordx4 v[18:19], off
    v_lshl_add_u64 v[18:19], v[18:19], 0, s[26:27]
    v_mfma_f32_16x16x32_bf16 v[168:171], v[44:47], v[76:79], v[168:171]
    global_load_dword v92, v[88:89], off
    v_lshl_add_u64 v[88:89], v[88:89], 0, v[90:91]
    v_mfma_f32_16x16x32_bf16 v[208:211], v[44:47], v[80:83], v[208:211]
    v_mfma_f32_16x16x32_bf16 v[248:251], v[44:47], v[84:87], v[248:251]
    ds_read_b64_tr_b16 v[44:45], v29 offset:41056
    ds_read_b64_tr_b16 v[46:47], v29 offset:42848
    v_mfma_f32_16x16x32_bf16 v[132:135], v[48:51], v[72:75], v[132:135]
    s_add_u32 m0, s20, 2048
    s_nop 0
    global_load_lds_dwordx4 v12, s[18:19]
    v_mfma_f32_16x16x32_bf16 v[172:175], v[48:51], v[76:79], v[172:175]
    s_add_u32 m0, s21, 3072
    s_nop 0
    global_load_lds_dwordx4 v[20:21], off
    v_lshl_add_u64 v[20:21], v[20:21], 0, s[28:29]
    v_mfma_f32_16x16x32_bf16 v[212:215], v[48:51], v[80:83], v[212:215]
    v_mfma_f32_16x16x32_bf16 v[252:255], v[48:51], v[84:87], v[252:255]
L1_loop0:
    ds_read_b64_tr_b16 v[48:49], v29 offset:41184
    ds_read_b64_tr_b16 v[50:51], v29 offset:42976
    s_waitcnt lgkmcnt(8)
    v_mfma_f32_16x16x32_bf16 v[96:99], v[32:35], v[56:59], v[96:99]
    s_add_u32 m0, s20, 3072
    s_nop 0
    global_load_lds_dwordx4 v13, s[18:19]
    s_add_u32 s18, s18, 128
    s_addc_u32 s19, s19, 0
    v_mfma_f32_16x16x32_bf16 v[136:139], v[32:35], v[60:63], v[136:139]
    s_add_u32 m0, s21, 4096
    s_nop 0
    global_load_lds_dwordx4 v[22:23], off
    v_lshl_add_u64 v[22:23], v[22:23], 0, s[30:31]
    v_mfma_f32_16x16x32_bf16 v[176:179], v[32:35], v[64:67], v[176:179]
    v_mfma_f32_16x16x32_bf16 v[216:219], v[32:35], v[68:71], v[216:219]
    ds_read_b64_tr_b16 v[32:33], v28 offset:41216
    ds_read_b64_tr_b16 v[34:35], v28 offset:43008
    s_waitcnt lgkmcnt(8)
    v_mfma_f32_16x16x32_bf16 v[100:103], v[36:39], v[56:59], v[100:103]
    s_add_u32 m0, s21, 20480
    s_nop 0
    global_load_lds_dwordx4 v[2:3], off
    v_lshl_add_u64 v[2:3], v[2:3], 0, s[78:79]
    v_mfma_f32_16x16x32_bf16 v[140:143], v[36:39], v[60:63], v[140:143]
    s_add_u32 m0, s20, 16384
    s_nop 0
    global_load_lds_dwordx4 v10, s[76:77]
    v_mfma_f32_16x16x32_bf16 v[180:183], v[36:39], v[64:67], v[180:183]
    v_mfma_f32_16x16x32_bf16 v[220:223], v[36:39], v[68:71], v[220:223]
    ds_read_b64_tr_b16 v[36:37], v29 offset:41248
    ds_read_b64_tr_b16 v[38:39], v29 offset:43040
    ds_read_b128 v[72:75], v25 offset:32768
    s_waitcnt lgkmcnt(9)
    v_mfma_f32_16x16x32_bf16 v[104:107], v[40:43], v[56:59], v[104:107]
    s_add_u32 m0, s21, 21504
    s_nop 0
    global_load_lds_dwordx4 v[4:5], off
    v_lshl_add_u64 v[4:5], v[4:5], 0, s[78:79]
    v_mfma_f32_16x16x32_bf16 v[144:147], v[40:43], v[60:63], v[144:147]
    s_add_u32 m0, s20, 17408
    s_nop 0
    global_load_lds_dwordx4 v11, s[76:77]
    v_mfma_f32_16x16x32_bf16 v[184:187], v[40:43], v[64:67], v[184:187]
    v_mfma_f32_16x16x32_bf16 v[224:227], v[40:43], v[68:71], v[224:227]
    ds_read_b64_tr_b16 v[40:41], v28 offset:41280
    ds_read_b64_tr_b16 v[42:43], v28 offset:43072
    ds_read_b128 v[76:79], v25 offset:34816
    s_waitcnt lgkmcnt(10)
    v_mfma_f32_16x16x32_bf16 v[108:111], v[44:47], v[56:59], v[108:111]
    s_add_u32 m0, s21, 22528
    s_nop 0
    global_load_lds_dwordx4 v[6:7], off
    v_lshl_add_u64 v[6:7], v[6:7], 0, s[78:79]
    v_mfma_f32_16x16x32_bf16 v[148:151], v[44:47], v[60:63], v[148:151]
    s_add_u32 m0, s20, 18432
    s_nop 0
    global_load_lds_dwordx4 v12, s[76:77]
    v_mfma_f32_16x16x32_bf16 v[188:191], v[44:47], v[64:67], v[188:191]
    v_mfma_f32_16x16x32_bf16 v[228:231], v[44:47], v[68:71], v[228:231]
    ds_read_b64_tr_b16 v[44:45], v26 offset:40960
    ds_read_b64_tr_b16 v[46:47], v26 offset:41728
    ds_read_b128 v[80:83], v25 offset:36864
    s_waitcnt lgkmcnt(11)
    v_mfma_f32_16x16x32_bf16 v[112:115], v[48:51], v[56:59], v[112:115]
    s_add_u32 m0, s21, 23552
    s_nop 0
    global_load_lds_dwordx4 v[8:9], off
    v_lshl_add_u64 v[8:9], v[8:9], 0, s[78:79]
    v_mfma_f32_16x16x32_bf16 v[152:155], v[48:51], v[60:63], v[152:155]
    s_add_u32 m0, s20, 19456
    s_nop 0
    global_load_lds_dwordx4 v13, s[76:77]
    s_add_u32 s76, s76, 128
    s_addc_u32 s77, s77, 0
    v_mfma_f32_16x16x32_bf16 v[192:195], v[48:51], v[64:67], v[192:195]
    v_mfma_f32_16x16x32_bf16 v[232:235], v[48:51], v[68:71], v[232:235]
    ds_read_b64_tr_b16 v[48:49], v27 offset:40992
    ds_read_b64_tr_b16 v[50:51], v27 offset:41760
    ds_read_b128 v[84:87], v25 offset:38912
    s_waitcnt lgkmcnt(12)
    v_mfma_f32_16x16x32_bf16 v[116:119], v[32:35], v[56:59], v[116:119]
    s_add_u32 m0, s21, 24576
    s_nop 0
    global_load_lds_dwordx4 v[30:31], off
    v_lshl_add_u64 v[30:31], v[30:31], 0, s[78:79]
    v_mfma_f32_16x16x32_bf16 v[156:159], v[32:35], v[60:63], v[156:159]
    v_mfma_f32_16x16x32_bf16 v[196:199], v[32:35], v[64:67], v[196:199]
    v_mfma_f32_16x16x32_bf16 v[236:239], v[32:35], v[68:71], v[236:239]
    ds_read_b64_tr_b16 v[32:33], v28 offset:55296
    ds_read_b64_tr_b16 v[34:35], v28 offset:57088
    s_waitcnt lgkmcnt(12)
    v_mfma_f32_16x16x32_bf16 v[120:123], v[36:39], v[56:59], v[120:123]
    v_mfma_f32_16x16x32_bf16 v[160:163], v[36:39], v[60:63], v[160:163]
    v_mfma_f32_16x16x32_bf16 v[200:203], v[36:39], v[64:67], v[200:203]
    v_mfma_f32_16x16x32_bf16 v[240:243], v[36:39], v[68:71], v[240:243]
    ds_read_b64_tr_b16 v[36:37], v29 offset:55328
    ds_read_b64_tr_b16 v[38:39], v29 offset:57120
    s_waitcnt lgkmcnt(11)
    v_mfma_f32_16x16x32_bf16 v[124:127], v[40:43], v[56:59], v[124:127]
    v_mfma_f32_16x16x32_bf16 v[164:167], v[40:43], v[60:63], v[164:167]
    v_mfma_f32_16x16x32_bf16 v[204:207], v[40:43], v[64:67], v[204:207]
    v_mfma_f32_16x16x32_bf16 v[244:247], v[40:43], v[68:71], v[244:247]
    ds_read_b64_tr_b16 v[40:41], v28 offset:55360
    ds_read_b64_tr_b16 v[42:43], v28 offset:57152
    s_waitcnt lgkmcnt(10)
    v_mfma_f32_16x16x32_bf16 v[128:131], v[44:47], v[56:59], v[128:131]
    v_mfma_f32_16x16x32_bf16 v[168:171], v[44:47], v[60:63], v[168:171]
    v_mfma_f32_16x16x32_bf16 v[208:211], v[44:47], v[64:67], v[208:211]
    v_mfma_f32_16x16x32_bf16 v[248:251], v[44:47], v[68:71], v[248:251]
    ds_read_b64_tr_b16 v[44:45], v29 offset:55392
    ds_read_b64_tr_b16 v[46:47], v29 offset:57184
    s_waitcnt lgkmcnt(9)
    v_mfma_f32_16x16x32_bf16 v[132:135], v[48:51], v[56:59], v[132:135]
    v_mfma_f32_16x16x32_bf16 v[172:175], v[48:51], v[60:63], v[172:175]
    v_mfma_f32_16x16x32_bf16 v[212:215], v[48:51], v[64:67], v[212:215]
    v_mfma_f32_16x16x32_bf16 v[252:255], v[48:51], v[68:71], v[252:255]
    ds_read_b64_tr_b16 v[48:49], v29 offset:55520
    ds_read_b64_tr_b16 v[50:51], v29 offset:57312
    s_waitcnt lgkmcnt(8)
    v_mfma_f32_16x16x32_bf16 v[96:99], v[32:35], v[72:75], v[96:99]
    v_mfma_f32_16x16x32_bf16 v[136:139], v[32:35], v[76:79], v[136:139]
    v_mfma_f32_16x16x32_bf16 v[176:179], v[32:35], v[80:83], v[176:179]
    v_mfma_f32_16x16x32_bf16 v[216:219], v[32:35], v[84:87], v[216:219]
    ds_read_b64_tr_b16 v[32:33], v28 offset:55552
    ds_read_b64_tr_b16 v[34:35], v28 offset:57344
    s_waitcnt lgkmcnt(8)
    v_mfma_f32_16x16x32_bf16 v[100:103], v[36:39], v[72:75], v[100:103]
    v_mfma_f32_16x16x32_bf16 v[140:143], v[36:39], v[76:79], v[140:143]
    v_mfma_f32_16x16x32_bf16 v[180:183], v[36:39], v[80:83], v[180:183]
    v_mfma_f32_16x16x32_bf16 v[220:223], v[36:39], v[84:87], v[220:223]
    ds_read_b64_tr_b16 v[36:37], v29 offset:55584
    ds_read_b64_tr_b16 v[38:39], v29 offset:57376
    s_waitcnt lgkmcnt(8)
    v_mfma_f32_16x16x32_bf16 v[104:107], v[40:43], v[72:75], v[104:107]
    v_mfma_f32_16x16x32_bf16 v[144:147], v[40:43], v[76:79], v[144:147]
    v_mfma_f32_16x16x32_bf16 v[184:187], v[40:43], v[80:83], v[184:187]
    v_mfma_f32_16x16x32_bf16 v[224:227], v[40:43], v[84:87], v[224:227]
    ds_read_b64_tr_b16 v[40:41], v28 offset:55616
    ds_read_b64_tr_b16 v[42:43], v28 offset:57408
    s_waitcnt lgkmcnt(8)
    v_mfma_f32_16x16x32_bf16 v[108:111], v[44:47], v[72:75], v[108:111]
    v_mfma_f32_16x16x32_bf16 v[148:151], v[44:47], v[76:79], v[148:151]
    v_mfma_f32_16x16x32_bf16 v[188:191], v[44:47], v[80:83], v[188:191]
    v_mfma_f32_16x16x32_bf16 v[228:231], v[44:47], v[84:87], v[228:231]
    ds_read_b64_tr_b16 v[44:45], v26 offset:47104
    ds_read_b64_tr_b16 v[46:47], v26 offset:47872
    s_waitcnt lgkmcnt(8)
    v_mfma_f32_16x16x32_bf16 v[112:115], v[48:51], v[72:75], v[112:115]
    v_mfma_f32_16x16x32_bf16 v[152:155], v[48:51], v[76:79], v[152:155]
    v_mfma_f32_16x16x32_bf16 v[192:195], v[48:51], v[80:83], v[192:195]
    v_mfma_f32_16x16x32_bf16 v[232:235], v[48:51], v[84:87], v[232:235]
    ds_read_b64_tr_b16 v[48:49], v27 offset:47136
    ds_read_b64_tr_b16 v[50:51], v27 offset:47904
    s_waitcnt lgkmcnt(8)
    v_mfma_f32_16x16x32_bf16 v[116:119], v[32:35], v[72:75], v[116:119]
    v_mfma_f32_16x16x32_bf16 v[156:159], v[32:35], v[76:79], v[156:159]
    v_mfma_f32_16x16x32_bf16 v[196:199], v[32:35], v[80:83], v[196:199]
    v_mfma_f32_16x16x32_bf16 v[236:239], v[32:35], v[84:87], v[236:239]
    s_waitcnt lgkmcnt(0) vmcnt(0)
    s_barrier
    ds_read_b128 v[56:59], v24 offset:0
    ds_read_b128 v[60:63], v24 offset:2048
    ds_read_b128 v[64:67], v24 offset:4096
    ds_read_b128 v[68:71], v24 offset:6144
    ds_read_b64_tr_b16 v[32:33], v28 offset:0
    ds_read_b64_tr_b16 v[34:35], v28 offset:1792
    v_mfma_f32_16x16x32_bf16 v[120:123], v[36:39], v[72:75], v[120:123]
    s_add_u32 m0, s21, 40960
    s_nop 0
    global_load_lds_dwordx4 v[14:15], off
    v_lshl_add_u64 v[14:15], v[14:15], 0, s[22:23]
    v_mfma_f32_16x16x32_bf16 v[160:163], v[36:39], v[76:79], v[160:163]
    s_add_u32 m0, s20, 32768
    s_nop 0
    global_load_lds_dwordx4 v10, s[18:19]
    v_mfma_f32_16x16x32_bf16 v[200:203], v[36:39], v[80:83], v[200:203]
    v_mfma_f32_16x16x32_bf16 v[240:243], v[36:39], v[84:87], v[240:243]
    ds_read_b64_tr_b16 v[36:37], v29 offset:32
    ds_read_b64_tr_b16 v[38:39], v29 offset:1824
    v_mfma_f32_16x16x32_bf16 v[124:127], v[40:43], v[72:75], v[124:127]
    s_add_u32 m0, s21, 41984
    s_nop 0
    global_load_lds_dwordx4 v[16:17], off
    v_lshl_add_u64 v[16:17], v[16:17], 0, s[24:25]
    v_mfma_f32_16x16x32_bf16 v[164:167], v[40:43], v[76:79], v[164:167]
    s_add_u32 m0, s20, 33792
    s_nop 0
    global_load_lds_dwordx4 v11, s[18:19]
    v_mfma_f32_16x16x32_bf16 v[204:207], v[40:43], v[80:83], v[204:207]
    v_mfma_f32_16x16x32_bf16 v[244:247], v[40:43], v[84:87], v[244:247]
    ds_read_b64_tr_b16 v[40:41], v28 offset:64
    ds_read_b64_tr_b16 v[42:43], v28 offset:1856
    v_mfma_f32_16x16x32_bf16 v[128:131], v[44:47], v[72:75], v[128:131]
    s_add_u32 m0, s21, 43008
    s_nop 0
    global_load_lds_dwordx4 v[18:19], off
    v_lshl_add_u64 v[18:19], v[18:19], 0, s[26:27]
    v_mfma_f32_16x16x32_bf16 v[168:171], v[44:47], v[76:79], v[168:171]
    global_load_dword v92, v[88:89], off
    v_lshl_add_u64 v[88:89], v[88:89], 0, v[90:91]
    v_mfma_f32_16x16x32_bf16 v[208:211], v[44:47], v[80:83], v[208:211]
    v_mfma_f32_16x16x32_bf16 v[248:251], v[44:47], v[84:87], v[248:251]
    ds_read_b64_tr_b16 v[44:45], v29 offset:96
    ds_read_b64_tr_b16 v[46:47], v29 offset:1888
    v_mfma_f32_16x16x32_bf16 v[132:135], v[48:51], v[72:75], v[132:135]
    s_add_u32 m0, s20, 34816
    s_nop 0
    global_load_lds_dwordx4 v12, s[18:19]
    v_mfma_f32_16x16x32_bf16 v[172:175], v[48:51], v[76:79], v[172:175]
    s_add_u32 m0, s21, 44032
    s_nop 0
    global_load_lds_dwordx4 v[20:21], off
    v_lshl_add_u64 v[20:21], v[20:21], 0, s[28:29]
    v_mfma_f32_16x16x32_bf16 v[212:215], v[48:51], v[80:83], v[212:215]
    v_mfma_f32_16x16x32_bf16 v[252:255], v[48:51], v[84:87], v[252:255]
    ds_read_b64_tr_b16 v[48:49], v29 offset:224
    ds_read_b64_tr_b16 v[50:51], v29 offset:2016
    s_waitcnt lgkmcnt(8)
    v_mfma_f32_16x16x32_bf16 v[96:99], v[32:35], v[56:59], v[96:99]
    s_add_u32 m0, s20, 35840
    s_nop 0
    global_load_lds_dwordx4 v13, s[18:19]
    s_add_u32 s18, s18, 128
    s_addc_u32 s19, s19, 0
    v_mfma_f32_16x16x32_bf16 v[136:139], v[32:35], v[60:63], v[136:139]
    s_add_u32 m0, s21, 45056
    s_nop 0
    global_load_lds_dwordx4 v[22:23], off
    v_lshl_add_u64 v[22:23], v[22:23], 0, s[30:31]
    v_mfma_f32_16x16x32_bf16 v[176:179], v[32:35], v[64:67], v[176:179]
    v_mfma_f32_16x16x32_bf16 v[216:219], v[32:35], v[68:71], v[216:219]
    ds_read_b64_tr_b16 v[32:33], v28 offset:256
    ds_read_b64_tr_b16 v[34:35], v28 offset:2048
    s_waitcnt lgkmcnt(8)
    v_mfma_f32_16x16x32_bf16 v[100:103], v[36:39], v[56:59], v[100:103]
    s_add_u32 m0, s21, 61440
    s_nop 0
    global_load_lds_dwordx4 v[2:3], off
    v_lshl_add_u64 v[2:3], v[2:3], 0, s[78:79]
    v_mfma_f32_16x16x32_bf16 v[140:143], v[36:39], v[60:63], v[140:143]
    s_add_u32 m0, s20, 49152
    s_nop 0
    global_load_lds_dwordx4 v10, s[76:77]
    v_mfma_f32_16x16x32_bf16 v[180:183], v[36:39], v[64:67], v[180:183]
    v_mfma_f32_16x16x32_bf16 v[220:223], v[36:39], v[68:71], v[220:223]
    ds_read_b64_tr_b16 v[36:37], v29 offset:288
    ds_read_b64_tr_b16 v[38:39], v29 offset:2080
    ds_read_b128 v[72:75], v25 offset:0
    s_waitcnt lgkmcnt(9)
    v_mfma_f32_16x16x32_bf16 v[104:107], v[40:43], v[56:59], v[104:107]
    s_add_u32 m0, s21, 62464
    s_nop 0
    global_load_lds_dwordx4 v[4:5], off
    v_lshl_add_u64 v[4:5], v[4:5], 0, s[78:79]
    v_mfma_f32_16x16x32_bf16 v[144:147], v[40:43], v[60:63], v[144:147]
    s_add_u32 m0, s20, 50176
    s_nop 0
    global_load_lds_dwordx4 v11, s[76:77]
    v_mfma_f32_16x16x32_bf16 v[184:187], v[40:43], v[64:67], v[184:187]
    v_mfma_f32_16x16x32_bf16 v[224:227], v[40:43], v[68:71], v[224:227]
    ds_read_b64_tr_b16 v[40:41], v28 offset:320
    ds_read_b64_tr_b16 v[42:43], v28 offset:2112
    ds_read_b128 v[76:79], v25 offset:2048
    s_waitcnt lgkmcnt(10)
    v_mfma_f32_16x16x32_bf16 v[108:111], v[44:47], v[56:59], v[108:111]
    s_add_u32 m0, s21, 63488
    s_nop 0
    global_load_lds_dwordx4 v[6:7], off
    v_lshl_add_u64 v[6:7], v[6:7], 0, s[78:79]
    v_mfma_f32_16x16x32_bf16 v[148:151], v[44:47], v[60:63], v[148:151]
    s_add_u32 m0, s20, 51200
    s_nop 0
    global_load_lds_dwordx4 v12, s[76:77]
    v_mfma_f32_16x16x32_bf16 v[188:191], v[44:47], v[64:67], v[188:191]
    v_mfma_f32_16x16x32_bf16 v[228:231], v[44:47], v[68:71], v[228:231]
    ds_read_b64_tr_b16 v[44:45], v26 offset:0
    ds_read_b64_tr_b16 v[46:47], v26 offset:768
    ds_read_b128 v[80:83], v25 offset:4096
    s_waitcnt lgkmcnt(11)
    v_mfma_f32_16x16x32_bf16 v[112:115], v[48:51], v[56:59], v[112:115]
    s_add_u32 m0, s21, 64512
    s_nop 0
    global_load_lds_dwordx4 v[8:9], off
    v_lshl_add_u64 v[8:9], v[8:9], 0, s[78:79]
    v_mfma_f32_16x16x32_bf16 v[152:155], v[48:51], v[60:63], v[152:155]
    s_add_u32 m0, s20, 52224
    s_nop 0
    global_load_lds_dwordx4 v13, s[76:77]
    s_add_u32 s76, s76, 128
    s_addc_u32 s77, s77, 0
    v_mfma_f32_16x16x32_bf16 v[192:195], v[48:51], v[64:67], v[192:195]
    v_mfma_f32_16x16x32_bf16 v[232:235], v[48:51], v[68:71], v[232:235]
    ds_read_b64_tr_b16 v[48:49], v27 offset:32
    ds_read_b64_tr_b16 v[50:51], v27 offset:800
    ds_read_b128 v[84:87], v25 offset:6144
    s_waitcnt lgkmcnt(12)
    v_mfma_f32_16x16x32_bf16 v[116:119], v[32:35], v[56:59], v[116:119]
    s_add_u32 m0, s21, 65536
    s_nop 0
    global_load_lds_dwordx4 v[30:31], off
    v_lshl_add_u64 v[30:31], v[30:31], 0, s[78:79]
    v_mfma_f32_16x16x32_bf16 v[156:159], v[32:35], v[60:63], v[156:159]
    v_mfma_f32_16x16x32_bf16 v[196:199], v[32:35], v[64:67], v[196:199]
    v_mfma_f32_16x16x32_bf16 v[236:239], v[32:35], v[68:71], v[236:239]
    ds_read_b64_tr_b16 v[32:33], v28 offset:14336
    ds_read_b64_tr_b16 v[34:35], v28 offset:16128
    s_waitcnt lgkmcnt(12)
    v_mfma_f32_16x16x32_bf16 v[120:123], v[36:39], v[56:59], v[120:123]
    v_mfma_f32_16x16x32_bf16 v[160:163], v[36:39], v[60:63], v[160:163]
    v_mfma_f32_16x16x32_bf16 v[200:203], v[36:39], v[64:67], v[200:203]
    v_mfma_f32_16x16x32_bf16 v[240:243], v[36:39], v[68:71], v[240:243]
    ds_read_b64_tr_b16 v[36:37], v29 offset:14368
    ds_read_b64_tr_b16 v[38:39], v29 offset:16160
    s_waitcnt lgkmcnt(11)
    v_mfma_f32_16x16x32_bf16 v[124:127], v[40:43], v[56:59], v[124:127]
    v_mfma_f32_16x16x32_bf16 v[164:167], v[40:43], v[60:63], v[164:167]
    v_mfma_f32_16x16x32_bf16 v[204:207], v[40:43], v[64:67], v[204:207]
    v_mfma_f32_16x16x32_bf16 v[244:247], v[40:43], v[68:71], v[244:247]
    ds_read_b64_tr_b16 v[40:41], v28 offset:14400
    ds_read_b64_tr_b16 v[42:43], v28 offset:16192
    s_waitcnt lgkmcnt(10)
    v_mfma_f32_16x16x32_bf16 v[128:131], v[44:47], v[56:59], v[128:131]
    v_mfma_f32_16x16x32_bf16 v[168:171], v[44:47], v[60:63], v[168:171]
    v_mfma_f32_16x16x32_bf16 v[208:211], v[44:47], v[64:67], v[208:211]
    v_mfma_f32_16x16x32_bf16 v[248:251], v[44:47], v[68:71], v[248:251]
    ds_read_b64_tr_b16 v[44:45], v29 offset:14432
    ds_read_b64_tr_b16 v[46:47], v29 offset:16224
    s_waitcnt lgkmcnt(9)
    v_mfma_f32_16x16x32_bf16 v[132:135], v[48:51], v[56:59], v[132:135]
    v_mfma_f32_16x16x32_bf16 v[172:175], v[48:51], v[60:63], v[172:175]
    v_mfma_f32_16x16x32_bf16 v[212:215], v[48:51], v[64:67], v[212:215]
    v_mfma_f32_16x16x32_bf16 v[252:255], v[48:51], v[68:71], v[252:255]
    ds_read_b64_tr_b16 v[48:49], v29 offset:14560
    ds_read_b64_tr_b16 v[50:51], v29 offset:16352
    s_waitcnt lgkmcnt(8)
    v_mfma_f32_16x16x32_bf16 v[96:99], v[32:35], v[72:75], v[96:99]
    v_mfma_f32_16x16x32_bf16 v[136:139], v[32:35], v[76:79], v[136:139]
    v_mfma_f32_16x16x32_bf16 v[176:179], v[32:35], v[80:83], v[176:179]
    v_mfma_f32_16x16x32_bf16 v[216:219], v[32:35], v[84:87], v[216:219]
    ds_read_b64_tr_b16 v[32:33], v28 offset:14592
    ds_read_b64_tr_b16 v[34:35], v28 offset:16384
    s_waitcnt lgkmcnt(8)
    v_mfma_f32_16x16x32_bf16 v[100:103], v[36:39], v[72:75], v[100:103]
    v_mfma_f32_16x16x32_bf16 v[140:143], v[36:39], v[76:79], v[140:143]
    v_mfma_f32_16x16x32_bf16 v[180:183], v[36:39], v[80:83], v[180:183]
    v_mfma_f32_16x16x32_bf16 v[220:223], v[36:39], v[84:87], v[220:223]
    ds_read_b64_tr_b16 v[36:37], v29 offset:14624
    ds_read_b64_tr_b16 v[38:39], v29 offset:16416
    s_waitcnt lgkmcnt(8)
    v_mfma_f32_16x16x32_bf16 v[104:107], v[40:43], v[72:75], v[104:107]
    v_mfma_f32_16x16x32_bf16 v[144:147], v[40:43], v[76:79], v[144:147]
    v_mfma_f32_16x16x32_bf16 v[184:187], v[40:43], v[80:83], v[184:187]
    v_mfma_f32_16x16x32_bf16 v[224:227], v[40:43], v[84:87], v[224:227]
    ds_read_b64_tr_b16 v[40:41], v28 offset:14656
    ds_read_b64_tr_b16 v[42:43], v28 offset:16448
    s_waitcnt lgkmcnt(8)
    v_mfma_f32_16x16x32_bf16 v[108:111], v[44:47], v[72:75], v[108:111]
    v_mfma_f32_16x16x32_bf16 v[148:151], v[44:47], v[76:79], v[148:151]
    v_mfma_f32_16x16x32_bf16 v[188:191], v[44:47], v[80:83], v[188:191]
    v_mfma_f32_16x16x32_bf16 v[228:231], v[44:47], v[84:87], v[228:231]
    ds_read_b64_tr_b16 v[44:45], v26 offset:6144
    ds_read_b64_tr_b16 v[46:47], v26 offset:6912
    s_waitcnt lgkmcnt(8)
    v_mfma_f32_16x16x32_bf16 v[112:115], v[48:51], v[72:75], v[112:115]
    v_mfma_f32_16x16x32_bf16 v[152:155], v[48:51], v[76:79], v[152:155]
    v_mfma_f32_16x16x32_bf16 v[192:195], v[48:51], v[80:83], v[192:195]
    v_mfma_f32_16x16x32_bf16 v[232:235], v[48:51], v[84:87], v[232:235]
    ds_read_b64_tr_b16 v[48:49], v27 offset:6176
    ds_read_b64_tr_b16 v[50:51], v27 offset:6944
    s_waitcnt lgkmcnt(8)
    v_mfma_f32_16x16x32_bf16 v[116:119], v[32:35], v[72:75], v[116:119]
    v_mfma_f32_16x16x32_bf16 v[156:159], v[32:35], v[76:79], v[156:159]
    v_mfma_f32_16x16x32_bf16 v[196:199], v[32:35], v[80:83], v[196:199]
    v_mfma_f32_16x16x32_bf16 v[236:239], v[32:35], v[84:87], v[236:239]
    s_waitcnt lgkmcnt(0) vmcnt(0)
    s_barrier
    ds_read_b128 v[56:59], v24 offset:32768
    ds_read_b128 v[60:63], v24 offset:34816
    ds_read_b128 v[64:67], v24 offset:36864
    ds_read_b128 v[68:71], v24 offset:38912
    ds_read_b64_tr_b16 v[32:33], v28 offset:40960
    ds_read_b64_tr_b16 v[34:35], v28 offset:42752
    v_mfma_f32_16x16x32_bf16 v[120:123], v[36:39], v[72:75], v[120:123]
    s_add_u32 m0, s21, 0
    s_nop 0
    global_load_lds_dwordx4 v[14:15], off
    v_lshl_add_u64 v[14:15], v[14:15], 0, s[22:23]
    v_mfma_f32_16x16x32_bf16 v[160:163], v[36:39], v[76:79], v[160:163]
    s_add_u32 m0, s20, 0
    s_nop 0
    global_load_lds_dwordx4 v10, s[18:19]
    v_mfma_f32_16x16x32_bf16 v[200:203], v[36:39], v[80:83], v[200:203]
    v_mfma_f32_16x16x32_bf16 v[240:243], v[36:39], v[84:87], v[240:243]
    ds_read_b64_tr_b16 v[36:37], v29 offset:40992
    ds_read_b64_tr_b16 v[38:39], v29 offset:42784
    v_mfma_f32_16x16x32_bf16 v[124:127], v[40:43], v[72:75], v[124:127]
    s_add_u32 m0, s21, 1024
    s_nop 0
    global_load_lds_dwordx4 v[16:17], off
    v_lshl_add_u64 v[16:17], v[16:17], 0, s[24:25]
    v_mfma_f32_16x16x32_bf16 v[164:167], v[40:43], v[76:79], v[164:167]
    s_add_u32 m0, s20, 1024
    s_nop 0
    global_load_lds_dwordx4 v11, s[18:19]
    v_mfma_f32_16x16x32_bf16 v[204:207], v[40:43], v[80:83], v[204:207]
    v_mfma_f32_16x16x32_bf16 v[244:247], v[40:43], v[84:87], v[244:247]
    ds_read_b64_tr_b16 v[40:41], v28 offset:41024
    ds_read_b64_tr_b16 v[42:43], v28 offset:42816
    v_mfma_f32_16x16x32_bf16 v[128:131], v[44:47], v[72:75], v[128:131]
    s_add_u32 m0, s21, 2048
    s_nop 0
    global_load_lds_dwordx4 v[18:19], off
    v_lshl_add_u64 v[18:19], v[18:19], 0, s[26:27]
    v_mfma_f32_16x16x32_bf16 v[168:171], v[44:47], v[76:79], v[168:171]
    s_cmp_lt_u32 s32, 2
    s_cbranch_scc1 L1_pf0_0
    global_load_dword v92, v[88:89], off
    v_lshl_add_u64 v[88:89], v[88:89], 0, v[90:91]
L1_pf0_0:
    v_mfma_f32_16x16x32_bf16 v[208:211], v[44:47], v[80:83], v[208:211]
    v_mfma_f32_16x16x32_bf16 v[248:251], v[44:47], v[84:87], v[248:251]
    ds_read_b64_tr_b16 v[44:45], v29 offset:41056
    ds_read_b64_tr_b16 v[46:47], v29 offset:42848
    v_mfma_f32_16x16x32_bf16 v[132:135], v[48:51], v[72:75], v[132:135]
    s_add_u32 m0, s20, 2048
    s_nop 0
    global_load_lds_dwordx4 v12, s[18:19]
    v_mfma_f32_16x16x32_bf16 v[172:175], v[48:51], v[76:79], v[172:175]
    s_add_u32 m0, s21, 3072
    s_nop 0
    global_load_lds_dwordx4 v[20:21], off
    v_lshl_add_u64 v[20:21], v[20:21], 0, s[28:29]
    v_mfma_f32_16x16x32_bf16 v[212:215], v[48:51], v[80:83], v[212:215]
    v_mfma_f32_16x16x32_bf16 v[252:255], v[48:51], v[84:87], v[252:255]
    s_sub_u32 s32, s32, 1
    s_cmp_lg_u32 s32, 0
    s_cbranch_scc1 L1_loop0
    s_mul_i32 s33, s17, 3584
    v_lshlrev_b32 v1, 6, v0
    v_min_u32 v52, 3520, v1
    v_add_u32 v52, s33, v52
    global_load_dword v92, v52, s[58:59]
    s_lshl_b32 s33, s17, 10
    v_min_u32 v52, 960, v1
    v_add_u32 v52, s33, v52
    global_load_dword v92, v52, s[56:57]
    ds_read_b64_tr_b16 v[48:49], v29 offset:41184
    ds_read_b64_tr_b16 v[50:51], v29 offset:42976
    s_waitcnt lgkmcnt(8)
    v_mfma_f32_16x16x32_bf16 v[96:99], v[32:35], v[56:59], v[96:99]
    s_add_u32 m0, s20, 3072
    s_nop 0
    global_load_lds_dwordx4 v13, s[18:19]
    s_add_u32 s18, s18, 128
    s_addc_u32 s19, s19, 0
    v_mfma_f32_16x16x32_bf16 v[136:139], v[32:35], v[60:63], v[136:139]
    s_add_u32 m0, s21, 4096
    s_nop 0
    global_load_lds_dwordx4 v[22:23], off
    v_lshl_add_u64 v[22:23], v[22:23], 0, s[30:31]
    v_mfma_f32_16x16x32_bf16 v[176:179], v[32:35], v[64:67], v[176:179]
    v_mfma_f32_16x16x32_bf16 v[216:219], v[32:35], v[68:71], v[216:219]
    ds_read_b64_tr_b16 v[32:33], v28 offset:41216
    ds_read_b64_tr_b16 v[34:35], v28 offset:43008
    s_waitcnt lgkmcnt(8)
    v_mfma_f32_16x16x32_bf16 v[100:103], v[36:39], v[56:59], v[100:103]
    s_add_u32 m0, s21, 20480
    s_nop 0
    global_load_lds_dwordx4 v[2:3], off
    v_lshl_add_u64 v[2:3], v[2:3], 0, s[78:79]
    v_mfma_f32_16x16x32_bf16 v[140:143], v[36:39], v[60:63], v[140:143]
    s_add_u32 m0, s20, 16384
    s_nop 0
    global_load_lds_dwordx4 v10, s[76:77]
    v_mfma_f32_16x16x32_bf16 v[180:183], v[36:39], v[64:67], v[180:183]
    v_mfma_f32_16x16x32_bf16 v[220:223], v[36:39], v[68:71], v[220:223]
    ds_read_b64_tr_b16 v[36:37], v29 offset:41248
    ds_read_b64_tr_b16 v[38:39], v29 offset:43040
    ds_read_b128 v[72:75], v25 offset:32768
    s_waitcnt lgkmcnt(9)
    v_mfma_f32_16x16x32_bf16 v[104:107], v[40:43], v[56:59], v[104:107]
    s_add_u32 m0, s21, 21504
    s_nop 0
    global_load_lds_dwordx4 v[4:5], off
    v_lshl_add_u64 v[4:5], v[4:5], 0, s[78:79]
    v_mfma_f32_16x16x32_bf16 v[144:147], v[40:43], v[60:63], v[144:147]
    s_add_u32 m0, s20, 17408
    s_nop 0
    global_load_lds_dwordx4 v11, s[76:77]
    v_mfma_f32_16x16x32_bf16 v[184:187], v[40:43], v[64:67], v[184:187]
    v_mfma_f32_16x16x32_bf16 v[224:227], v[40:43], v[68:71], v[224:227]
    ds_read_b64_tr_b16 v[40:41], v28 offset:41280
    ds_read_b64_tr_b16 v[42:43], v28 offset:43072
    ds_read_b128 v[76:79], v25 offset:34816
    s_waitcnt lgkmcnt(10)
    v_mfma_f32_16x16x32_bf16 v[108:111], v[44:47], v[56:59], v[108:111]
    s_add_u32 m0, s21, 22528
    s_nop 0
    global_load_lds_dwordx4 v[6:7], off
    v_lshl_add_u64 v[6:7], v[6:7], 0, s[78:79]
    v_mfma_f32_16x16x32_bf16 v[148:151], v[44:47], v[60:63], v[148:151]
    s_add_u32 m0, s20, 18432
    s_nop 0
    global_load_lds_dwordx4 v12, s[76:77]
    v_mfma_f32_16x16x32_bf16 v[188:191], v[44:47], v[64:67], v[188:191]
    v_mfma_f32_16x16x32_bf16 v[228:231], v[44:47], v[68:71], v[228:231]
    ds_read_b64_tr_b16 v[44:45], v26 offset:40960
    ds_read_b64_tr_b16 v[46:47], v26 offset:41728
    ds_read_b128 v[80:83], v25 offset:36864
    s_waitcnt lgkmcnt(11)
    v_mfma_f32_16x16x32_bf16 v[112:115], v[48:51], v[56:59], v[112:115]
    s_add_u32 m0, s21, 23552
    s_nop 0
    global_load_lds_dwordx4 v[8:9], off
    v_lshl_add_u64 v[8:9], v[8:9], 0, s[78:79]
    v_mfma_f32_16x16x32_bf16 v[152:155], v[48:51], v[60:63], v[152:155]
    s_add_u32 m0, s20, 19456
    s_nop 0
    global_load_lds_dwordx4 v13, s[76:77]
    s_add_u32 s76, s76, 128
    s_addc_u32 s77, s77, 0
    v_mfma_f32_16x16x32_bf16 v[192:195], v[48:51], v[64:67], v[192:195]
    v_mfma_f32_16x16x32_bf16 v[232:235], v[48:51], v[68:71], v[232:235]
    ds_read_b64_tr_b16 v[48:49], v27 offset:40992
    ds_read_b64_tr_b16 v[50:51], v27 offset:41760
    ds_read_b128 v[84:87], v25 offset:38912
    s_waitcnt lgkmcnt(12)
    v_mfma_f32_16x16x32_bf16 v[116:119], v[32:35], v[56:59], v[116:119]
    s_add_u32 m0, s21, 24576
    s_nop 0
    global_load_lds_dwordx4 v[30:31], off
    v_lshl_add_u64 v[30:31], v[30:31], 0, s[78:79]
    v_mfma_f32_16x16x32_bf16 v[156:159], v[32:35], v[60:63], v[156:159]
    v_mfma_f32_16x16x32_bf16 v[196:199], v[32:35], v[64:67], v[196:199]
    v_mfma_f32_16x16x32_bf16 v[236:239], v[32:35], v[68:71], v[236:239]
    ds_read_b64_tr_b16 v[32:33], v28 offset:55296
    ds_read_b64_tr_b16 v[34:35], v28 offset:57088
    s_waitcnt lgkmcnt(12)
    v_mfma_f32_16x16x32_bf16 v[120:123], v[36:39], v[56:59], v[120:123]
    v_mfma_f32_16x16x32_bf16 v[160:163], v[36:39], v[60:63], v[160:163]
    v_mfma_f32_16x16x32_bf16 v[200:203], v[36:39], v[64:67], v[200:203]
    v_mfma_f32_16x16x32_bf16 v[240:243], v[36:39], v[68:71], v[240:243]
    ds_read_b64_tr_b16 v[36:37], v29 offset:55328
    ds_read_b64_tr_b16 v[38:39], v29 offset:57120
    s_waitcnt lgkmcnt(11)
    v_mfma_f32_16x16x32_bf16 v[124:127], v[40:43], v[56:59], v[124:127]
    v_mfma_f32_16x16x32_bf16 v[164:167], v[40:43], v[60:63], v[164:167]
    v_mfma_f32_16x16x32_bf16 v[204:207], v[40:43], v[64:67], v[204:207]
    v_mfma_f32_16x16x32_bf16 v[244:247], v[40:43], v[68:71], v[244:247]
    ds_read_b64_tr_b16 v[40:41], v28 offset:55360
    ds_read_b64_tr_b16 v[42:43], v28 offset:57152
    s_waitcnt lgkmcnt(10)
    v_mfma_f32_16x16x32_bf16 v[128:131], v[44:47], v[56:59], v[128:131]
    v_mfma_f32_16x16x32_bf16 v[168:171], v[44:47], v[60:63], v[168:171]
    v_mfma_f32_16x16x32_bf16 v[208:211], v[44:47], v[64:67], v[208:211]
    v_mfma_f32_16x16x32_bf16 v[248:251], v[44:47], v[68:71], v[248:251]
    ds_read_b64_tr_b16 v[44:45], v29 offset:55392
    ds_read_b64_tr_b16 v[46:47], v29 offset:57184
    s_waitcnt lgkmcnt(9)
    v_mfma_f32_16x16x32_bf16 v[132:135], v[48:51], v[56:59], v[132:135]
    v_mfma_f32_16x16x32_bf16 v[172:175], v[48:51], v[60:63], v[172:175]
    v_mfma_f32_16x16x32_bf16 v[212:215], v[48:51], v[64:67], v[212:215]
    v_mfma_f32_16x16x32_bf16 v[252:255], v[48:51], v[68:71], v[252:255]
    ds_read_b64_tr_b16 v[48:49], v29 offset:55520
    ds_read_b64_tr_b16 v[50:51], v29 offset:57312
    s_waitcnt lgkmcnt(8)
    v_mfma_f32_16x16x32_bf16 v[96:99], v[32:35], v[72:75], v[96:99]
    v_mfma_f32_16x16x32_bf16 v[136:139], v[32:35], v[76:79], v[136:139]
    v_mfma_f32_16x16x32_bf16 v[176:179], v[32:35], v[80:83], v[176:179]
    v_mfma_f32_16x16x32_bf16 v[216:219], v[32:35], v[84:87], v[216:219]
    ds_read_b64_tr_b16 v[32:33], v28 offset:55552
    ds_read_b64_tr_b16 v[34:35], v28 offset:57344
    s_waitcnt lgkmcnt(8)
    v_mfma_f32_16x16x32_bf16 v[100:103], v[36:39], v[72:75], v[100:103]
    v_mfma_f32_16x16x32_bf16 v[140:143], v[36:39], v[76:79], v[140:143]
    v_mfma_f32_16x16x32_bf16 v[180:183], v[36:39], v[80:83], v[180:183]
    v_mfma_f32_16x16x32_bf16 v[220:223], v[36:39], v[84:87], v[220:223]
    ds_read_b64_tr_b16 v[36:37], v29 offset:55584
    ds_read_b64_tr_b16 v[38:39], v29 offset:57376
    s_waitcnt lgkmcnt(8)
    v_mfma_f32_16x16x32_bf16 v[104:107], v[40:43], v[72:75], v[104:107]
    v_mfma_f32_16x16x32_bf16 v[144:147], v[40:43], v[76:79], v[144:147]
    v_mfma_f32_16x16x32_bf16 v[184:187], v[40:43], v[80:83], v[184:187]
    v_mfma_f32_16x16x32_bf16 v[224:227], v[40:43], v[84:87], v[224:227]
    ds_read_b64_tr_b16 v[40:41], v28 offset:55616
    ds_read_b64_tr_b16 v[42:43], v28 offset:57408
    s_waitcnt lgkmcnt(8)
    v_mfma_f32_16x16x32_bf16 v[108:111], v[44:47], v[72:75], v[108:111]
    v_mfma_f32_16x16x32_bf16 v[148:151], v[44:47], v[76:79], v[148:151]
    v_mfma_f32_16x16x32_bf16 v[188:191], v[44:47], v[80:83], v[188:191]
    v_mfma_f32_16x16x32_bf16 v[228:231], v[44:47], v[84:87], v[228:231]
    ds_read_b64_tr_b16 v[44:45], v26 offset:47104
    ds_read_b64_tr_b16 v[46:47], v26 offset:47872
    s_waitcnt lgkmcnt(8)
    v_mfma_f32_16x16x32_bf16 v[112:115], v[48:51], v[72:75], v[112:115]
    v_mfma_f32_16x16x32_bf16 v[152:155], v[48:51], v[76:79], v[152:155]
    v_mfma_f32_16x16x32_bf16 v[192:195], v[48:51], v[80:83], v[192:195]
    v_mfma_f32_16x16x32_bf16 v[232:235], v[48:51], v[84:87], v[232:235]
    ds_read_b64_tr_b16 v[48:49], v27 offset:47136
    ds_read_b64_tr_b16 v[50:51], v27 offset:47904
    s_waitcnt lgkmcnt(8)
    v_mfma_f32_16x16x32_bf16 v[116:119], v[32:35], v[72:75], v[116:119]
    v_mfma_f32_16x16x32_bf16 v[156:159], v[32:35], v[76:79], v[156:159]
    v_mfma_f32_16x16x32_bf16 v[196:199], v[32:35], v[80:83], v[196:199]
    v_mfma_f32_16x16x32_bf16 v[236:239], v[32:35], v[84:87], v[236:239]
    s_waitcnt lgkmcnt(0) vmcnt(0)
    s_barrier
    ds_read_b128 v[56:59], v24 offset:0
    ds_read_b128 v[60:63], v24 offset:2048
    ds_read_b128 v[64:67], v24 offset:4096
    ds_read_b128 v[68:71], v24 offset:6144
    ds_read_b64_tr_b16 v[32:33], v28 offset:0
    ds_read_b64_tr_b16 v[34:35], v28 offset:1792
    v_mfma_f32_16x16x32_bf16 v[120:123], v[36:39], v[72:75], v[120:123]
    s_add_u32 m0, s21, 40960
    s_nop 0
    global_load_lds_dwordx4 v[14:15], off
    v_lshl_add_u64 v[14:15], v[14:15], 0, s[22:23]
    v_mfma_f32_16x16x32_bf16 v[160:163], v[36:39], v[76:79], v[160:163]
    s_add_u32 m0, s20, 32768
    s_nop 0
    global_load_lds_dwordx4 v10, s[18:19]
    v_mfma_f32_16x16x32_bf16 v[200:203], v[36:39], v[80:83], v[200:203]
    v_mfma_f32_16x16x32_bf16 v[240:243], v[36:39], v[84:87], v[240:243]
    ds_read_b64_tr_b16 v[36:37], v29 offset:32
    ds_read_b64_tr_b16 v[38:39], v29 offset:1824
    v_mfma_f32_16x16x32_bf16 v[124:127], v[40:43], v[72:75], v[124:127]
    s_add_u32 m0, s21, 41984
    s_nop 0
    global_load_lds_dwordx4 v[16:17], off
    v_lshl_add_u64 v[16:17], v[16:17], 0, s[24:25]
    v_mfma_f32_16x16x32_bf16 v[164:167], v[40:43], v[76:79], v[164:167]
    s_add_u32 m0, s20, 33792
    s_nop 0
    global_load_lds_dwordx4 v11, s[18:19]
    v_mfma_f32_16x16x32_bf16 v[204:207], v[40:43], v[80:83], v[204:207]
    v_mfma_f32_16x16x32_bf16 v[244:247], v[40:43], v[84:87], v[244:247]
    ds_read_b64_tr_b16 v[40:41], v28 offset:64
    ds_read_b64_tr_b16 v[42:43], v28 offset:1856
    v_mfma_f32_16x16x32_bf16 v[128:131], v[44:47], v[72:75], v[128:131]
    s_add_u32 m0, s21, 43008
    s_nop 0
    global_load_lds_dwordx4 v[18:19], off
    v_lshl_add_u64 v[18:19], v[18:19], 0, s[26:27]
    v_mfma_f32_16x16x32_bf16 v[168:171], v[44:47], v[76:79], v[168:171]
    s_add_u32 m0, s20, 34816
    s_nop 0
    global_load_lds_dwordx4 v12, s[18:19]
    v_mfma_f32_16x16x32_bf16 v[208:211], v[44:47], v[80:83], v[208:211]
    v_mfma_f32_16x16x32_bf16 v[248:251], v[44:47], v[84:87], v[248:251]
    ds_read_b64_tr_b16 v[44:45], v29 offset:96
    ds_read_b64_tr_b16 v[46:47], v29 offset:1888
    v_mfma_f32_16x16x32_bf16 v[132:135], v[48:51], v[72:75], v[132:135]
    s_add_u32 m0, s21, 44032
    s_nop 0
    global_load_lds_dwordx4 v[20:21], off
    v_lshl_add_u64 v[20:21], v[20:21], 0, s[28:29]
    v_mfma_f32_16x16x32_bf16 v[172:175], v[48:51], v[76:79], v[172:175]
    s_add_u32 m0, s20, 35840
    s_nop 0
    global_load_lds_dwordx4 v13, s[18:19]
    s_add_u32 s18, s18, 128
    s_addc_u32 s19, s19, 0
    v_mfma_f32_16x16x32_bf16 v[212:215], v[48:51], v[80:83], v[212:215]
    v_mfma_f32_16x16x32_bf16 v[252:255], v[48:51], v[84:87], v[252:255]
    ds_read_b64_tr_b16 v[48:49], v29 offset:224
    ds_read_b64_tr_b16 v[50:51], v29 offset:2016
    s_waitcnt lgkmcnt(8)
    v_mfma_f32_16x16x32_bf16 v[96:99], v[32:35], v[56:59], v[96:99]
    s_add_u32 m0, s21, 45056
    s_nop 0
    global_load_lds_dwordx4 v[22:23], off
    v_lshl_add_u64 v[22:23], v[22:23], 0, s[30:31]
    v_mfma_f32_16x16x32_bf16 v[136:139], v[32:35], v[60:63], v[136:139]
    s_add_u32 m0, s21, 61440
    s_nop 0
    global_load_lds_dwordx4 v[2:3], off
    v_lshl_add_u64 v[2:3], v[2:3], 0, s[78:79]
    v_mfma_f32_16x16x32_bf16 v[176:179], v[32:35], v[64:67], v[176:179]
    v_mfma_f32_16x16x32_bf16 v[216:219], v[32:35], v[68:71], v[216:219]
    ds_read_b64_tr_b16 v[32:33], v28 offset:256
    ds_read_b64_tr_b16 v[34:35], v28 offset:2048
    s_waitcnt lgkmcnt(8)
    v_mfma_f32_16x16x32_bf16 v[100:103], v[36:39], v[56:59], v[100:103]
    s_add_u32 m0, s20, 49152
    s_nop 0
    global_load_lds_dwordx4 v10, s[76:77]
    v_mfma_f32_16x16x32_bf16 v[140:143], v[36:39], v[60:63], v[140:143]
    s_add_u32 m0, s21, 62464
    s_nop 0
    global_load_lds_dwordx4 v[4:5], off
    v_lshl_add_u64 v[4:5], v[4:5], 0, s[78:79]
    v_mfma_f32_16x16x32_bf16 v[180:183], v[36:39], v[64:67], v[180:183]
    v_mfma_f32_16x16x32_bf16 v[220:223], v[36:39], v[68:71], v[220:223]
    ds_read_b64_tr_b16 v[36:37], v29 offset:288
    ds_read_b64_tr_b16 v[38:39], v29 offset:2080
    ds_read_b128 v[72:75], v25 offset:0
    s_waitcnt lgkmcnt(9)
    v_mfma_f32_16x16x32_bf16 v[104:107], v[40:43], v[56:59], v[104:107]
    s_add_u32 m0, s20, 50176
    s_nop 0
    global_load_lds_dwordx4 v11, s[76:77]
    v_mfma_f32_16x16x32_bf16 v[144:147], v[40:43], v[60:63], v[144:147]
    s_add_u32 m0, s21, 63488
    s_nop 0
    global_load_lds_dwordx4 v[6:7], off
    v_lshl_add_u64 v[6:7], v[6:7], 0, s[78:79]
    v_mfma_f32_16x16x32_bf16 v[184:187], v[40:43], v[64:67], v[184:187]
    v_mfma_f32_16x16x32_bf16 v[224:227], v[40:43], v[68:71], v[224:227]
    ds_read_b64_tr_b16 v[40:41], v28 offset:320
    ds_read_b64_tr_b16 v[42:43], v28 offset:2112
    ds_read_b128 v[76:79], v25 offset:2048
    s_waitcnt lgkmcnt(10)
    v_mfma_f32_16x16x32_bf16 v[108:111], v[44:47], v[56:59], v[108:111]
    s_add_u32 m0, s20, 51200
    s_nop 0
    global_load_lds_dwordx4 v12, s[76:77]
    v_mfma_f32_16x16x32_bf16 v[148:151], v[44:47], v[60:63], v[148:151]
    s_add_u32 m0, s21, 64512
    s_nop 0
    global_load_lds_dwordx4 v[8:9], off
    v_lshl_add_u64 v[8:9], v[8:9], 0, s[78:79]
    v_mfma_f32_16x16x32_bf16 v[188:191], v[44:47], v[64:67], v[188:191]
    v_mfma_f32_16x16x32_bf16 v[228:231], v[44:47], v[68:71], v[228:231]
    ds_read_b64_tr_b16 v[44:45], v26 offset:0
    ds_read_b64_tr_b16 v[46:47], v26 offset:768
    ds_read_b128 v[80:83], v25 offset:4096
    s_waitcnt lgkmcnt(11)
    v_mfma_f32_16x16x32_bf16 v[112:115], v[48:51], v[56:59], v[112:115]
    s_add_u32 m0, s20, 52224
    s_nop 0
    global_load_lds_dwordx4 v13, s[76:77]
    s_add_u32 s76, s76, 128
    s_addc_u32 s77, s77, 0
    v_mfma_f32_16x16x32_bf16 v[152:155], v[48:51], v[60:63], v[152:155]
    s_add_u32 m0, s21, 65536
    s_nop 0
    global_load_lds_dwordx4 v[30:31], off
    v_lshl_add_u64 v[30:31], v[30:31], 0, s[78:79]
    v_mfma_f32_16x16x32_bf16 v[192:195], v[48:51], v[64:67], v[192:195]
    v_mfma_f32_16x16x32_bf16 v[232:235], v[48:51], v[68:71], v[232:235]
    ds_read_b64_tr_b16 v[48:49], v27 offset:32
    ds_read_b64_tr_b16 v[50:51], v27 offset:800
    ds_read_b128 v[84:87], v25 offset:6144
    s_waitcnt lgkmcnt(12)
    v_mfma_f32_16x16x32_bf16 v[116:119], v[32:35], v[56:59], v[116:119]
    v_mfma_f32_16x16x32_bf16 v[156:159], v[32:35], v[60:63], v[156:159]
    v_mfma_f32_16x16x32_bf16 v[196:199], v[32:35], v[64:67], v[196:199]
    v_mfma_f32_16x16x32_bf16 v[236:239], v[32:35], v[68:71], v[236:239]
    ds_read_b64_tr_b16 v[32:33], v28 offset:14336
    ds_read_b64_tr_b16 v[34:35], v28 offset:16128
    s_waitcnt lgkmcnt(12)
    v_mfma_f32_16x16x32_bf16 v[120:123], v[36:39], v[56:59], v[120:123]
    v_mfma_f32_16x16x32_bf16 v[160:163], v[36:39], v[60:63], v[160:163]
    v_mfma_f32_16x16x32_bf16 v[200:203], v[36:39], v[64:67], v[200:203]
    v_mfma_f32_16x16x32_bf16 v[240:243], v[36:39], v[68:71], v[240:243]
    ds_read_b64_tr_b16 v[36:37], v29 offset:14368
    ds_read_b64_tr_b16 v[38:39], v29 offset:16160
    s_waitcnt lgkmcnt(11)
    v_mfma_f32_16x16x32_bf16 v[124:127], v[40:43], v[56:59], v[124:127]
    v_mfma_f32_16x16x32_bf16 v[164:167], v[40:43], v[60:63], v[164:167]
    v_mfma_f32_16x16x32_bf16 v[204:207], v[40:43], v[64:67], v[204:207]
    v_mfma_f32_16x16x32_bf16 v[244:247], v[40:43], v[68:71], v[244:247]
    ds_read_b64_tr_b16 v[40:41], v28 offset:14400
    ds_read_b64_tr_b16 v[42:43], v28 offset:16192
    s_waitcnt lgkmcnt(10)
    v_mfma_f32_16x16x32_bf16 v[128:131], v[44:47], v[56:59], v[128:131]
    v_mfma_f32_16x16x32_bf16 v[168:171], v[44:47], v[60:63], v[168:171]
    v_mfma_f32_16x16x32_bf16 v[208:211], v[44:47], v[64:67], v[208:211]
    v_mfma_f32_16x16x32_bf16 v[248:251], v[44:47], v[68:71], v[248:251]
    ds_read_b64_tr_b16 v[44:45], v29 offset:14432
    ds_read_b64_tr_b16 v[46:47], v29 offset:16224
    s_waitcnt lgkmcnt(9)
    v_mfma_f32_16x16x32_bf16 v[132:135], v[48:51], v[56:59], v[132:135]
    v_mfma_f32_16x16x32_bf16 v[172:175], v[48:51], v[60:63], v[172:175]
    v_mfma_f32_16x16x32_bf16 v[212:215], v[48:51], v[64:67], v[212:215]
    v_mfma_f32_16x16x32_bf16 v[252:255], v[48:51], v[68:71], v[252:255]
    ds_read_b64_tr_b16 v[48:49], v29 offset:14560
    ds_read_b64_tr_b16 v[50:51], v29 offset:16352
    s_waitcnt lgkmcnt(8)
    v_mfma_f32_16x16x32_bf16 v[96:99], v[32:35], v[72:75], v[96:99]
    v_mfma_f32_16x16x32_bf16 v[136:139], v[32:35], v[76:79], v[136:139]
    v_mfma_f32_16x16x32_bf16 v[176:179], v[32:35], v[80:83], v[176:179]
    v_mfma_f32_16x16x32_bf16 v[216:219], v[32:35], v[84:87], v[216:219]
    ds_read_b64_tr_b16 v[32:33], v28 offset:14592
    ds_read_b64_tr_b16 v[34:35], v28 offset:16384
    s_waitcnt lgkmcnt(8)
    v_mfma_f32_16x16x32_bf16 v[100:103], v[36:39], v[72:75], v[100:103]
    v_mfma_f32_16x16x32_bf16 v[140:143], v[36:39], v[76:79], v[140:143]
    v_mfma_f32_16x16x32_bf16 v[180:183], v[36:39], v[80:83], v[180:183]
    v_mfma_f32_16x16x32_bf16 v[220:223], v[36:39], v[84:87], v[220:223]
    ds_read_b64_tr_b16 v[36:37], v29 offset:14624
    ds_read_b64_tr_b16 v[38:39], v29 offset:16416
    s_waitcnt lgkmcnt(8)
    v_mfma_f32_16x16x32_bf16 v[104:107], v[40:43], v[72:75], v[104:107]
    v_mfma_f32_16x16x32_bf16 v[144:147], v[40:43], v[76:79], v[144:147]
    v_mfma_f32_16x16x32_bf16 v[184:187], v[40:43], v[80:83], v[184:187]
    v_mfma_f32_16x16x32_bf16 v[224:227], v[40:43], v[84:87], v[224:227]
    ds_read_b64_tr_b16 v[40:41], v28 offset:14656
    ds_read_b64_tr_b16 v[42:43], v28 offset:16448
    s_waitcnt lgkmcnt(8)
    v_mfma_f32_16x16x32_bf16 v[108:111], v[44:47], v[72:75], v[108:111]
    v_mfma_f32_16x16x32_bf16 v[148:151], v[44:47], v[76:79], v[148:151]
    v_mfma_f32_16x16x32_bf16 v[188:191], v[44:47], v[80:83], v[188:191]
    v_mfma_f32_16x16x32_bf16 v[228:231], v[44:47], v[84:87], v[228:231]
    ds_read_b64_tr_b16 v[44:45], v26 offset:6144
    ds_read_b64_tr_b16 v[46:47], v26 offset:6912
    s_waitcnt lgkmcnt(8)
    v_mfma_f32_16x16x32_bf16 v[112:115], v[48:51], v[72:75], v[112:115]
    v_mfma_f32_16x16x32_bf16 v[152:155], v[48:51], v[76:79], v[152:155]
    v_mfma_f32_16x16x32_bf16 v[192:195], v[48:51], v[80:83], v[192:195]
    v_mfma_f32_16x16x32_bf16 v[232:235], v[48:51], v[84:87], v[232:235]
    ds_read_b64_tr_b16 v[48:49], v27 offset:6176
    ds_read_b64_tr_b16 v[50:51], v27 offset:6944
    s_waitcnt lgkmcnt(8)
    v_mfma_f32_16x16x32_bf16 v[116:119], v[32:35], v[72:75], v[116:119]
    v_mfma_f32_16x16x32_bf16 v[156:159], v[32:35], v[76:79], v[156:159]
    v_mfma_f32_16x16x32_bf16 v[196:199], v[32:35], v[80:83], v[196:199]
    v_mfma_f32_16x16x32_bf16 v[236:239], v[32:35], v[84:87], v[236:239]
    s_waitcnt lgkmcnt(0) vmcnt(0)
    s_barrier
    ds_read_b128 v[56:59], v24 offset:32768
    ds_read_b128 v[60:63], v24 offset:34816
    ds_read_b128 v[64:67], v24 offset:36864
    ds_read_b128 v[68:71], v24 offset:38912
    ds_read_b64_tr_b16 v[32:33], v28 offset:40960
    ds_read_b64_tr_b16 v[34:35], v28 offset:42752
    v_mfma_f32_16x16x32_bf16 v[120:123], v[36:39], v[72:75], v[120:123]
    v_mfma_f32_16x16x32_bf16 v[160:163], v[36:39], v[76:79], v[160:163]
    v_mfma_f32_16x16x32_bf16 v[200:203], v[36:39], v[80:83], v[200:203]
    v_mfma_f32_16x16x32_bf16 v[240:243], v[36:39], v[84:87], v[240:243]
    ds_read_b64_tr_b16 v[36:37], v29 offset:40992
    ds_read_b64_tr_b16 v[38:39], v29 offset:42784
    v_mfma_f32_16x16x32_bf16 v[124:127], v[40:43], v[72:75], v[124:127]
    v_mfma_f32_16x16x32_bf16 v[164:167], v[40:43], v[76:79], v[164:167]
    v_mfma_f32_16x16x32_bf16 v[204:207], v[40:43], v[80:83], v[204:207]
    v_mfma_f32_16x16x32_bf16 v[244:247], v[40:43], v[84:87], v[244:247]
    ds_read_b64_tr_b16 v[40:41], v28 offset:41024
    ds_read_b64_tr_b16 v[42:43], v28 offset:42816
    v_mfma_f32_16x16x32_bf16 v[128:131], v[44:47], v[72:75], v[128:131]
    v_mfma_f32_16x16x32_bf16 v[168:171], v[44:47], v[76:79], v[168:171]
    v_mfma_f32_16x16x32_bf16 v[208:211], v[44:47], v[80:83], v[208:211]
    v_mfma_f32_16x16x32_bf16 v[248:251], v[44:47], v[84:87], v[248:251]
    ds_read_b64_tr_b16 v[44:45], v29 offset:41056
    ds_read_b64_tr_b16 v[46:47], v29 offset:42848
    v_mfma_f32_16x16x32_bf16 v[132:135], v[48:51], v[72:75], v[132:135]
    v_mfma_f32_16x16x32_bf16 v[172:175], v[48:51], v[76:79], v[172:175]
    v_mfma_f32_16x16x32_bf16 v[212:215], v[48:51], v[80:83], v[212:215]
    v_mfma_f32_16x16x32_bf16 v[252:255], v[48:51], v[84:87], v[252:255]
    s_setprio 1
    ds_read_b64_tr_b16 v[48:49], v29 offset:41184
    ds_read_b64_tr_b16 v[50:51], v29 offset:42976
    s_waitcnt lgkmcnt(8)
    v_mfma_f32_16x16x32_bf16 v[96:99], v[32:35], v[56:59], v[96:99]
    v_mfma_f32_16x16x32_bf16 v[136:139], v[32:35], v[60:63], v[136:139]
    v_mfma_f32_16x16x32_bf16 v[176:179], v[32:35], v[64:67], v[176:179]
    v_mfma_f32_16x16x32_bf16 v[216:219], v[32:35], v[68:71], v[216:219]
    ds_read_b64_tr_b16 v[32:33], v28 offset:41216
    ds_read_b64_tr_b16 v[34:35], v28 offset:43008
    s_waitcnt lgkmcnt(8)
    v_mfma_f32_16x16x32_bf16 v[100:103], v[36:39], v[56:59], v[100:103]
    v_mfma_f32_16x16x32_bf16 v[140:143], v[36:39], v[60:63], v[140:143]
    v_mfma_f32_16x16x32_bf16 v[180:183], v[36:39], v[64:67], v[180:183]
    v_mfma_f32_16x16x32_bf16 v[220:223], v[36:39], v[68:71], v[220:223]
    ds_read_b64_tr_b16 v[36:37], v29 offset:41248
    ds_read_b64_tr_b16 v[38:39], v29 offset:43040
    ds_read_b128 v[72:75], v25 offset:32768
    s_waitcnt lgkmcnt(9)
    v_mfma_f32_16x16x32_bf16 v[104:107], v[40:43], v[56:59], v[104:107]
    v_mfma_f32_16x16x32_bf16 v[144:147], v[40:43], v[60:63], v[144:147]
    v_mfma_f32_16x16x32_bf16 v[184:187], v[40:43], v[64:67], v[184:187]
    v_mfma_f32_16x16x32_bf16 v[224:227], v[40:43], v[68:71], v[224:227]
    ds_read_b64_tr_b16 v[40:41], v28 offset:41280
    ds_read_b64_tr_b16 v[42:43], v28 offset:43072
    ds_read_b128 v[76:79], v25 offset:34816
    s_waitcnt lgkmcnt(10)
    v_mfma_f32_16x16x32_bf16 v[108:111], v[44:47], v[56:59], v[108:111]
    v_mfma_f32_16x16x32_bf16 v[148:151], v[44:47], v[60:63], v[148:151]
    v_mfma_f32_16x16x32_bf16 v[188:191], v[44:47], v[64:67], v[188:191]
    v_mfma_f32_16x16x32_bf16 v[228:231], v[44:47], v[68:71], v[228:231]
    ds_read_b64_tr_b16 v[44:45], v26 offset:40960
    ds_read_b64_tr_b16 v[46:47], v26 offset:41728
    ds_read_b128 v[80:83], v25 offset:36864
    s_waitcnt lgkmcnt(11)
    v_mfma_f32_16x16x32_bf16 v[112:115], v[48:51], v[56:59], v[112:115]
    v_mfma_f32_16x16x32_bf16 v[152:155], v[48:51], v[60:63], v[152:155]
    v_mfma_f32_16x16x32_bf16 v[192:195], v[48:51], v[64:67], v[192:195]
    v_mfma_f32_16x16x32_bf16 v[232:235], v[48:51], v[68:71], v[232:235]
    ds_read_b64_tr_b16 v[48:49], v27 offset:40992
    ds_read_b64_tr_b16 v[50:51], v27 offset:41760
    ds_read_b128 v[84:87], v25 offset:38912
    s_waitcnt lgkmcnt(12)
    v_mfma_f32_16x16x32_bf16 v[116:119], v[32:35], v[56:59], v[116:119]
    v_mfma_f32_16x16x32_bf16 v[156:159], v[32:35], v[60:63], v[156:159]
    v_mfma_f32_16x16x32_bf16 v[196:199], v[32:35], v[64:67], v[196:199]
    v_mfma_f32_16x16x32_bf16 v[236:239], v[32:35], v[68:71], v[236:239]
    ds_read_b64_tr_b16 v[32:33], v28 offset:55296
    ds_read_b64_tr_b16 v[34:35], v28 offset:57088
    s_waitcnt lgkmcnt(12)
    v_mfma_f32_16x16x32_bf16 v[120:123], v[36:39], v[56:59], v[120:123]
    v_mfma_f32_16x16x32_bf16 v[160:163], v[36:39], v[60:63], v[160:163]
    v_mfma_f32_16x16x32_bf16 v[200:203], v[36:39], v[64:67], v[200:203]
    v_mfma_f32_16x16x32_bf16 v[240:243], v[36:39], v[68:71], v[240:243]
    ds_read_b64_tr_b16 v[36:37], v29 offset:55328
    ds_read_b64_tr_b16 v[38:39], v29 offset:57120
    s_waitcnt lgkmcnt(11)
    v_mfma_f32_16x16x32_bf16 v[124:127], v[40:43], v[56:59], v[124:127]
    v_mfma_f32_16x16x32_bf16 v[164:167], v[40:43], v[60:63], v[164:167]
    v_mfma_f32_16x16x32_bf16 v[204:207], v[40:43], v[64:67], v[204:207]
    v_mfma_f32_16x16x32_bf16 v[244:247], v[40:43], v[68:71], v[244:247]
    ds_read_b64_tr_b16 v[40:41], v28 offset:55360
    ds_read_b64_tr_b16 v[42:43], v28 offset:57152
    s_waitcnt lgkmcnt(10)
    v_mfma_f32_16x16x32_bf16 v[128:131], v[44:47], v[56:59], v[128:131]
    v_mfma_f32_16x16x32_bf16 v[168:171], v[44:47], v[60:63], v[168:171]
    v_mfma_f32_16x16x32_bf16 v[208:211], v[44:47], v[64:67], v[208:211]
    v_mfma_f32_16x16x32_bf16 v[248:251], v[44:47], v[68:71], v[248:251]
    ds_read_b64_tr_b16 v[44:45], v29 offset:55392
    ds_read_b64_tr_b16 v[46:47], v29 offset:57184
    s_waitcnt lgkmcnt(9)
    v_mfma_f32_16x16x32_bf16 v[132:135], v[48:51], v[56:59], v[132:135]
    v_mfma_f32_16x16x32_bf16 v[172:175], v[48:51], v[60:63], v[172:175]
    v_mfma_f32_16x16x32_bf16 v[212:215], v[48:51], v[64:67], v[212:215]
    v_mfma_f32_16x16x32_bf16 v[252:255], v[48:51], v[68:71], v[252:255]
    ds_read_b64_tr_b16 v[48:49], v29 offset:55520
    ds_read_b64_tr_b16 v[50:51], v29 offset:57312
    s_waitcnt lgkmcnt(8)
    v_mfma_f32_16x16x32_bf16 v[96:99], v[32:35], v[72:75], v[96:99]
    v_mfma_f32_16x16x32_bf16 v[136:139], v[32:35], v[76:79], v[136:139]
    v_mfma_f32_16x16x32_bf16 v[176:179], v[32:35], v[80:83], v[176:179]
    v_mfma_f32_16x16x32_bf16 v[216:219], v[32:35], v[84:87], v[216:219]
    ds_read_b64_tr_b16 v[32:33], v28 offset:55552
    ds_read_b64_tr_b16 v[34:35], v28 offset:57344
    s_waitcnt lgkmcnt(8)
    v_mfma_f32_16x16x32_bf16 v[100:103], v[36:39], v[72:75], v[100:103]
    v_mfma_f32_16x16x32_bf16 v[140:143], v[36:39], v[76:79], v[140:143]
    v_mfma_f32_16x16x32_bf16 v[180:183], v[36:39], v[80:83], v[180:183]
    v_mfma_f32_16x16x32_bf16 v[220:223], v[36:39], v[84:87], v[220:223]
    ds_read_b64_tr_b16 v[36:37], v29 offset:55584
    ds_read_b64_tr_b16 v[38:39], v29 offset:57376
    s_waitcnt lgkmcnt(8)
    v_mfma_f32_16x16x32_bf16 v[104:107], v[40:43], v[72:75], v[104:107]
    v_mfma_f32_16x16x32_bf16 v[144:147], v[40:43], v[76:79], v[144:147]
    v_mfma_f32_16x16x32_bf16 v[184:187], v[40:43], v[80:83], v[184:187]
    v_mfma_f32_16x16x32_bf16 v[224:227], v[40:43], v[84:87], v[224:227]
    ds_read_b64_tr_b16 v[40:41], v28 offset:55616
    ds_read_b64_tr_b16 v[42:43], v28 offset:57408
    s_waitcnt lgkmcnt(8)
    v_mfma_f32_16x16x32_bf16 v[108:111], v[44:47], v[72:75], v[108:111]
    v_mfma_f32_16x16x32_bf16 v[148:151], v[44:47], v[76:79], v[148:151]
    v_mfma_f32_16x16x32_bf16 v[188:191], v[44:47], v[80:83], v[188:191]
    v_mfma_f32_16x16x32_bf16 v[228:231], v[44:47], v[84:87], v[228:231]
    ds_read_b64_tr_b16 v[44:45], v26 offset:47104
    ds_read_b64_tr_b16 v[46:47], v26 offset:47872
    s_waitcnt lgkmcnt(8)
    v_mfma_f32_16x16x32_bf16 v[112:115], v[48:51], v[72:75], v[112:115]
    v_mfma_f32_16x16x32_bf16 v[152:155], v[48:51], v[76:79], v[152:155]
    v_mfma_f32_16x16x32_bf16 v[192:195], v[48:51], v[80:83], v[192:195]
    v_mfma_f32_16x16x32_bf16 v[232:235], v[48:51], v[84:87], v[232:235]
    ds_read_b64_tr_b16 v[48:49], v27 offset:47136
    ds_read_b64_tr_b16 v[50:51], v27 offset:47904
    s_waitcnt lgkmcnt(8)
    v_mfma_f32_16x16x32_bf16 v[116:119], v[32:35], v[72:75], v[116:119]
    v_mfma_f32_16x16x32_bf16 v[156:159], v[32:35], v[76:79], v[156:159]
    v_mfma_f32_16x16x32_bf16 v[196:199], v[32:35], v[80:83], v[196:199]
    v_mfma_f32_16x16x32_bf16 v[236:239], v[32:35], v[84:87], v[236:239]
    s_waitcnt lgkmcnt(6)
    v_mfma_f32_16x16x32_bf16 v[120:123], v[36:39], v[72:75], v[120:123]
    v_mfma_f32_16x16x32_bf16 v[160:163], v[36:39], v[76:79], v[160:163]
    v_mfma_f32_16x16x32_bf16 v[200:203], v[36:39], v[80:83], v[200:203]
    v_mfma_f32_16x16x32_bf16 v[240:243], v[36:39], v[84:87], v[240:243]
    s_waitcnt lgkmcnt(4)
    v_mfma_f32_16x16x32_bf16 v[124:127], v[40:43], v[72:75], v[124:127]
    v_mfma_f32_16x16x32_bf16 v[164:167], v[40:43], v[76:79], v[164:167]
    v_mfma_f32_16x16x32_bf16 v[204:207], v[40:43], v[80:83], v[204:207]
    v_mfma_f32_16x16x32_bf16 v[244:247], v[40:43], v[84:87], v[244:247]
    s_waitcnt lgkmcnt(2)
    v_mfma_f32_16x16x32_bf16 v[128:131], v[44:47], v[72:75], v[128:131]
    v_mfma_f32_16x16x32_bf16 v[168:171], v[44:47], v[76:79], v[168:171]
    v_mfma_f32_16x16x32_bf16 v[208:211], v[44:47], v[80:83], v[208:211]
    v_mfma_f32_16x16x32_bf16 v[248:251], v[44:47], v[84:87], v[248:251]
    s_waitcnt lgkmcnt(0)
    v_mfma_f32_16x16x32_bf16 v[132:135], v[48:51], v[72:75], v[132:135]
    v_mfma_f32_16x16x32_bf16 v[172:175], v[48:51], v[76:79], v[172:175]
    v_mfma_f32_16x16x32_bf16 v[212:215], v[48:51], v[80:83], v[212:215]
    v_mfma_f32_16x16x32_bf16 v[252:255], v[48:51], v[84:87], v[252:255]
    s_nop 7
    s_nop 7
    v_and_b32 v2, 15, v0
    v_lshrrev_b32 v3, 4, v0
    s_and_b32 s33, s14, 3
    s_lshl_b32 s33, s33, 6
    s_lshl_b32 s34, s16, 8
    s_add_u32 s33, s33, s34
    v_add_u32 v2, s33, v2
    v_and_b32 v4, 1, v3
    v_lshlrev_b32 v4, 5, v4
    v_lshrrev_b32 v5, 1, v3
    v_lshl_add_u32 v4, v5, 4, v4
    v_lshlrev_b32 v5, 3, v3
    s_mul_i32 s33, s15, 224
    s_add_u32 s33, s33, 16777216
    s_add_u32 s36, s12, s33
    s_addc_u32 s37, s13, 0
    v_mul_u32_u24 v6, 7168, v2
    v_add_u32 v7, v6, v5
    v_add_u32 v6, v6, v4
    s_mul_i32 s33, s15, 393216
    s_add_u32 s38, s12, s33
    s_addc_u32 s39, s13, 0
    v_lshl_add_u32 v8, v2, 6, v4
    s_mov_b32 s40, 0xc0135761
    s_mov_b32 s42, 0xbdd2d3e8
    s_mov_b32 s43, 0xbdd2d3e8
    v_mov_b32 v10, s40
    v_mov_b32 v11, s40
    v_cvt_pk_bf16_f32 v96, 0, v96
    v_cvt_pk_bf16_f32 v97, 0, v97
    v_cvt_pk_bf16_f32 v98, 0, v98
    v_cvt_pk_bf16_f32 v99, 0, v99
    v_cvt_pk_bf16_f32 v112, 0, v112
    v_cvt_pk_bf16_f32 v113, 0, v113
    v_cvt_pk_bf16_f32 v114, 0, v114
    v_cvt_pk_bf16_f32 v115, 0, v115
    v_pk_mul_f32 v[32:33], v[96:97], v[96:97]
    v_pk_mul_f32 v[34:35], v[98:99], v[98:99]
    v_pk_fma_f32 v[32:33], v[32:33], s[42:43], v[10:11]
    v_pk_fma_f32 v[34:35], v[34:35], s[42:43], v[10:11]
    v_pk_mul_f32 v[32:33], v[32:33], v[96:97]
    v_pk_mul_f32 v[34:35], v[34:35], v[98:99]
    v_exp_f32 v32, v32
    v_exp_f32 v33, v33
    v_exp_f32 v34, v34
    v_exp_f32 v35, v35
    s_nop 0
    v_pk_add_f32 v[32:33], v[32:33], 1.0 op_sel_hi:[1,0]
    v_pk_add_f32 v[34:35], v[34:35], 1.0 op_sel_hi:[1,0]
    v_rcp_f32 v32, v32
    v_rcp_f32 v33, v33
    v_rcp_f32 v34, v34
    v_rcp_f32 v35, v35
    s_nop 0
    v_pk_mul_f32 v[32:33], v[32:33], v[96:97]
    v_pk_mul_f32 v[34:35], v[34:35], v[98:99]
    v_cvt_pk_bf16_f32 v32, 0, v32
    v_cvt_pk_bf16_f32 v33, 0, v33
    v_cvt_pk_bf16_f32 v34, 0, v34
    v_cvt_pk_bf16_f32 v35, 0, v35
    v_pk_mul_f32 v[32:33], v[32:33], v[112:113]
    v_pk_mul_f32 v[34:35], v[34:35], v[114:115]
    v_cvt_pk_bf16_f32 v48, v32, v33
    v_cvt_pk_bf16_f32 v49, v34, v35
    v_cvt_pk_bf16_f32 v100, 0, v100
    v_cvt_pk_bf16_f32 v101, 0, v101
    v_cvt_pk_bf16_f32 v102, 0, v102
    v_cvt_pk_bf16_f32 v103, 0, v103
    v_cvt_pk_bf16_f32 v116, 0, v116
    v_cvt_pk_bf16_f32 v117, 0, v117
    v_cvt_pk_bf16_f32 v118, 0, v118
    v_cvt_pk_bf16_f32 v119, 0, v119
    v_pk_mul_f32 v[36:37], v[100:101], v[100:101]
    v_pk_mul_f32 v[38:39], v[102:103], v[102:103]
    v_pk_fma_f32 v[36:37], v[36:37], s[42:43], v[10:11]
    v_pk_fma_f32 v[38:39], v[38:39], s[42:43], v[10:11]
    v_pk_mul_f32 v[36:37], v[36:37], v[100:101]
    v_pk_mul_f32 v[38:39], v[38:39], v[102:103]
    v_exp_f32 v36, v36
    v_exp_f32 v37, v37
    v_exp_f32 v38, v38
    v_exp_f32 v39, v39
    s_nop 0
    v_pk_add_f32 v[36:37], v[36:37], 1.0 op_sel_hi:[1,0]
    v_pk_add_f32 v[38:39], v[38:39], 1.0 op_sel_hi:[1,0]
    v_rcp_f32 v36, v36
    v_rcp_f32 v37, v37
    v_rcp_f32 v38, v38
    v_rcp_f32 v39, v39
    s_nop 0
    v_pk_mul_f32 v[36:37], v[36:37], v[100:101]
    v_pk_mul_f32 v[38:39], v[38:39], v[102:103]
    v_cvt_pk_bf16_f32 v36, 0, v36
    v_cvt_pk_bf16_f32 v37, 0, v37
    v_cvt_pk_bf16_f32 v38, 0, v38
    v_cvt_pk_bf16_f32 v39, 0, v39
    v_pk_mul_f32 v[36:37], v[36:37], v[116:117]
    v_pk_mul_f32 v[38:39], v[38:39], v[118:119]
    v_cvt_pk_bf16_f32 v50, v36, v37
    v_cvt_pk_bf16_f32 v51, v38, v39
    v_cvt_pk_bf16_f32 v104, 0, v104
    v_cvt_pk_bf16_f32 v105, 0, v105
    v_cvt_pk_bf16_f32 v106, 0, v106
    v_cvt_pk_bf16_f32 v107, 0, v107
    v_cvt_pk_bf16_f32 v120, 0, v120
    v_cvt_pk_bf16_f32 v121, 0, v121
    v_cvt_pk_bf16_f32 v122, 0, v122
    v_cvt_pk_bf16_f32 v123, 0, v123
    v_pk_mul_f32 v[32:33], v[104:105], v[104:105]
    v_pk_mul_f32 v[34:35], v[106:107], v[106:107]
    v_pk_fma_f32 v[32:33], v[32:33], s[42:43], v[10:11]
    v_pk_fma_f32 v[34:35], v[34:35], s[42:43], v[10:11]
    v_pk_mul_f32 v[32:33], v[32:33], v[104:105]
    v_pk_mul_f32 v[34:35], v[34:35], v[106:107]
    v_exp_f32 v32, v32
    v_exp_f32 v33, v33
    v_exp_f32 v34, v34
    v_exp_f32 v35, v35
    s_nop 0
    v_pk_add_f32 v[32:33], v[32:33], 1.0 op_sel_hi:[1,0]
    v_pk_add_f32 v[34:35], v[34:35], 1.0 op_sel_hi:[1,0]
    v_rcp_f32 v32, v32
    v_rcp_f32 v33, v33
    v_rcp_f32 v34, v34
    v_rcp_f32 v35, v35
    s_nop 0
    v_pk_mul_f32 v[32:33], v[32:33], v[104:105]
    v_pk_mul_f32 v[34:35], v[34:35], v[106:107]
    v_cvt_pk_bf16_f32 v32, 0, v32
    v_cvt_pk_bf16_f32 v33, 0, v33
    v_cvt_pk_bf16_f32 v34, 0, v34
    v_cvt_pk_bf16_f32 v35, 0, v35
    v_pk_mul_f32 v[32:33], v[32:33], v[120:121]
    v_pk_mul_f32 v[34:35], v[34:35], v[122:123]
    v_cvt_pk_bf16_f32 v52, v32, v33
    v_cvt_pk_bf16_f32 v53, v34, v35
    v_cvt_pk_bf16_f32 v108, 0, v108
    v_cvt_pk_bf16_f32 v109, 0, v109
    v_cvt_pk_bf16_f32 v110, 0, v110
    v_cvt_pk_bf16_f32 v111, 0, v111
    v_cvt_pk_bf16_f32 v124, 0, v124
    v_cvt_pk_bf16_f32 v125, 0, v125
    v_cvt_pk_bf16_f32 v126, 0, v126
    v_cvt_pk_bf16_f32 v127, 0, v127
    v_pk_mul_f32 v[36:37], v[108:109], v[108:109]
    v_pk_mul_f32 v[38:39], v[110:111], v[110:111]
    v_pk_fma_f32 v[36:37], v[36:37], s[42:43], v[10:11]
    v_pk_fma_f32 v[38:39], v[38:39], s[42:43], v[10:11]
    v_pk_mul_f32 v[36:37], v[36:37], v[108:109]
    v_pk_mul_f32 v[38:39], v[38:39], v[110:111]
    v_exp_f32 v36, v36
    v_exp_f32 v37, v37
    v_exp_f32 v38, v38
    v_exp_f32 v39, v39
    s_nop 0
    v_pk_add_f32 v[36:37], v[36:37], 1.0 op_sel_hi:[1,0]
    v_pk_add_f32 v[38:39], v[38:39], 1.0 op_sel_hi:[1,0]
    v_rcp_f32 v36, v36
    v_rcp_f32 v37, v37
    v_rcp_f32 v38, v38
    v_rcp_f32 v39, v39
    s_nop 0
    v_pk_mul_f32 v[36:37], v[36:37], v[108:109]
    v_pk_mul_f32 v[38:39], v[38:39], v[110:111]
    v_cvt_pk_bf16_f32 v36, 0, v36
    v_cvt_pk_bf16_f32 v37, 0, v37
    v_cvt_pk_bf16_f32 v38, 0, v38
    v_cvt_pk_bf16_f32 v39, 0, v39
    v_pk_mul_f32 v[36:37], v[36:37], v[124:125]
    v_pk_mul_f32 v[38:39], v[38:39], v[126:127]
    v_cvt_pk_bf16_f32 v54, v36, v37
    v_cvt_pk_bf16_f32 v55, v38, v39
    s_nop 1
    v_permlane16_swap_b32 v48, v50
    v_permlane16_swap_b32 v49, v51
    global_store_dwordx4 v6, v[48:51], s[36:37] offset:0
    v_permlane16_swap_b32 v52, v54
    v_permlane16_swap_b32 v53, v55
    global_store_dwordx4 v6, v[52:55], s[36:37] offset:64
    v_cvt_pk_bf16_f32 v56, v128, v129
    v_cvt_pk_bf16_f32 v57, v130, v131
    v_cvt_pk_bf16_f32 v58, v132, v133
    v_cvt_pk_bf16_f32 v59, v134, v135
    s_nop 1
    v_permlane16_swap_b32 v56, v58
    v_permlane16_swap_b32 v57, v59
    v_add_u32 v1, 0, v8
    global_store_dwordx4 v1, v[56:59], s[38:39]
    v_add_u32 v6, 114688, v6
    v_add_u32 v7, 114688, v7
    v_add_u32 v8, 1024, v8
    s_nop 1
    v_cvt_pk_bf16_f32 v136, 0, v136
    v_cvt_pk_bf16_f32 v137, 0, v137
    v_cvt_pk_bf16_f32 v138, 0, v138
    v_cvt_pk_bf16_f32 v139, 0, v139
    v_cvt_pk_bf16_f32 v152, 0, v152
    v_cvt_pk_bf16_f32 v153, 0, v153
    v_cvt_pk_bf16_f32 v154, 0, v154
    v_cvt_pk_bf16_f32 v155, 0, v155
    v_pk_mul_f32 v[32:33], v[136:137], v[136:137]
    v_pk_mul_f32 v[34:35], v[138:139], v[138:139]
    v_pk_fma_f32 v[32:33], v[32:33], s[42:43], v[10:11]
    v_pk_fma_f32 v[34:35], v[34:35], s[42:43], v[10:11]
    v_pk_mul_f32 v[32:33], v[32:33], v[136:137]
    v_pk_mul_f32 v[34:35], v[34:35], v[138:139]
    v_exp_f32 v32, v32
    v_exp_f32 v33, v33
    v_exp_f32 v34, v34
    v_exp_f32 v35, v35
    s_nop 0
    v_pk_add_f32 v[32:33], v[32:33], 1.0 op_sel_hi:[1,0]
    v_pk_add_f32 v[34:35], v[34:35], 1.0 op_sel_hi:[1,0]
    v_rcp_f32 v32, v32
    v_rcp_f32 v33, v33
    v_rcp_f32 v34, v34
    v_rcp_f32 v35, v35
    s_nop 0
    v_pk_mul_f32 v[32:33], v[32:33], v[136:137]
    v_pk_mul_f32 v[34:35], v[34:35], v[138:139]
    v_cvt_pk_bf16_f32 v32, 0, v32
    v_cvt_pk_bf16_f32 v33, 0, v33
    v_cvt_pk_bf16_f32 v34, 0, v34
    v_cvt_pk_bf16_f32 v35, 0, v35
    v_pk_mul_f32 v[32:33], v[32:33], v[152:153]
    v_pk_mul_f32 v[34:35], v[34:35], v[154:155]
    v_cvt_pk_bf16_f32 v48, v32, v33
    v_cvt_pk_bf16_f32 v49, v34, v35
    v_cvt_pk_bf16_f32 v140, 0, v140
    v_cvt_pk_bf16_f32 v141, 0, v141
    v_cvt_pk_bf16_f32 v142, 0, v142
    v_cvt_pk_bf16_f32 v143, 0, v143
    v_cvt_pk_bf16_f32 v156, 0, v156
    v_cvt_pk_bf16_f32 v157, 0, v157
    v_cvt_pk_bf16_f32 v158, 0, v158
    v_cvt_pk_bf16_f32 v159, 0, v159
    v_pk_mul_f32 v[36:37], v[140:141], v[140:141]
    v_pk_mul_f32 v[38:39], v[142:143], v[142:143]
    v_pk_fma_f32 v[36:37], v[36:37], s[42:43], v[10:11]
    v_pk_fma_f32 v[38:39], v[38:39], s[42:43], v[10:11]
    v_pk_mul_f32 v[36:37], v[36:37], v[140:141]
    v_pk_mul_f32 v[38:39], v[38:39], v[142:143]
    v_exp_f32 v36, v36
    v_exp_f32 v37, v37
    v_exp_f32 v38, v38
    v_exp_f32 v39, v39
    s_nop 0
    v_pk_add_f32 v[36:37], v[36:37], 1.0 op_sel_hi:[1,0]
    v_pk_add_f32 v[38:39], v[38:39], 1.0 op_sel_hi:[1,0]
    v_rcp_f32 v36, v36
    v_rcp_f32 v37, v37
    v_rcp_f32 v38, v38
    v_rcp_f32 v39, v39
    s_nop 0
    v_pk_mul_f32 v[36:37], v[36:37], v[140:141]
    v_pk_mul_f32 v[38:39], v[38:39], v[142:143]
    v_cvt_pk_bf16_f32 v36, 0, v36
    v_cvt_pk_bf16_f32 v37, 0, v37
    v_cvt_pk_bf16_f32 v38, 0, v38
    v_cvt_pk_bf16_f32 v39, 0, v39
    v_pk_mul_f32 v[36:37], v[36:37], v[156:157]
    v_pk_mul_f32 v[38:39], v[38:39], v[158:159]
    v_cvt_pk_bf16_f32 v50, v36, v37
    v_cvt_pk_bf16_f32 v51, v38, v39
    v_cvt_pk_bf16_f32 v144, 0, v144
    v_cvt_pk_bf16_f32 v145, 0, v145
    v_cvt_pk_bf16_f32 v146, 0, v146
    v_cvt_pk_bf16_f32 v147, 0, v147
    v_cvt_pk_bf16_f32 v160, 0, v160
    v_cvt_pk_bf16_f32 v161, 0, v161
    v_cvt_pk_bf16_f32 v162, 0, v162
    v_cvt_pk_bf16_f32 v163, 0, v163
    v_pk_mul_f32 v[32:33], v[144:145], v[144:145]
    v_pk_mul_f32 v[34:35], v[146:147], v[146:147]
    v_pk_fma_f32 v[32:33], v[32:33], s[42:43], v[10:11]
    v_pk_fma_f32 v[34:35], v[34:35], s[42:43], v[10:11]
    v_pk_mul_f32 v[32:33], v[32:33], v[144:145]
    v_pk_mul_f32 v[34:35], v[34:35], v[146:147]
    v_exp_f32 v32, v32
    v_exp_f32 v33, v33
    v_exp_f32 v34, v34
    v_exp_f32 v35, v35
    s_nop 0
    v_pk_add_f32 v[32:33], v[32:33], 1.0 op_sel_hi:[1,0]
    v_pk_add_f32 v[34:35], v[34:35], 1.0 op_sel_hi:[1,0]
    v_rcp_f32 v32, v32
    v_rcp_f32 v33, v33
    v_rcp_f32 v34, v34
    v_rcp_f32 v35, v35
    s_nop 0
    v_pk_mul_f32 v[32:33], v[32:33], v[144:145]
    v_pk_mul_f32 v[34:35], v[34:35], v[146:147]
    v_cvt_pk_bf16_f32 v32, 0, v32
    v_cvt_pk_bf16_f32 v33, 0, v33
    v_cvt_pk_bf16_f32 v34, 0, v34
    v_cvt_pk_bf16_f32 v35, 0, v35
    v_pk_mul_f32 v[32:33], v[32:33], v[160:161]
    v_pk_mul_f32 v[34:35], v[34:35], v[162:163]
    v_cvt_pk_bf16_f32 v52, v32, v33
    v_cvt_pk_bf16_f32 v53, v34, v35
    v_cvt_pk_bf16_f32 v148, 0, v148
    v_cvt_pk_bf16_f32 v149, 0, v149
    v_cvt_pk_bf16_f32 v150, 0, v150
    v_cvt_pk_bf16_f32 v151, 0, v151
    v_cvt_pk_bf16_f32 v164, 0, v164
    v_cvt_pk_bf16_f32 v165, 0, v165
    v_cvt_pk_bf16_f32 v166, 0, v166
    v_cvt_pk_bf16_f32 v167, 0, v167
    v_pk_mul_f32 v[36:37], v[148:149], v[148:149]
    v_pk_mul_f32 v[38:39], v[150:151], v[150:151]
    v_pk_fma_f32 v[36:37], v[36:37], s[42:43], v[10:11]
    v_pk_fma_f32 v[38:39], v[38:39], s[42:43], v[10:11]
    v_pk_mul_f32 v[36:37], v[36:37], v[148:149]
    v_pk_mul_f32 v[38:39], v[38:39], v[150:151]
    v_exp_f32 v36, v36
    v_exp_f32 v37, v37
    v_exp_f32 v38, v38
    v_exp_f32 v39, v39
    s_nop 0
    v_pk_add_f32 v[36:37], v[36:37], 1.0 op_sel_hi:[1,0]
    v_pk_add_f32 v[38:39], v[38:39], 1.0 op_sel_hi:[1,0]
    v_rcp_f32 v36, v36
    v_rcp_f32 v37, v37
    v_rcp_f32 v38, v38
    v_rcp_f32 v39, v39
    s_nop 0
    v_pk_mul_f32 v[36:37], v[36:37], v[148:149]
    v_pk_mul_f32 v[38:39], v[38:39], v[150:151]
    v_cvt_pk_bf16_f32 v36, 0, v36
    v_cvt_pk_bf16_f32 v37, 0, v37
    v_cvt_pk_bf16_f32 v38, 0, v38
    v_cvt_pk_bf16_f32 v39, 0, v39
    v_pk_mul_f32 v[36:37], v[36:37], v[164:165]
    v_pk_mul_f32 v[38:39], v[38:39], v[166:167]
    v_cvt_pk_bf16_f32 v54, v36, v37
    v_cvt_pk_bf16_f32 v55, v38, v39
    s_nop 1
    v_permlane16_swap_b32 v48, v50
    v_permlane16_swap_b32 v49, v51
    global_store_dwordx4 v6, v[48:51], s[36:37] offset:0
    v_permlane16_swap_b32 v52, v54
    v_permlane16_swap_b32 v53, v55
    global_store_dwordx4 v6, v[52:55], s[36:37] offset:64
    v_cvt_pk_bf16_f32 v56, v168, v169
    v_cvt_pk_bf16_f32 v57, v170, v171
    v_cvt_pk_bf16_f32 v58, v172, v173
    v_cvt_pk_bf16_f32 v59, v174, v175
    s_nop 1
    v_permlane16_swap_b32 v56, v58
    v_permlane16_swap_b32 v57, v59
    v_add_u32 v1, 0, v8
    global_store_dwordx4 v1, v[56:59], s[38:39]
    v_add_u32 v6, 114688, v6
    v_add_u32 v7, 114688, v7
    v_add_u32 v8, 1024, v8
    s_nop 1
    v_cvt_pk_bf16_f32 v176, 0, v176
    v_cvt_pk_bf16_f32 v177, 0, v177
    v_cvt_pk_bf16_f32 v178, 0, v178
    v_cvt_pk_bf16_f32 v179, 0, v179
    v_cvt_pk_bf16_f32 v192, 0, v192
    v_cvt_pk_bf16_f32 v193, 0, v193
    v_cvt_pk_bf16_f32 v194, 0, v194
    v_cvt_pk_bf16_f32 v195, 0, v195
    v_pk_mul_f32 v[32:33], v[176:177], v[176:177]
    v_pk_mul_f32 v[34:35], v[178:179], v[178:179]
    v_pk_fma_f32 v[32:33], v[32:33], s[42:43], v[10:11]
    v_pk_fma_f32 v[34:35], v[34:35], s[42:43], v[10:11]
    v_pk_mul_f32 v[32:33], v[32:33], v[176:177]
    v_pk_mul_f32 v[34:35], v[34:35], v[178:179]
    v_exp_f32 v32, v32
    v_exp_f32 v33, v33
    v_exp_f32 v34, v34
    v_exp_f32 v35, v35
    s_nop 0
    v_pk_add_f32 v[32:33], v[32:33], 1.0 op_sel_hi:[1,0]
    v_pk_add_f32 v[34:35], v[34:35], 1.0 op_sel_hi:[1,0]
    v_rcp_f32 v32, v32
    v_rcp_f32 v33, v33
    v_rcp_f32 v34, v34
    v_rcp_f32 v35, v35
    s_nop 0
    v_pk_mul_f32 v[32:33], v[32:33], v[176:177]
    v_pk_mul_f32 v[34:35], v[34:35], v[178:179]
    v_cvt_pk_bf16_f32 v32, 0, v32
    v_cvt_pk_bf16_f32 v33, 0, v33
    v_cvt_pk_bf16_f32 v34, 0, v34
    v_cvt_pk_bf16_f32 v35, 0, v35
    v_pk_mul_f32 v[32:33], v[32:33], v[192:193]
    v_pk_mul_f32 v[34:35], v[34:35], v[194:195]
    v_cvt_pk_bf16_f32 v48, v32, v33
    v_cvt_pk_bf16_f32 v49, v34, v35
    v_cvt_pk_bf16_f32 v180, 0, v180
    v_cvt_pk_bf16_f32 v181, 0, v181
    v_cvt_pk_bf16_f32 v182, 0, v182
    v_cvt_pk_bf16_f32 v183, 0, v183
    v_cvt_pk_bf16_f32 v196, 0, v196
    v_cvt_pk_bf16_f32 v197, 0, v197
    v_cvt_pk_bf16_f32 v198, 0, v198
    v_cvt_pk_bf16_f32 v199, 0, v199
    v_pk_mul_f32 v[36:37], v[180:181], v[180:181]
    v_pk_mul_f32 v[38:39], v[182:183], v[182:183]
    v_pk_fma_f32 v[36:37], v[36:37], s[42:43], v[10:11]
    v_pk_fma_f32 v[38:39], v[38:39], s[42:43], v[10:11]
    v_pk_mul_f32 v[36:37], v[36:37], v[180:181]
    v_pk_mul_f32 v[38:39], v[38:39], v[182:183]
    v_exp_f32 v36, v36
    v_exp_f32 v37, v37
    v_exp_f32 v38, v38
    v_exp_f32 v39, v39
    s_nop 0
    v_pk_add_f32 v[36:37], v[36:37], 1.0 op_sel_hi:[1,0]
    v_pk_add_f32 v[38:39], v[38:39], 1.0 op_sel_hi:[1,0]
    v_rcp_f32 v36, v36
    v_rcp_f32 v37, v37
    v_rcp_f32 v38, v38
    v_rcp_f32 v39, v39
    s_nop 0
    v_pk_mul_f32 v[36:37], v[36:37], v[180:181]
    v_pk_mul_f32 v[38:39], v[38:39], v[182:183]
    v_cvt_pk_bf16_f32 v36, 0, v36
    v_cvt_pk_bf16_f32 v37, 0, v37
    v_cvt_pk_bf16_f32 v38, 0, v38
    v_cvt_pk_bf16_f32 v39, 0, v39
    v_pk_mul_f32 v[36:37], v[36:37], v[196:197]
    v_pk_mul_f32 v[38:39], v[38:39], v[198:199]
    v_cvt_pk_bf16_f32 v50, v36, v37
    v_cvt_pk_bf16_f32 v51, v38, v39
    v_cvt_pk_bf16_f32 v184, 0, v184
    v_cvt_pk_bf16_f32 v185, 0, v185
    v_cvt_pk_bf16_f32 v186, 0, v186
    v_cvt_pk_bf16_f32 v187, 0, v187
    v_cvt_pk_bf16_f32 v200, 0, v200
    v_cvt_pk_bf16_f32 v201, 0, v201
    v_cvt_pk_bf16_f32 v202, 0, v202
    v_cvt_pk_bf16_f32 v203, 0, v203
    v_pk_mul_f32 v[32:33], v[184:185], v[184:185]
    v_pk_mul_f32 v[34:35], v[186:187], v[186:187]
    v_pk_fma_f32 v[32:33], v[32:33], s[42:43], v[10:11]
    v_pk_fma_f32 v[34:35], v[34:35], s[42:43], v[10:11]
    v_pk_mul_f32 v[32:33], v[32:33], v[184:185]
    v_pk_mul_f32 v[34:35], v[34:35], v[186:187]
    v_exp_f32 v32, v32
    v_exp_f32 v33, v33
    v_exp_f32 v34, v34
    v_exp_f32 v35, v35
    s_nop 0
    v_pk_add_f32 v[32:33], v[32:33], 1.0 op_sel_hi:[1,0]
    v_pk_add_f32 v[34:35], v[34:35], 1.0 op_sel_hi:[1,0]
    v_rcp_f32 v32, v32
    v_rcp_f32 v33, v33
    v_rcp_f32 v34, v34
    v_rcp_f32 v35, v35
    s_nop 0
    v_pk_mul_f32 v[32:33], v[32:33], v[184:185]
    v_pk_mul_f32 v[34:35], v[34:35], v[186:187]
    v_cvt_pk_bf16_f32 v32, 0, v32
    v_cvt_pk_bf16_f32 v33, 0, v33
    v_cvt_pk_bf16_f32 v34, 0, v34
    v_cvt_pk_bf16_f32 v35, 0, v35
    v_pk_mul_f32 v[32:33], v[32:33], v[200:201]
    v_pk_mul_f32 v[34:35], v[34:35], v[202:203]
    v_cvt_pk_bf16_f32 v52, v32, v33
    v_cvt_pk_bf16_f32 v53, v34, v35
    v_cvt_pk_bf16_f32 v188, 0, v188
    v_cvt_pk_bf16_f32 v189, 0, v189
    v_cvt_pk_bf16_f32 v190, 0, v190
    v_cvt_pk_bf16_f32 v191, 0, v191
    v_cvt_pk_bf16_f32 v204, 0, v204
    v_cvt_pk_bf16_f32 v205, 0, v205
    v_cvt_pk_bf16_f32 v206, 0, v206
    v_cvt_pk_bf16_f32 v207, 0, v207
    v_pk_mul_f32 v[36:37], v[188:189], v[188:189]
    v_pk_mul_f32 v[38:39], v[190:191], v[190:191]
    v_pk_fma_f32 v[36:37], v[36:37], s[42:43], v[10:11]
    v_pk_fma_f32 v[38:39], v[38:39], s[42:43], v[10:11]
    v_pk_mul_f32 v[36:37], v[36:37], v[188:189]
    v_pk_mul_f32 v[38:39], v[38:39], v[190:191]
    v_exp_f32 v36, v36
    v_exp_f32 v37, v37
    v_exp_f32 v38, v38
    v_exp_f32 v39, v39
    s_nop 0
    v_pk_add_f32 v[36:37], v[36:37], 1.0 op_sel_hi:[1,0]
    v_pk_add_f32 v[38:39], v[38:39], 1.0 op_sel_hi:[1,0]
    v_rcp_f32 v36, v36
    v_rcp_f32 v37, v37
    v_rcp_f32 v38, v38
    v_rcp_f32 v39, v39
    s_nop 0
    v_pk_mul_f32 v[36:37], v[36:37], v[188:189]
    v_pk_mul_f32 v[38:39], v[38:39], v[190:191]
    v_cvt_pk_bf16_f32 v36, 0, v36
    v_cvt_pk_bf16_f32 v37, 0, v37
    v_cvt_pk_bf16_f32 v38, 0, v38
    v_cvt_pk_bf16_f32 v39, 0, v39
    v_pk_mul_f32 v[36:37], v[36:37], v[204:205]
    v_pk_mul_f32 v[38:39], v[38:39], v[206:207]
    v_cvt_pk_bf16_f32 v54, v36, v37
    v_cvt_pk_bf16_f32 v55, v38, v39
    s_nop 1
    v_permlane16_swap_b32 v48, v50
    v_permlane16_swap_b32 v49, v51
    global_store_dwordx4 v6, v[48:51], s[36:37] offset:0
    v_permlane16_swap_b32 v52, v54
    v_permlane16_swap_b32 v53, v55
    global_store_dwordx4 v6, v[52:55], s[36:37] offset:64
    v_cvt_pk_bf16_f32 v56, v208, v209
    v_cvt_pk_bf16_f32 v57, v210, v211
    v_cvt_pk_bf16_f32 v58, v212, v213
    v_cvt_pk_bf16_f32 v59, v214, v215
    s_nop 1
    v_permlane16_swap_b32 v56, v58
    v_permlane16_swap_b32 v57, v59
    v_add_u32 v1, 0, v8
    global_store_dwordx4 v1, v[56:59], s[38:39]
    v_add_u32 v6, 114688, v6
    v_add_u32 v7, 114688, v7
    v_add_u32 v8, 1024, v8
    s_nop 1
    v_cvt_pk_bf16_f32 v216, 0, v216
    v_cvt_pk_bf16_f32 v217, 0, v217
    v_cvt_pk_bf16_f32 v218, 0, v218
    v_cvt_pk_bf16_f32 v219, 0, v219
    v_cvt_pk_bf16_f32 v232, 0, v232
    v_cvt_pk_bf16_f32 v233, 0, v233
    v_cvt_pk_bf16_f32 v234, 0, v234
    v_cvt_pk_bf16_f32 v235, 0, v235
    v_pk_mul_f32 v[32:33], v[216:217], v[216:217]
    v_pk_mul_f32 v[34:35], v[218:219], v[218:219]
    v_pk_fma_f32 v[32:33], v[32:33], s[42:43], v[10:11]
    v_pk_fma_f32 v[34:35], v[34:35], s[42:43], v[10:11]
    v_pk_mul_f32 v[32:33], v[32:33], v[216:217]
    v_pk_mul_f32 v[34:35], v[34:35], v[218:219]
    v_exp_f32 v32, v32
    v_exp_f32 v33, v33
    v_exp_f32 v34, v34
    v_exp_f32 v35, v35
    s_nop 0
    v_pk_add_f32 v[32:33], v[32:33], 1.0 op_sel_hi:[1,0]
    v_pk_add_f32 v[34:35], v[34:35], 1.0 op_sel_hi:[1,0]
    v_rcp_f32 v32, v32
    v_rcp_f32 v33, v33
    v_rcp_f32 v34, v34
    v_rcp_f32 v35, v35
    s_nop 0
    v_pk_mul_f32 v[32:33], v[32:33], v[216:217]
    v_pk_mul_f32 v[34:35], v[34:35], v[218:219]
    v_cvt_pk_bf16_f32 v32, 0, v32
    v_cvt_pk_bf16_f32 v33, 0, v33
    v_cvt_pk_bf16_f32 v34, 0, v34
    v_cvt_pk_bf16_f32 v35, 0, v35
    v_pk_mul_f32 v[32:33], v[32:33], v[232:233]
    v_pk_mul_f32 v[34:35], v[34:35], v[234:235]
    v_cvt_pk_bf16_f32 v48, v32, v33
    v_cvt_pk_bf16_f32 v49, v34, v35
    v_cvt_pk_bf16_f32 v220, 0, v220
    v_cvt_pk_bf16_f32 v221, 0, v221
    v_cvt_pk_bf16_f32 v222, 0, v222
    v_cvt_pk_bf16_f32 v223, 0, v223
    v_cvt_pk_bf16_f32 v236, 0, v236
    v_cvt_pk_bf16_f32 v237, 0, v237
    v_cvt_pk_bf16_f32 v238, 0, v238
    v_cvt_pk_bf16_f32 v239, 0, v239
    v_pk_mul_f32 v[36:37], v[220:221], v[220:221]
    v_pk_mul_f32 v[38:39], v[222:223], v[222:223]
    v_pk_fma_f32 v[36:37], v[36:37], s[42:43], v[10:11]
    v_pk_fma_f32 v[38:39], v[38:39], s[42:43], v[10:11]
    v_pk_mul_f32 v[36:37], v[36:37], v[220:221]
    v_pk_mul_f32 v[38:39], v[38:39], v[222:223]
    v_exp_f32 v36, v36
    v_exp_f32 v37, v37
    v_exp_f32 v38, v38
    v_exp_f32 v39, v39
    s_nop 0
    v_pk_add_f32 v[36:37], v[36:37], 1.0 op_sel_hi:[1,0]
    v_pk_add_f32 v[38:39], v[38:39], 1.0 op_sel_hi:[1,0]
    v_rcp_f32 v36, v36
    v_rcp_f32 v37, v37
    v_rcp_f32 v38, v38
    v_rcp_f32 v39, v39
    s_nop 0
    v_pk_mul_f32 v[36:37], v[36:37], v[220:221]
    v_pk_mul_f32 v[38:39], v[38:39], v[222:223]
    v_cvt_pk_bf16_f32 v36, 0, v36
    v_cvt_pk_bf16_f32 v37, 0, v37
    v_cvt_pk_bf16_f32 v38, 0, v38
    v_cvt_pk_bf16_f32 v39, 0, v39
    v_pk_mul_f32 v[36:37], v[36:37], v[236:237]
    v_pk_mul_f32 v[38:39], v[38:39], v[238:239]
    v_cvt_pk_bf16_f32 v50, v36, v37
    v_cvt_pk_bf16_f32 v51, v38, v39
    v_cvt_pk_bf16_f32 v224, 0, v224
    v_cvt_pk_bf16_f32 v225, 0, v225
    v_cvt_pk_bf16_f32 v226, 0, v226
    v_cvt_pk_bf16_f32 v227, 0, v227
    v_cvt_pk_bf16_f32 v240, 0, v240
    v_cvt_pk_bf16_f32 v241, 0, v241
    v_cvt_pk_bf16_f32 v242, 0, v242
    v_cvt_pk_bf16_f32 v243, 0, v243
    v_pk_mul_f32 v[32:33], v[224:225], v[224:225]
    v_pk_mul_f32 v[34:35], v[226:227], v[226:227]
    v_pk_fma_f32 v[32:33], v[32:33], s[42:43], v[10:11]
    v_pk_fma_f32 v[34:35], v[34:35], s[42:43], v[10:11]
    v_pk_mul_f32 v[32:33], v[32:33], v[224:225]
    v_pk_mul_f32 v[34:35], v[34:35], v[226:227]
    v_exp_f32 v32, v32
    v_exp_f32 v33, v33
    v_exp_f32 v34, v34
    v_exp_f32 v35, v35
    s_nop 0
    v_pk_add_f32 v[32:33], v[32:33], 1.0 op_sel_hi:[1,0]
    v_pk_add_f32 v[34:35], v[34:35], 1.0 op_sel_hi:[1,0]
    v_rcp_f32 v32, v32
    v_rcp_f32 v33, v33
    v_rcp_f32 v34, v34
    v_rcp_f32 v35, v35
    s_nop 0
    v_pk_mul_f32 v[32:33], v[32:33], v[224:225]
    v_pk_mul_f32 v[34:35], v[34:35], v[226:227]
    v_cvt_pk_bf16_f32 v32, 0, v32
    v_cvt_pk_bf16_f32 v33, 0, v33
    v_cvt_pk_bf16_f32 v34, 0, v34
    v_cvt_pk_bf16_f32 v35, 0, v35
    v_pk_mul_f32 v[32:33], v[32:33], v[240:241]
    v_pk_mul_f32 v[34:35], v[34:35], v[242:243]
    v_cvt_pk_bf16_f32 v52, v32, v33
    v_cvt_pk_bf16_f32 v53, v34, v35
    v_cvt_pk_bf16_f32 v228, 0, v228
    v_cvt_pk_bf16_f32 v229, 0, v229
    v_cvt_pk_bf16_f32 v230, 0, v230
    v_cvt_pk_bf16_f32 v231, 0, v231
    v_cvt_pk_bf16_f32 v244, 0, v244
    v_cvt_pk_bf16_f32 v245, 0, v245
    v_cvt_pk_bf16_f32 v246, 0, v246
    v_cvt_pk_bf16_f32 v247, 0, v247
    v_pk_mul_f32 v[36:37], v[228:229], v[228:229]
    v_pk_mul_f32 v[38:39], v[230:231], v[230:231]
    v_pk_fma_f32 v[36:37], v[36:37], s[42:43], v[10:11]
    v_pk_fma_f32 v[38:39], v[38:39], s[42:43], v[10:11]
    v_pk_mul_f32 v[36:37], v[36:37], v[228:229]
    v_pk_mul_f32 v[38:39], v[38:39], v[230:231]
    v_exp_f32 v36, v36
    v_exp_f32 v37, v37
    v_exp_f32 v38, v38
    v_exp_f32 v39, v39
    s_nop 0
    v_pk_add_f32 v[36:37], v[36:37], 1.0 op_sel_hi:[1,0]
    v_pk_add_f32 v[38:39], v[38:39], 1.0 op_sel_hi:[1,0]
    v_rcp_f32 v36, v36
    v_rcp_f32 v37, v37
    v_rcp_f32 v38, v38
    v_rcp_f32 v39, v39
    s_nop 0
    v_pk_mul_f32 v[36:37], v[36:37], v[228:229]
    v_pk_mul_f32 v[38:39], v[38:39], v[230:231]
    v_cvt_pk_bf16_f32 v36, 0, v36
    v_cvt_pk_bf16_f32 v37, 0, v37
    v_cvt_pk_bf16_f32 v38, 0, v38
    v_cvt_pk_bf16_f32 v39, 0, v39
    v_pk_mul_f32 v[36:37], v[36:37], v[244:245]
    v_pk_mul_f32 v[38:39], v[38:39], v[246:247]
    v_cvt_pk_bf16_f32 v54, v36, v37
    v_cvt_pk_bf16_f32 v55, v38, v39
    s_nop 1
    v_permlane16_swap_b32 v48, v50
    v_permlane16_swap_b32 v49, v51
    global_store_dwordx4 v6, v[48:51], s[36:37] offset:0
    v_permlane16_swap_b32 v52, v54
    v_permlane16_swap_b32 v53, v55
    global_store_dwordx4 v6, v[52:55], s[36:37] offset:64
    v_cvt_pk_bf16_f32 v56, v248, v249
    v_cvt_pk_bf16_f32 v57, v250, v251
    v_cvt_pk_bf16_f32 v58, v252, v253
    v_cvt_pk_bf16_f32 v59, v254, v255
    s_nop 1
    v_permlane16_swap_b32 v56, v58
    v_permlane16_swap_b32 v57, v59
    v_add_u32 v1, 0, v8
    global_store_dwordx4 v1, v[56:59], s[38:39]
    s_endpgm
L1_h1:
    s_waitcnt vmcnt(0)
    s_barrier
    ds_read_b128 v[56:59], v24 offset:0
    ds_read_b128 v[60:63], v24 offset:2048
    ds_read_b128 v[64:67], v24 offset:4096
    ds_read_b128 v[68:71], v24 offset:6144
    ds_read_b64_tr_b16 v[32:33], v28 offset:128
    ds_read_b64_tr_b16 v[34:35], v28 offset:1920
    ds_read_b64_tr_b16 v[36:37], v29 offset:160
    ds_read_b64_tr_b16 v[38:39], v29 offset:1952
    ds_read_b64_tr_b16 v[40:41], v28 offset:192
    ds_read_b64_tr_b16 v[42:43], v28 offset:1984
    ds_read_b64_tr_b16 v[44:45], v29 offset:352
    ds_read_b64_tr_b16 v[46:47], v29 offset:2144
    s_mov_b32 s32, 6
    ds_read_b64_tr_b16 v[48:49], v28 offset:384
    ds_read_b64_tr_b16 v[50:51], v28 offset:2176
    s_waitcnt lgkmcnt(8)
    v_mfma_f32_16x16x32_bf16 v[96:99], v[32:35], v[56:59], 0
    global_load_dword v92, v[88:89], off
    v_lshl_add_u64 v[88:89], v[88:89], 0, v[90:91]
    v_mfma_f32_16x16x32_bf16 v[136:139], v[32:35], v[60:63], 0
    global_load_dword v92, v[88:89], off
    v_lshl_add_u64 v[88:89], v[88:89], 0, v[90:91]
    v_mfma_f32_16x16x32_bf16 v[176:179], v[32:35], v[64:67], 0
    v_mfma_f32_16x16x32_bf16 v[216:219], v[32:35], v[68:71], 0
    ds_read_b64_tr_b16 v[32:33], v29 offset:416
    ds_read_b64_tr_b16 v[34:35], v29 offset:2208
    s_waitcnt lgkmcnt(8)
    v_mfma_f32_16x16x32_bf16 v[100:103], v[36:39], v[56:59], 0
    v_mfma_f32_16x16x32_bf16 v[140:143], v[36:39], v[60:63], 0
    v_mfma_f32_16x16x32_bf16 v[180:183], v[36:39], v[64:67], 0
    v_mfma_f32_16x16x32_bf16 v[220:223], v[36:39], v[68:71], 0
    ds_read_b64_tr_b16 v[36:37], v26 offset:64
    ds_read_b64_tr_b16 v[38:39], v26 offset:832
    ds_read_b128 v[72:75], v25 offset:0
    s_waitcnt lgkmcnt(9)
    v_mfma_f32_16x16x32_bf16 v[104:107], v[40:43], v[56:59], 0
    v_mfma_f32_16x16x32_bf16 v[144:147], v[40:43], v[60:63], 0
    v_mfma_f32_16x16x32_bf16 v[184:187], v[40:43], v[64:67], 0
    v_mfma_f32_16x16x32_bf16 v[224:227], v[40:43], v[68:71], 0
    ds_read_b64_tr_b16 v[40:41], v27 offset:96
    ds_read_b64_tr_b16 v[42:43], v27 offset:864
    ds_read_b128 v[76:79], v25 offset:2048
    s_waitcnt lgkmcnt(10)
    v_mfma_f32_16x16x32_bf16 v[108:111], v[44:47], v[56:59], 0
    v_mfma_f32_16x16x32_bf16 v[148:151], v[44:47], v[60:63], 0
    v_mfma_f32_16x16x32_bf16 v[188:191], v[44:47], v[64:67], 0
    v_mfma_f32_16x16x32_bf16 v[228:231], v[44:47], v[68:71], 0
    ds_read_b64_tr_b16 v[44:45], v26 offset:128
    ds_read_b64_tr_b16 v[46:47], v26 offset:896
    ds_read_b128 v[80:83], v25 offset:4096
    s_waitcnt lgkmcnt(11)
    v_mfma_f32_16x16x32_bf16 v[112:115], v[48:51], v[56:59], 0
    v_mfma_f32_16x16x32_bf16 v[152:155], v[48:51], v[60:63], 0
    v_mfma_f32_16x16x32_bf16 v[192:195], v[48:51], v[64:67], 0
    v_mfma_f32_16x16x32_bf16 v[232:235], v[48:51], v[68:71], 0
    ds_read_b64_tr_b16 v[48:49], v27 offset:160
    ds_read_b64_tr_b16 v[50:51], v27 offset:928
    ds_read_b128 v[84:87], v25 offset:6144
    s_waitcnt lgkmcnt(12)
    v_mfma_f32_16x16x32_bf16 v[116:119], v[32:35], v[56:59], 0
    v_mfma_f32_16x16x32_bf16 v[156:159], v[32:35], v[60:63], 0
    v_mfma_f32_16x16x32_bf16 v[196:199], v[32:35], v[64:67], 0
    v_mfma_f32_16x16x32_bf16 v[236:239], v[32:35], v[68:71], 0
    ds_read_b64_tr_b16 v[32:33], v28 offset:14464
    ds_read_b64_tr_b16 v[34:35], v28 offset:16256
    s_waitcnt lgkmcnt(12)
    v_mfma_f32_16x16x32_bf16 v[120:123], v[36:39], v[56:59], 0
    v_mfma_f32_16x16x32_bf16 v[160:163], v[36:39], v[60:63], 0
    v_mfma_f32_16x16x32_bf16 v[200:203], v[36:39], v[64:67], 0
    v_mfma_f32_16x16x32_bf16 v[240:243], v[36:39], v[68:71], 0
    ds_read_b64_tr_b16 v[36:37], v29 offset:14496
    ds_read_b64_tr_b16 v[38:39], v29 offset:16288
    s_waitcnt lgkmcnt(11)
    v_mfma_f32_16x16x32_bf16 v[124:127], v[40:43], v[56:59], 0
    v_mfma_f32_16x16x32_bf16 v[164:167], v[40:43], v[60:63], 0
    v_mfma_f32_16x16x32_bf16 v[204:207], v[40:43], v[64:67], 0
    v_mfma_f32_16x16x32_bf16 v[244:247], v[40:43], v[68:71], 0
    ds_read_b64_tr_b16 v[40:41], v28 offset:14528
    ds_read_b64_tr_b16 v[42:43], v28 offset:16320
    s_waitcnt lgkmcnt(10)
    v_mfma_f32_16x16x32_bf16 v[128:131], v[44:47], v[56:59], 0
    v_mfma_f32_16x16x32_bf16 v[168:171], v[44:47], v[60:63], 0
    v_mfma_f32_16x16x32_bf16 v[208:211], v[44:47], v[64:67], 0
    v_mfma_f32_16x16x32_bf16 v[248:251], v[44:47], v[68:71], 0
    ds_read_b64_tr_b16 v[44:45], v29 offset:14688
    ds_read_b64_tr_b16 v[46:47], v29 offset:16480
    s_waitcnt lgkmcnt(9)
    v_mfma_f32_16x16x32_bf16 v[132:135], v[48:51], v[56:59], 0
    v_mfma_f32_16x16x32_bf16 v[172:175], v[48:51], v[60:63], 0
    v_mfma_f32_16x16x32_bf16 v[212:215], v[48:51], v[64:67], 0
    v_mfma_f32_16x16x32_bf16 v[252:255], v[48:51], v[68:71], 0
    ds_read_b64_tr_b16 v[48:49], v28 offset:14720
    ds_read_b64_tr_b16 v[50:51], v28 offset:16512
    s_waitcnt lgkmcnt(8)
    v_mfma_f32_16x16x32_bf16 v[96:99], v[32:35], v[72:75], v[96:99]
    v_mfma_f32_16x16x32_bf16 v[136:139], v[32:35], v[76:79], v[136:139]
    v_mfma_f32_16x16x32_bf16 v[176:179], v[32:35], v[80:83], v[176:179]
    v_mfma_f32_16x16x32_bf16 v[216:219], v[32:35], v[84:87], v[216:219]
    ds_read_b64_tr_b16 v[32:33], v29 offset:14752
    ds_read_b64_tr_b16 v[34:35], v29 offset:16544
    s_waitcnt lgkmcnt(8)
    v_mfma_f32_16x16x32_bf16 v[100:103], v[36:39], v[72:75], v[100:103]
    v_mfma_f32_16x16x32_bf16 v[140:143], v[36:39], v[76:79], v[140:143]
    v_mfma_f32_16x16x32_bf16 v[180:183], v[36:39], v[80:83], v[180:183]
    v_mfma_f32_16x16x32_bf16 v[220:223], v[36:39], v[84:87], v[220:223]
    ds_read_b64_tr_b16 v[36:37], v26 offset:6208
    ds_read_b64_tr_b16 v[38:39], v26 offset:6976
    s_waitcnt lgkmcnt(8)
    v_mfma_f32_16x16x32_bf16 v[104:107], v[40:43], v[72:75], v[104:107]
    v_mfma_f32_16x16x32_bf16 v[144:147], v[40:43], v[76:79], v[144:147]
    v_mfma_f32_16x16x32_bf16 v[184:187], v[40:43], v[80:83], v[184:187]
    v_mfma_f32_16x16x32_bf16 v[224:227], v[40:43], v[84:87], v[224:227]
    ds_read_b64_tr_b16 v[40:41], v27 offset:6240
    ds_read_b64_tr_b16 v[42:43], v27 offset:7008
    s_waitcnt lgkmcnt(8)
    v_mfma_f32_16x16x32_bf16 v[108:111], v[44:47], v[72:75], v[108:111]
    v_mfma_f32_16x16x32_bf16 v[148:151], v[44:47], v[76:79], v[148:151]
    v_mfma_f32_16x16x32_bf16 v[188:191], v[44:47], v[80:83], v[188:191]
    v_mfma_f32_16x16x32_bf16 v[228:231], v[44:47], v[84:87], v[228:231]
    ds_read_b64_tr_b16 v[44:45], v26 offset:6272
    ds_read_b64_tr_b16 v[46:47], v26 offset:7040
    s_waitcnt lgkmcnt(8)
    v_mfma_f32_16x16x32_bf16 v[112:115], v[48:51], v[72:75], v[112:115]
    v_mfma_f32_16x16x32_bf16 v[152:155], v[48:51], v[76:79], v[152:155]
    v_mfma_f32_16x16x32_bf16 v[192:195], v[48:51], v[80:83], v[192:195]
    v_mfma_f32_16x16x32_bf16 v[232:235], v[48:51], v[84:87], v[232:235]
    ds_read_b64_tr_b16 v[48:49], v27 offset:6304
    ds_read_b64_tr_b16 v[50:51], v27 offset:7072
    s_waitcnt lgkmcnt(8)
    v_mfma_f32_16x16x32_bf16 v[116:119], v[32:35], v[72:75], v[116:119]
    v_mfma_f32_16x16x32_bf16 v[156:159], v[32:35], v[76:79], v[156:159]
    v_mfma_f32_16x16x32_bf16 v[196:199], v[32:35], v[80:83], v[196:199]
    v_mfma_f32_16x16x32_bf16 v[236:239], v[32:35], v[84:87], v[236:239]
    s_waitcnt lgkmcnt(0) vmcnt(0)
    s_barrier
    ds_read_b128 v[56:59], v24 offset:32768
    ds_read_b128 v[60:63], v24 offset:34816
    ds_read_b128 v[64:67], v24 offset:36864
    ds_read_b128 v[68:71], v24 offset:38912
    ds_read_b64_tr_b16 v[32:33], v28 offset:41088
    ds_read_b64_tr_b16 v[34:35], v28 offset:42880
    v_mfma_f32_16x16x32_bf16 v[120:123], v[36:39], v[72:75], v[120:123]
    global_load_dword v92, v[88:89], off
    v_lshl_add_u64 v[88:89], v[88:89], 0, v[90:91]
    v_mfma_f32_16x16x32_bf16 v[160:163], v[36:39], v[76:79], v[160:163]
    v_mfma_f32_16x16x32_bf16 v[200:203], v[36:39], v[80:83], v[200:203]
    v_mfma_f32_16x16x32_bf16 v[240:243], v[36:39], v[84:87], v[240:243]
    ds_read_b64_tr_b16 v[36:37], v29 offset:41120
    ds_read_b64_tr_b16 v[38:39], v29 offset:42912
    v_mfma_f32_16x16x32_bf16 v[124:127], v[40:43], v[72:75], v[124:127]
    v_mfma_f32_16x16x32_bf16 v[164:167], v[40:43], v[76:79], v[164:167]
    v_mfma_f32_16x16x32_bf16 v[204:207], v[40:43], v[80:83], v[204:207]
    v_mfma_f32_16x16x32_bf16 v[244:247], v[40:43], v[84:87], v[244:247]
    ds_read_b64_tr_b16 v[40:41], v28 offset:41152
    ds_read_b64_tr_b16 v[42:43], v28 offset:42944
    v_mfma_f32_16x16x32_bf16 v[128:131], v[44:47], v[72:75], v[128:131]
    v_mfma_f32_16x16x32_bf16 v[168:171], v[44:47], v[76:79], v[168:171]
    v_mfma_f32_16x16x32_bf16 v[208:211], v[44:47], v[80:83], v[208:211]
    v_mfma_f32_16x16x32_bf16 v[248:251], v[44:47], v[84:87], v[248:251]
    ds_read_b64_tr_b16 v[44:45], v29 offset:41312
    ds_read_b64_tr_b16 v[46:47], v29 offset:43104
    v_mfma_f32_16x16x32_bf16 v[132:135], v[48:51], v[72:75], v[132:135]
    v_mfma_f32_16x16x32_bf16 v[172:175], v[48:51], v[76:79], v[172:175]
    v_mfma_f32_16x16x32_bf16 v[212:215], v[48:51], v[80:83], v[212:215]
    v_mfma_f32_16x16x32_bf16 v[252:255], v[48:51], v[84:87], v[252:255]
L1_loop1:
    ds_read_b64_tr_b16 v[48:49], v28 offset:41344
    ds_read_b64_tr_b16 v[50:51], v28 offset:43136
    s_waitcnt lgkmcnt(8)
    v_mfma_f32_16x16x32_bf16 v[96:99], v[32:35], v[56:59], v[96:99]
    v_mfma_f32_16x16x32_bf16 v[136:139], v[32:35], v[60:63], v[136:139]
    v_mfma_f32_16x16x32_bf16 v[176:179], v[32:35], v[64:67], v[176:179]
    v_mfma_f32_16x16x32_bf16 v[216:219], v[32:35], v[68:71], v[216:219]
    ds_read_b64_tr_b16 v[32:33], v29 offset:41376
    ds_read_b64_tr_b16 v[34:35], v29 offset:43168
    s_waitcnt lgkmcnt(8)
    v_mfma_f32_16x16x32_bf16 v[100:103], v[36:39], v[56:59], v[100:103]
    v_mfma_f32_16x16x32_bf16 v[140:143], v[36:39], v[60:63], v[140:143]
    v_mfma_f32_16x16x32_bf16 v[180:183], v[36:39], v[64:67], v[180:183]
    v_mfma_f32_16x16x32_bf16 v[220:223], v[36:39], v[68:71], v[220:223]
    ds_read_b64_tr_b16 v[36:37], v26 offset:41024
    ds_read_b64_tr_b16 v[38:39], v26 offset:41792
    ds_read_b128 v[72:75], v25 offset:32768
    s_waitcnt lgkmcnt(9)
    v_mfma_f32_16x16x32_bf16 v[104:107], v[40:43], v[56:59], v[104:107]
    v_mfma_f32_16x16x32_bf16 v[144:147], v[40:43], v[60:63], v[144:147]
    v_mfma_f32_16x16x32_bf16 v[184:187], v[40:43], v[64:67], v[184:187]
    v_mfma_f32_16x16x32_bf16 v[224:227], v[40:43], v[68:71], v[224:227]
    ds_read_b64_tr_b16 v[40:41], v27 offset:41056
    ds_read_b64_tr_b16 v[42:43], v27 offset:41824
    ds_read_b128 v[76:79], v25 offset:34816
    s_waitcnt lgkmcnt(10)
    v_mfma_f32_16x16x32_bf16 v[108:111], v[44:47], v[56:59], v[108:111]
    v_mfma_f32_16x16x32_bf16 v[148:151], v[44:47], v[60:63], v[148:151]
    v_mfma_f32_16x16x32_bf16 v[188:191], v[44:47], v[64:67], v[188:191]
    v_mfma_f32_16x16x32_bf16 v[228:231], v[44:47], v[68:71], v[228:231]
    ds_read_b64_tr_b16 v[44:45], v26 offset:41088
    ds_read_b64_tr_b16 v[46:47], v26 offset:41856
    ds_read_b128 v[80:83], v25 offset:36864
    s_waitcnt lgkmcnt(11)
    v_mfma_f32_16x16x32_bf16 v[112:115], v[48:51], v[56:59], v[112:115]
    v_mfma_f32_16x16x32_bf16 v[152:155], v[48:51], v[60:63], v[152:155]
    v_mfma_f32_16x16x32_bf16 v[192:195], v[48:51], v[64:67], v[192:195]
    v_mfma_f32_16x16x32_bf16 v[232:235], v[48:51], v[68:71], v[232:235]
    ds_read_b64_tr_b16 v[48:49], v27 offset:41120
    ds_read_b64_tr_b16 v[50:51], v27 offset:41888
    ds_read_b128 v[84:87], v25 offset:38912
    s_waitcnt lgkmcnt(12)
    v_mfma_f32_16x16x32_bf16 v[116:119], v[32:35], v[56:59], v[116:119]
    v_mfma_f32_16x16x32_bf16 v[156:159], v[32:35], v[60:63], v[156:159]
    v_mfma_f32_16x16x32_bf16 v[196:199], v[32:35], v[64:67], v[196:199]
    v_mfma_f32_16x16x32_bf16 v[236:239], v[32:35], v[68:71], v[236:239]
    ds_read_b64_tr_b16 v[32:33], v28 offset:55424
    ds_read_b64_tr_b16 v[34:35], v28 offset:57216
    s_waitcnt lgkmcnt(12)
    v_mfma_f32_16x16x32_bf16 v[120:123], v[36:39], v[56:59], v[120:123]
    v_mfma_f32_16x16x32_bf16 v[160:163], v[36:39], v[60:63], v[160:163]
    v_mfma_f32_16x16x32_bf16 v[200:203], v[36:39], v[64:67], v[200:203]
    v_mfma_f32_16x16x32_bf16 v[240:243], v[36:39], v[68:71], v[240:243]
    ds_read_b64_tr_b16 v[36:37], v29 offset:55456
    ds_read_b64_tr_b16 v[38:39], v29 offset:57248
    s_waitcnt lgkmcnt(11)
    v_mfma_f32_16x16x32_bf16 v[124:127], v[40:43], v[56:59], v[124:127]
    v_mfma_f32_16x16x32_bf16 v[164:167], v[40:43], v[60:63], v[164:167]
    v_mfma_f32_16x16x32_bf16 v[204:207], v[40:43], v[64:67], v[204:207]
    v_mfma_f32_16x16x32_bf16 v[244:247], v[40:43], v[68:71], v[244:247]
    ds_read_b64_tr_b16 v[40:41], v28 offset:55488
    ds_read_b64_tr_b16 v[42:43], v28 offset:57280
    s_waitcnt lgkmcnt(10)
    v_mfma_f32_16x16x32_bf16 v[128:131], v[44:47], v[56:59], v[128:131]
    v_mfma_f32_16x16x32_bf16 v[168:171], v[44:47], v[60:63], v[168:171]
    v_mfma_f32_16x16x32_bf16 v[208:211], v[44:47], v[64:67], v[208:211]
    v_mfma_f32_16x16x32_bf16 v[248:251], v[44:47], v[68:71], v[248:251]
    ds_read_b64_tr_b16 v[44:45], v29 offset:55648
    ds_read_b64_tr_b16 v[46:47], v29 offset:57440
    s_waitcnt lgkmcnt(9)
    v_mfma_f32_16x16x32_bf16 v[132:135], v[48:51], v[56:59], v[132:135]
    v_mfma_f32_16x16x32_bf16 v[172:175], v[48:51], v[60:63], v[172:175]
    v_mfma_f32_16x16x32_bf16 v[212:215], v[48:51], v[64:67], v[212:215]
    v_mfma_f32_16x16x32_bf16 v[252:255], v[48:51], v[68:71], v[252:255]
    ds_read_b64_tr_b16 v[48:49], v28 offset:55680
    ds_read_b64_tr_b16 v[50:51], v28 offset:57472
    s_waitcnt lgkmcnt(8)
    v_mfma_f32_16x16x32_bf16 v[96:99], v[32:35], v[72:75], v[96:99]
    v_mfma_f32_16x16x32_bf16 v[136:139], v[32:35], v[76:79], v[136:139]
    v_mfma_f32_16x16x32_bf16 v[176:179], v[32:35], v[80:83], v[176:179]
    v_mfma_f32_16x16x32_bf16 v[216:219], v[32:35], v[84:87], v[216:219]
    ds_read_b64_tr_b16 v[32:33], v29 offset:55712
    ds_read_b64_tr_b16 v[34:35], v29 offset:57504
    s_waitcnt lgkmcnt(8)
    v_mfma_f32_16x16x32_bf16 v[100:103], v[36:39], v[72:75], v[100:103]
    v_mfma_f32_16x16x32_bf16 v[140:143], v[36:39], v[76:79], v[140:143]
    v_mfma_f32_16x16x32_bf16 v[180:183], v[36:39], v[80:83], v[180:183]
    v_mfma_f32_16x16x32_bf16 v[220:223], v[36:39], v[84:87], v[220:223]
    ds_read_b64_tr_b16 v[36:37], v26 offset:47168
    ds_read_b64_tr_b16 v[38:39], v26 offset:47936
    s_waitcnt lgkmcnt(8)
    v_mfma_f32_16x16x32_bf16 v[104:107], v[40:43], v[72:75], v[104:107]
    v_mfma_f32_16x16x32_bf16 v[144:147], v[40:43], v[76:79], v[144:147]
    v_mfma_f32_16x16x32_bf16 v[184:187], v[40:43], v[80:83], v[184:187]
    v_mfma_f32_16x16x32_bf16 v[224:227], v[40:43], v[84:87], v[224:227]
    ds_read_b64_tr_b16 v[40:41], v27 offset:47200
    ds_read_b64_tr_b16 v[42:43], v27 offset:47968
    s_waitcnt lgkmcnt(8)
    v_mfma_f32_16x16x32_bf16 v[108:111], v[44:47], v[72:75], v[108:111]
    v_mfma_f32_16x16x32_bf16 v[148:151], v[44:47], v[76:79], v[148:151]
    v_mfma_f32_16x16x32_bf16 v[188:191], v[44:47], v[80:83], v[188:191]
    v_mfma_f32_16x16x32_bf16 v[228:231], v[44:47], v[84:87], v[228:231]
    ds_read_b64_tr_b16 v[44:45], v26 offset:47232
    ds_read_b64_tr_b16 v[46:47], v26 offset:48000
    s_waitcnt lgkmcnt(8)
    v_mfma_f32_16x16x32_bf16 v[112:115], v[48:51], v[72:75], v[112:115]
    v_mfma_f32_16x16x32_bf16 v[152:155], v[48:51], v[76:79], v[152:155]
    v_mfma_f32_16x16x32_bf16 v[192:195], v[48:51], v[80:83], v[192:195]
    v_mfma_f32_16x16x32_bf16 v[232:235], v[48:51], v[84:87], v[232:235]
    ds_read_b64_tr_b16 v[48:49], v27 offset:47264
    ds_read_b64_tr_b16 v[50:51], v27 offset:48032
    s_waitcnt lgkmcnt(8)
    v_mfma_f32_16x16x32_bf16 v[116:119], v[32:35], v[72:75], v[116:119]
    v_mfma_f32_16x16x32_bf16 v[156:159], v[32:35], v[76:79], v[156:159]
    v_mfma_f32_16x16x32_bf16 v[196:199], v[32:35], v[80:83], v[196:199]
    v_mfma_f32_16x16x32_bf16 v[236:239], v[32:35], v[84:87], v[236:239]
    s_waitcnt lgkmcnt(0) vmcnt(0)
    s_barrier
    ds_read_b128 v[56:59], v24 offset:0
    ds_read_b128 v[60:63], v24 offset:2048
    ds_read_b128 v[64:67], v24 offset:4096
    ds_read_b128 v[68:71], v24 offset:6144
    ds_read_b64_tr_b16 v[32:33], v28 offset:128
    ds_read_b64_tr_b16 v[34:35], v28 offset:1920
    v_mfma_f32_16x16x32_bf16 v[120:123], v[36:39], v[72:75], v[120:123]
    global_load_dword v92, v[88:89], off
    v_lshl_add_u64 v[88:89], v[88:89], 0, v[90:91]
    v_mfma_f32_16x16x32_bf16 v[160:163], v[36:39], v[76:79], v[160:163]
    v_mfma_f32_16x16x32_bf16 v[200:203], v[36:39], v[80:83], v[200:203]
    v_mfma_f32_16x16x32_bf16 v[240:243], v[36:39], v[84:87], v[240:243]
    ds_read_b64_tr_b16 v[36:37], v29 offset:160
    ds_read_b64_tr_b16 v[38:39], v29 offset:1952
    v_mfma_f32_16x16x32_bf16 v[124:127], v[40:43], v[72:75], v[124:127]
    v_mfma_f32_16x16x32_bf16 v[164:167], v[40:43], v[76:79], v[164:167]
    v_mfma_f32_16x16x32_bf16 v[204:207], v[40:43], v[80:83], v[204:207]
    v_mfma_f32_16x16x32_bf16 v[244:247], v[40:43], v[84:87], v[244:247]
    ds_read_b64_tr_b16 v[40:41], v28 offset:192
    ds_read_b64_tr_b16 v[42:43], v28 offset:1984
    v_mfma_f32_16x16x32_bf16 v[128:131], v[44:47], v[72:75], v[128:131]
    v_mfma_f32_16x16x32_bf16 v[168:171], v[44:47], v[76:79], v[168:171]
    v_mfma_f32_16x16x32_bf16 v[208:211], v[44:47], v[80:83], v[208:211]
    v_mfma_f32_16x16x32_bf16 v[248:251], v[44:47], v[84:87], v[248:251]
    ds_read_b64_tr_b16 v[44:45], v29 offset:352
    ds_read_b64_tr_b16 v[46:47], v29 offset:2144
    v_mfma_f32_16x16x32_bf16 v[132:135], v[48:51], v[72:75], v[132:135]
    v_mfma_f32_16x16x32_bf16 v[172:175], v[48:51], v[76:79], v[172:175]
    v_mfma_f32_16x16x32_bf16 v[212:215], v[48:51], v[80:83], v[212:215]
    v_mfma_f32_16x16x32_bf16 v[252:255], v[48:51], v[84:87], v[252:255]
    ds_read_b64_tr_b16 v[48:49], v28 offset:384
    ds_read_b64_tr_b16 v[50:51], v28 offset:2176
    s_waitcnt lgkmcnt(8)
    v_mfma_f32_16x16x32_bf16 v[96:99], v[32:35], v[56:59], v[96:99]
    v_mfma_f32_16x16x32_bf16 v[136:139], v[32:35], v[60:63], v[136:139]
    v_mfma_f32_16x16x32_bf16 v[176:179], v[32:35], v[64:67], v[176:179]
    v_mfma_f32_16x16x32_bf16 v[216:219], v[32:35], v[68:71], v[216:219]
    ds_read_b64_tr_b16 v[32:33], v29 offset:416
    ds_read_b64_tr_b16 v[34:35], v29 offset:2208
    s_waitcnt lgkmcnt(8)
    v_mfma_f32_16x16x32_bf16 v[100:103], v[36:39], v[56:59], v[100:103]
    v_mfma_f32_16x16x32_bf16 v[140:143], v[36:39], v[60:63], v[140:143]
    v_mfma_f32_16x16x32_bf16 v[180:183], v[36:39], v[64:67], v[180:183]
    v_mfma_f32_16x16x32_bf16 v[220:223], v[36:39], v[68:71], v[220:223]
    ds_read_b64_tr_b16 v[36:37], v26 offset:64
    ds_read_b64_tr_b16 v[38:39], v26 offset:832
    ds_read_b128 v[72:75], v25 offset:0
    s_waitcnt lgkmcnt(9)
    v_mfma_f32_16x16x32_bf16 v[104:107], v[40:43], v[56:59], v[104:107]
    v_mfma_f32_16x16x32_bf16 v[144:147], v[40:43], v[60:63], v[144:147]
    v_mfma_f32_16x16x32_bf16 v[184:187], v[40:43], v[64:67], v[184:187]
    v_mfma_f32_16x16x32_bf16 v[224:227], v[40:43], v[68:71], v[224:227]
    ds_read_b64_tr_b16 v[40:41], v27 offset:96
    ds_read_b64_tr_b16 v[42:43], v27 offset:864
    ds_read_b128 v[76:79], v25 offset:2048
    s_waitcnt lgkmcnt(10)
    v_mfma_f32_16x16x32_bf16 v[108:111], v[44:47], v[56:59], v[108:111]
    v_mfma_f32_16x16x32_bf16 v[148:151], v[44:47], v[60:63], v[148:151]
    v_mfma_f32_16x16x32_bf16 v[188:191], v[44:47], v[64:67], v[188:191]
    v_mfma_f32_16x16x32_bf16 v[228:231], v[44:47], v[68:71], v[228:231]
    ds_read_b64_tr_b16 v[44:45], v26 offset:128
    ds_read_b64_tr_b16 v[46:47], v26 offset:896
    ds_read_b128 v[80:83], v25 offset:4096
    s_waitcnt lgkmcnt(11)
    v_mfma_f32_16x16x32_bf16 v[112:115], v[48:51], v[56:59], v[112:115]
    v_mfma_f32_16x16x32_bf16 v[152:155], v[48:51], v[60:63], v[152:155]
    v_mfma_f32_16x16x32_bf16 v[192:195], v[48:51], v[64:67], v[192:195]
    v_mfma_f32_16x16x32_bf16 v[232:235], v[48:51], v[68:71], v[232:235]
    ds_read_b64_tr_b16 v[48:49], v27 offset:160
    ds_read_b64_tr_b16 v[50:51], v27 offset:928
    ds_read_b128 v[84:87], v25 offset:6144
    s_waitcnt lgkmcnt(12)
    v_mfma_f32_16x16x32_bf16 v[116:119], v[32:35], v[56:59], v[116:119]
    v_mfma_f32_16x16x32_bf16 v[156:159], v[32:35], v[60:63], v[156:159]
    v_mfma_f32_16x16x32_bf16 v[196:199], v[32:35], v[64:67], v[196:199]
    v_mfma_f32_16x16x32_bf16 v[236:239], v[32:35], v[68:71], v[236:239]
    ds_read_b64_tr_b16 v[32:33], v28 offset:14464
    ds_read_b64_tr_b16 v[34:35], v28 offset:16256
    s_waitcnt lgkmcnt(12)
    v_mfma_f32_16x16x32_bf16 v[120:123], v[36:39], v[56:59], v[120:123]
    v_mfma_f32_16x16x32_bf16 v[160:163], v[36:39], v[60:63], v[160:163]
    v_mfma_f32_16x16x32_bf16 v[200:203], v[36:39], v[64:67], v[200:203]
    v_mfma_f32_16x16x32_bf16 v[240:243], v[36:39], v[68:71], v[240:243]
    ds_read_b64_tr_b16 v[36:37], v29 offset:14496
    ds_read_b64_tr_b16 v[38:39], v29 offset:16288
    s_waitcnt lgkmcnt(11)
    v_mfma_f32_16x16x32_bf16 v[124:127], v[40:43], v[56:59], v[124:127]
    v_mfma_f32_16x16x32_bf16 v[164:167], v[40:43], v[60:63], v[164:167]
    v_mfma_f32_16x16x32_bf16 v[204:207], v[40:43], v[64:67], v[204:207]
    v_mfma_f32_16x16x32_bf16 v[244:247], v[40:43], v[68:71], v[244:247]
    ds_read_b64_tr_b16 v[40:41], v28 offset:14528
    ds_read_b64_tr_b16 v[42:43], v28 offset:16320
    s_waitcnt lgkmcnt(10)
    v_mfma_f32_16x16x32_bf16 v[128:131], v[44:47], v[56:59], v[128:131]
    v_mfma_f32_16x16x32_bf16 v[168:171], v[44:47], v[60:63], v[168:171]
    v_mfma_f32_16x16x32_bf16 v[208:211], v[44:47], v[64:67], v[208:211]
    v_mfma_f32_16x16x32_bf16 v[248:251], v[44:47], v[68:71], v[248:251]
    ds_read_b64_tr_b16 v[44:45], v29 offset:14688
    ds_read_b64_tr_b16 v[46:47], v29 offset:16480
    s_waitcnt lgkmcnt(9)
    v_mfma_f32_16x16x32_bf16 v[132:135], v[48:51], v[56:59], v[132:135]
    v_mfma_f32_16x16x32_bf16 v[172:175], v[48:51], v[60:63], v[172:175]
    v_mfma_f32_16x16x32_bf16 v[212:215], v[48:51], v[64:67], v[212:215]
    v_mfma_f32_16x16x32_bf16 v[252:255], v[48:51], v[68:71], v[252:255]
    ds_read_b64_tr_b16 v[48:49], v28 offset:14720
    ds_read_b64_tr_b16 v[50:51], v28 offset:16512
    s_waitcnt lgkmcnt(8)
    v_mfma_f32_16x16x32_bf16 v[96:99], v[32:35], v[72:75], v[96:99]
    v_mfma_f32_16x16x32_bf16 v[136:139], v[32:35], v[76:79], v[136:139]
    v_mfma_f32_16x16x32_bf16 v[176:179], v[32:35], v[80:83], v[176:179]
    v_mfma_f32_16x16x32_bf16 v[216:219], v[32:35], v[84:87], v[216:219]
    ds_read_b64_tr_b16 v[32:33], v29 offset:14752
    ds_read_b64_tr_b16 v[34:35], v29 offset:16544
    s_waitcnt lgkmcnt(8)
    v_mfma_f32_16x16x32_bf16 v[100:103], v[36:39], v[72:75], v[100:103]
    v_mfma_f32_16x16x32_bf16 v[140:143], v[36:39], v[76:79], v[140:143]
    v_mfma_f32_16x16x32_bf16 v[180:183], v[36:39], v[80:83], v[180:183]
    v_mfma_f32_16x16x32_bf16 v[220:223], v[36:39], v[84:87], v[220:223]
    ds_read_b64_tr_b16 v[36:37], v26 offset:6208
    ds_read_b64_tr_b16 v[38:39], v26 offset:6976
    s_waitcnt lgkmcnt(8)
    v_mfma_f32_16x16x32_bf16 v[104:107], v[40:43], v[72:75], v[104:107]
    v_mfma_f32_16x16x32_bf16 v[144:147], v[40:43], v[76:79], v[144:147]
    v_mfma_f32_16x16x32_bf16 v[184:187], v[40:43], v[80:83], v[184:187]
    v_mfma_f32_16x16x32_bf16 v[224:227], v[40:43], v[84:87], v[224:227]
    ds_read_b64_tr_b16 v[40:41], v27 offset:6240
    ds_read_b64_tr_b16 v[42:43], v27 offset:7008
    s_waitcnt lgkmcnt(8)
    v_mfma_f32_16x16x32_bf16 v[108:111], v[44:47], v[72:75], v[108:111]
    v_mfma_f32_16x16x32_bf16 v[148:151], v[44:47], v[76:79], v[148:151]
    v_mfma_f32_16x16x32_bf16 v[188:191], v[44:47], v[80:83], v[188:191]
    v_mfma_f32_16x16x32_bf16 v[228:231], v[44:47], v[84:87], v[228:231]
    ds_read_b64_tr_b16 v[44:45], v26 offset:6272
    ds_read_b64_tr_b16 v[46:47], v26 offset:7040
    s_waitcnt lgkmcnt(8)
    v_mfma_f32_16x16x32_bf16 v[112:115], v[48:51], v[72:75], v[112:115]
    v_mfma_f32_16x16x32_bf16 v[152:155], v[48:51], v[76:79], v[152:155]
    v_mfma_f32_16x16x32_bf16 v[192:195], v[48:51], v[80:83], v[192:195]
    v_mfma_f32_16x16x32_bf16 v[232:235], v[48:51], v[84:87], v[232:235]
    ds_read_b64_tr_b16 v[48:49], v27 offset:6304
    ds_read_b64_tr_b16 v[50:51], v27 offset:7072
    s_waitcnt lgkmcnt(8)
    v_mfma_f32_16x16x32_bf16 v[116:119], v[32:35], v[72:75], v[116:119]
    v_mfma_f32_16x16x32_bf16 v[156:159], v[32:35], v[76:79], v[156:159]
    v_mfma_f32_16x16x32_bf16 v[196:199], v[32:35], v[80:83], v[196:199]
    v_mfma_f32_16x16x32_bf16 v[236:239], v[32:35], v[84:87], v[236:239]
    s_waitcnt lgkmcnt(0) vmcnt(0)
    s_barrier
    ds_read_b128 v[56:59], v24 offset:32768
    ds_read_b128 v[60:63], v24 offset:34816
    ds_read_b128 v[64:67], v24 offset:36864
    ds_read_b128 v[68:71], v24 offset:38912
    ds_read_b64_tr_b16 v[32:33], v28 offset:41088
    ds_read_b64_tr_b16 v[34:35], v28 offset:42880
    v_mfma_f32_16x16x32_bf16 v[120:123], v[36:39], v[72:75], v[120:123]
    s_cmp_lt_u32 s32, 2
    s_cbranch_scc1 L1_pf1_0
    global_load_dword v92, v[88:89], off
    v_lshl_add_u64 v[88:89], v[88:89], 0, v[90:91]
L1_pf1_0:
    v_mfma_f32_16x16x32_bf16 v[160:163], v[36:39], v[76:79], v[160:163]
    v_mfma_f32_16x16x32_bf16 v[200:203], v[36:39], v[80:83], v[200:203]
    v_mfma_f32_16x16x32_bf16 v[240:243], v[36:39], v[84:87], v[240:243]
    ds_read_b64_tr_b16 v[36:37], v29 offset:41120
    ds_read_b64_tr_b16 v[38:39], v29 offset:42912
    v_mfma_f32_16x16x32_bf16 v[124:127], v[40:43], v[72:75], v[124:127]
    v_mfma_f32_16x16x32_bf16 v[164:167], v[40:43], v[76:79], v[164:167]
    v_mfma_f32_16x16x32_bf16 v[204:207], v[40:43], v[80:83], v[204:207]
    v_mfma_f32_16x16x32_bf16 v[244:247], v[40:43], v[84:87], v[244:247]
    ds_read_b64_tr_b16 v[40:41], v28 offset:41152
    ds_read_b64_tr_b16 v[42:43], v28 offset:42944
    v_mfma_f32_16x16x32_bf16 v[128:131], v[44:47], v[72:75], v[128:131]
    v_mfma_f32_16x16x32_bf16 v[168:171], v[44:47], v[76:79], v[168:171]
    v_mfma_f32_16x16x32_bf16 v[208:211], v[44:47], v[80:83], v[208:211]
    v_mfma_f32_16x16x32_bf16 v[248:251], v[44:47], v[84:87], v[248:251]
    ds_read_b64_tr_b16 v[44:45], v29 offset:41312
    ds_read_b64_tr_b16 v[46:47], v29 offset:43104
    v_mfma_f32_16x16x32_bf16 v[132:135], v[48:51], v[72:75], v[132:135]
    v_mfma_f32_16x16x32_bf16 v[172:175], v[48:51], v[76:79], v[172:175]
    v_mfma_f32_16x16x32_bf16 v[212:215], v[48:51], v[80:83], v[212:215]
    v_mfma_f32_16x16x32_bf16 v[252:255], v[48:51], v[84:87], v[252:255]
    s_sub_u32 s32, s32, 1
    s_cmp_lg_u32 s32, 0
    s_cbranch_scc1 L1_loop1
    s_mul_i32 s33, s17, 3584
    v_lshlrev_b32 v1, 6, v0
    v_min_u32 v52, 3520, v1
    v_add_u32 v52, s33, v52
    global_load_dword v92, v52, s[58:59]
    s_lshl_b32 s33, s17, 10
    v_min_u32 v52, 960, v1
    v_add_u32 v52, s33, v52
    global_load_dword v92, v52, s[56:57]
    ds_read_b64_tr_b16 v[48:49], v28 offset:41344
    ds_read_b64_tr_b16 v[50:51], v28 offset:43136
    s_waitcnt lgkmcnt(8)
    v_mfma_f32_16x16x32_bf16 v[96:99], v[32:35], v[56:59], v[96:99]
    v_mfma_f32_16x16x32_bf16 v[136:139], v[32:35], v[60:63], v[136:139]
    v_mfma_f32_16x16x32_bf16 v[176:179], v[32:35], v[64:67], v[176:179]
    v_mfma_f32_16x16x32_bf16 v[216:219], v[32:35], v[68:71], v[216:219]
    ds_read_b64_tr_b16 v[32:33], v29 offset:41376
    ds_read_b64_tr_b16 v[34:35], v29 offset:43168
    s_waitcnt lgkmcnt(8)
    v_mfma_f32_16x16x32_bf16 v[100:103], v[36:39], v[56:59], v[100:103]
    v_mfma_f32_16x16x32_bf16 v[140:143], v[36:39], v[60:63], v[140:143]
    v_mfma_f32_16x16x32_bf16 v[180:183], v[36:39], v[64:67], v[180:183]
    v_mfma_f32_16x16x32_bf16 v[220:223], v[36:39], v[68:71], v[220:223]
    ds_read_b64_tr_b16 v[36:37], v26 offset:41024
    ds_read_b64_tr_b16 v[38:39], v26 offset:41792
    ds_read_b128 v[72:75], v25 offset:32768
    s_waitcnt lgkmcnt(9)
    v_mfma_f32_16x16x32_bf16 v[104:107], v[40:43], v[56:59], v[104:107]
    v_mfma_f32_16x16x32_bf16 v[144:147], v[40:43], v[60:63], v[144:147]
    v_mfma_f32_16x16x32_bf16 v[184:187], v[40:43], v[64:67], v[184:187]
    v_mfma_f32_16x16x32_bf16 v[224:227], v[40:43], v[68:71], v[224:227]
    ds_read_b64_tr_b16 v[40:41], v27 offset:41056
    ds_read_b64_tr_b16 v[42:43], v27 offset:41824
    ds_read_b128 v[76:79], v25 offset:34816
    s_waitcnt lgkmcnt(10)
    v_mfma_f32_16x16x32_bf16 v[108:111], v[44:47], v[56:59], v[108:111]
    v_mfma_f32_16x16x32_bf16 v[148:151], v[44:47], v[60:63], v[148:151]
    v_mfma_f32_16x16x32_bf16 v[188:191], v[44:47], v[64:67], v[188:191]
    v_mfma_f32_16x16x32_bf16 v[228:231], v[44:47], v[68:71], v[228:231]
    ds_read_b64_tr_b16 v[44:45], v26 offset:41088
    ds_read_b64_tr_b16 v[46:47], v26 offset:41856
    ds_read_b128 v[80:83], v25 offset:36864
    s_waitcnt lgkmcnt(11)
    v_mfma_f32_16x16x32_bf16 v[112:115], v[48:51], v[56:59], v[112:115]
    v_mfma_f32_16x16x32_bf16 v[152:155], v[48:51], v[60:63], v[152:155]
    v_mfma_f32_16x16x32_bf16 v[192:195], v[48:51], v[64:67], v[192:195]
    v_mfma_f32_16x16x32_bf16 v[232:235], v[48:51], v[68:71], v[232:235]
    ds_read_b64_tr_b16 v[48:49], v27 offset:41120
    ds_read_b64_tr_b16 v[50:51], v27 offset:41888
    ds_read_b128 v[84:87], v25 offset:38912
    s_waitcnt lgkmcnt(12)
    v_mfma_f32_16x16x32_bf16 v[116:119], v[32:35], v[56:59], v[116:119]
    v_mfma_f32_16x16x32_bf16 v[156:159], v[32:35], v[60:63], v[156:159]
    v_mfma_f32_16x16x32_bf16 v[196:199], v[32:35], v[64:67], v[196:199]
    v_mfma_f32_16x16x32_bf16 v[236:239], v[32:35], v[68:71], v[236:239]
    ds_read_b64_tr_b16 v[32:33], v28 offset:55424
    ds_read_b64_tr_b16 v[34:35], v28 offset:57216
    s_waitcnt lgkmcnt(12)
    v_mfma_f32_16x16x32_bf16 v[120:123], v[36:39], v[56:59], v[120:123]
    v_mfma_f32_16x16x32_bf16 v[160:163], v[36:39], v[60:63], v[160:163]
    v_mfma_f32_16x16x32_bf16 v[200:203], v[36:39], v[64:67], v[200:203]
    v_mfma_f32_16x16x32_bf16 v[240:243], v[36:39], v[68:71], v[240:243]
    ds_read_b64_tr_b16 v[36:37], v29 offset:55456
    ds_read_b64_tr_b16 v[38:39], v29 offset:57248
    s_waitcnt lgkmcnt(11)
    v_mfma_f32_16x16x32_bf16 v[124:127], v[40:43], v[56:59], v[124:127]
    v_mfma_f32_16x16x32_bf16 v[164:167], v[40:43], v[60:63], v[164:167]
    v_mfma_f32_16x16x32_bf16 v[204:207], v[40:43], v[64:67], v[204:207]
    v_mfma_f32_16x16x32_bf16 v[244:247], v[40:43], v[68:71], v[244:247]
    ds_read_b64_tr_b16 v[40:41], v28 offset:55488
    ds_read_b64_tr_b16 v[42:43], v28 offset:57280
    s_waitcnt lgkmcnt(10)
    v_mfma_f32_16x16x32_bf16 v[128:131], v[44:47], v[56:59], v[128:131]
    v_mfma_f32_16x16x32_bf16 v[168:171], v[44:47], v[60:63], v[168:171]
    v_mfma_f32_16x16x32_bf16 v[208:211], v[44:47], v[64:67], v[208:211]
    v_mfma_f32_16x16x32_bf16 v[248:251], v[44:47], v[68:71], v[248:251]
    ds_read_b64_tr_b16 v[44:45], v29 offset:55648
    ds_read_b64_tr_b16 v[46:47], v29 offset:57440
    s_waitcnt lgkmcnt(9)
    v_mfma_f32_16x16x32_bf16 v[132:135], v[48:51], v[56:59], v[132:135]
    v_mfma_f32_16x16x32_bf16 v[172:175], v[48:51], v[60:63], v[172:175]
    v_mfma_f32_16x16x32_bf16 v[212:215], v[48:51], v[64:67], v[212:215]
    v_mfma_f32_16x16x32_bf16 v[252:255], v[48:51], v[68:71], v[252:255]
    ds_read_b64_tr_b16 v[48:49], v28 offset:55680
    ds_read_b64_tr_b16 v[50:51], v28 offset:57472
    s_waitcnt lgkmcnt(8)
    v_mfma_f32_16x16x32_bf16 v[96:99], v[32:35], v[72:75], v[96:99]
    v_mfma_f32_16x16x32_bf16 v[136:139], v[32:35], v[76:79], v[136:139]
    v_mfma_f32_16x16x32_bf16 v[176:179], v[32:35], v[80:83], v[176:179]
    v_mfma_f32_16x16x32_bf16 v[216:219], v[32:35], v[84:87], v[216:219]
    ds_read_b64_tr_b16 v[32:33], v29 offset:55712
    ds_read_b64_tr_b16 v[34:35], v29 offset:57504
    s_waitcnt lgkmcnt(8)
    v_mfma_f32_16x16x32_bf16 v[100:103], v[36:39], v[72:75], v[100:103]
    v_mfma_f32_16x16x32_bf16 v[140:143], v[36:39], v[76:79], v[140:143]
    v_mfma_f32_16x16x32_bf16 v[180:183], v[36:39], v[80:83], v[180:183]
    v_mfma_f32_16x16x32_bf16 v[220:223], v[36:39], v[84:87], v[220:223]
    ds_read_b64_tr_b16 v[36:37], v26 offset:47168
    ds_read_b64_tr_b16 v[38:39], v26 offset:47936
    s_waitcnt lgkmcnt(8)
    v_mfma_f32_16x16x32_bf16 v[104:107], v[40:43], v[72:75], v[104:107]
    v_mfma_f32_16x16x32_bf16 v[144:147], v[40:43], v[76:79], v[144:147]
    v_mfma_f32_16x16x32_bf16 v[184:187], v[40:43], v[80:83], v[184:187]
    v_mfma_f32_16x16x32_bf16 v[224:227], v[40:43], v[84:87], v[224:227]
    ds_read_b64_tr_b16 v[40:41], v27 offset:47200
    ds_read_b64_tr_b16 v[42:43], v27 offset:47968
    s_waitcnt lgkmcnt(8)
    v_mfma_f32_16x16x32_bf16 v[108:111], v[44:47], v[72:75], v[108:111]
    v_mfma_f32_16x16x32_bf16 v[148:151], v[44:47], v[76:79], v[148:151]
    v_mfma_f32_16x16x32_bf16 v[188:191], v[44:47], v[80:83], v[188:191]
    v_mfma_f32_16x16x32_bf16 v[228:231], v[44:47], v[84:87], v[228:231]
    ds_read_b64_tr_b16 v[44:45], v26 offset:47232
    ds_read_b64_tr_b16 v[46:47], v26 offset:48000
    s_waitcnt lgkmcnt(8)
    v_mfma_f32_16x16x32_bf16 v[112:115], v[48:51], v[72:75], v[112:115]
    v_mfma_f32_16x16x32_bf16 v[152:155], v[48:51], v[76:79], v[152:155]
    v_mfma_f32_16x16x32_bf16 v[192:195], v[48:51], v[80:83], v[192:195]
    v_mfma_f32_16x16x32_bf16 v[232:235], v[48:51], v[84:87], v[232:235]
    ds_read_b64_tr_b16 v[48:49], v27 offset:47264
    ds_read_b64_tr_b16 v[50:51], v27 offset:48032
    s_waitcnt lgkmcnt(8)
    v_mfma_f32_16x16x32_bf16 v[116:119], v[32:35], v[72:75], v[116:119]
    v_mfma_f32_16x16x32_bf16 v[156:159], v[32:35], v[76:79], v[156:159]
    v_mfma_f32_16x16x32_bf16 v[196:199], v[32:35], v[80:83], v[196:199]
    v_mfma_f32_16x16x32_bf16 v[236:239], v[32:35], v[84:87], v[236:239]
    s_waitcnt lgkmcnt(0) vmcnt(0)
    s_barrier
    ds_read_b128 v[56:59], v24 offset:0
    ds_read_b128 v[60:63], v24 offset:2048
    ds_read_b128 v[64:67], v24 offset:4096
    ds_read_b128 v[68:71], v24 offset:6144
    ds_read_b64_tr_b16 v[32:33], v28 offset:128
    ds_read_b64_tr_b16 v[34:35], v28 offset:1920
    v_mfma_f32_16x16x32_bf16 v[120:123], v[36:39], v[72:75], v[120:123]
    v_mfma_f32_16x16x32_bf16 v[160:163], v[36:39], v[76:79], v[160:163]
    v_mfma_f32_16x16x32_bf16 v[200:203], v[36:39], v[80:83], v[200:203]
    v_mfma_f32_16x16x32_bf16 v[240:243], v[36:39], v[84:87], v[240:243]
    ds_read_b64_tr_b16 v[36:37], v29 offset:160
    ds_read_b64_tr_b16 v[38:39], v29 offset:1952
    v_mfma_f32_16x16x32_bf16 v[124:127], v[40:43], v[72:75], v[124:127]
    v_mfma_f32_16x16x32_bf16 v[164:167], v[40:43], v[76:79], v[164:167]
    v_mfma_f32_16x16x32_bf16 v[204:207], v[40:43], v[80:83], v[204:207]
    v_mfma_f32_16x16x32_bf16 v[244:247], v[40:43], v[84:87], v[244:247]
    ds_read_b64_tr_b16 v[40:41], v28 offset:192
    ds_read_b64_tr_b16 v[42:43], v28 offset:1984
    v_mfma_f32_16x16x32_bf16 v[128:131], v[44:47], v[72:75], v[128:131]
    v_mfma_f32_16x16x32_bf16 v[168:171], v[44:47], v[76:79], v[168:171]
    v_mfma_f32_16x16x32_bf16 v[208:211], v[44:47], v[80:83], v[208:211]
    v_mfma_f32_16x16x32_bf16 v[248:251], v[44:47], v[84:87], v[248:251]
    ds_read_b64_tr_b16 v[44:45], v29 offset:352
    ds_read_b64_tr_b16 v[46:47], v29 offset:2144
    v_mfma_f32_16x16x32_bf16 v[132:135], v[48:51], v[72:75], v[132:135]
    v_mfma_f32_16x16x32_bf16 v[172:175], v[48:51], v[76:79], v[172:175]
    v_mfma_f32_16x16x32_bf16 v[212:215], v[48:51], v[80:83], v[212:215]
    v_mfma_f32_16x16x32_bf16 v[252:255], v[48:51], v[84:87], v[252:255]
    ds_read_b64_tr_b16 v[48:49], v28 offset:384
    ds_read_b64_tr_b16 v[50:51], v28 offset:2176
    s_waitcnt lgkmcnt(8)
    v_mfma_f32_16x16x32_bf16 v[96:99], v[32:35], v[56:59], v[96:99]
    v_mfma_f32_16x16x32_bf16 v[136:139], v[32:35], v[60:63], v[136:139]
    v_mfma_f32_16x16x32_bf16 v[176:179], v[32:35], v[64:67], v[176:179]
    v_mfma_f32_16x16x32_bf16 v[216:219], v[32:35], v[68:71], v[216:219]
    ds_read_b64_tr_b16 v[32:33], v29 offset:416
    ds_read_b64_tr_b16 v[34:35], v29 offset:2208
    s_waitcnt lgkmcnt(8)
    v_mfma_f32_16x16x32_bf16 v[100:103], v[36:39], v[56:59], v[100:103]
    v_mfma_f32_16x16x32_bf16 v[140:143], v[36:39], v[60:63], v[140:143]
    v_mfma_f32_16x16x32_bf16 v[180:183], v[36:39], v[64:67], v[180:183]
    v_mfma_f32_16x16x32_bf16 v[220:223], v[36:39], v[68:71], v[220:223]
    ds_read_b64_tr_b16 v[36:37], v26 offset:64
    ds_read_b64_tr_b16 v[38:39], v26 offset:832
    ds_read_b128 v[72:75], v25 offset:0
    s_waitcnt lgkmcnt(9)
    v_mfma_f32_16x16x32_bf16 v[104:107], v[40:43], v[56:59], v[104:107]
    v_mfma_f32_16x16x32_bf16 v[144:147], v[40:43], v[60:63], v[144:147]
    v_mfma_f32_16x16x32_bf16 v[184:187], v[40:43], v[64:67], v[184:187]
    v_mfma_f32_16x16x32_bf16 v[224:227], v[40:43], v[68:71], v[224:227]
    ds_read_b64_tr_b16 v[40:41], v27 offset:96
    ds_read_b64_tr_b16 v[42:43], v27 offset:864
    ds_read_b128 v[76:79], v25 offset:2048
    s_waitcnt lgkmcnt(10)
    v_mfma_f32_16x16x32_bf16 v[108:111], v[44:47], v[56:59], v[108:111]
    v_mfma_f32_16x16x32_bf16 v[148:151], v[44:47], v[60:63], v[148:151]
    v_mfma_f32_16x16x32_bf16 v[188:191], v[44:47], v[64:67], v[188:191]
    v_mfma_f32_16x16x32_bf16 v[228:231], v[44:47], v[68:71], v[228:231]
    ds_read_b64_tr_b16 v[44:45], v26 offset:128
    ds_read_b64_tr_b16 v[46:47], v26 offset:896
    ds_read_b128 v[80:83], v25 offset:4096
    s_waitcnt lgkmcnt(11)
    v_mfma_f32_16x16x32_bf16 v[112:115], v[48:51], v[56:59], v[112:115]
    v_mfma_f32_16x16x32_bf16 v[152:155], v[48:51], v[60:63], v[152:155]
    v_mfma_f32_16x16x32_bf16 v[192:195], v[48:51], v[64:67], v[192:195]
    v_mfma_f32_16x16x32_bf16 v[232:235], v[48:51], v[68:71], v[232:235]
    ds_read_b64_tr_b16 v[48:49], v27 offset:160
    ds_read_b64_tr_b16 v[50:51], v27 offset:928
    ds_read_b128 v[84:87], v25 offset:6144
    s_waitcnt lgkmcnt(12)
    v_mfma_f32_16x16x32_bf16 v[116:119], v[32:35], v[56:59], v[116:119]
    v_mfma_f32_16x16x32_bf16 v[156:159], v[32:35], v[60:63], v[156:159]
    v_mfma_f32_16x16x32_bf16 v[196:199], v[32:35], v[64:67], v[196:199]
    v_mfma_f32_16x16x32_bf16 v[236:239], v[32:35], v[68:71], v[236:239]
    ds_read_b64_tr_b16 v[32:33], v28 offset:14464
    ds_read_b64_tr_b16 v[34:35], v28 offset:16256
    s_waitcnt lgkmcnt(12)
    v_mfma_f32_16x16x32_bf16 v[120:123], v[36:39], v[56:59], v[120:123]
    v_mfma_f32_16x16x32_bf16 v[160:163], v[36:39], v[60:63], v[160:163]
    v_mfma_f32_16x16x32_bf16 v[200:203], v[36:39], v[64:67], v[200:203]
    v_mfma_f32_16x16x32_bf16 v[240:243], v[36:39], v[68:71], v[240:243]
    ds_read_b64_tr_b16 v[36:37], v29 offset:14496
    ds_read_b64_tr_b16 v[38:39], v29 offset:16288
    s_waitcnt lgkmcnt(11)
    v_mfma_f32_16x16x32_bf16 v[124:127], v[40:43], v[56:59], v[124:127]
    v_mfma_f32_16x16x32_bf16 v[164:167], v[40:43], v[60:63], v[164:167]
    v_mfma_f32_16x16x32_bf16 v[204:207], v[40:43], v[64:67], v[204:207]
    v_mfma_f32_16x16x32_bf16 v[244:247], v[40:43], v[68:71], v[244:247]
    ds_read_b64_tr_b16 v[40:41], v28 offset:14528
    ds_read_b64_tr_b16 v[42:43], v28 offset:16320
    s_waitcnt lgkmcnt(10)
    v_mfma_f32_16x16x32_bf16 v[128:131], v[44:47], v[56:59], v[128:131]
    v_mfma_f32_16x16x32_bf16 v[168:171], v[44:47], v[60:63], v[168:171]
    v_mfma_f32_16x16x32_bf16 v[208:211], v[44:47], v[64:67], v[208:211]
    v_mfma_f32_16x16x32_bf16 v[248:251], v[44:47], v[68:71], v[248:251]
    ds_read_b64_tr_b16 v[44:45], v29 offset:14688
    ds_read_b64_tr_b16 v[46:47], v29 offset:16480
    s_waitcnt lgkmcnt(9)
    v_mfma_f32_16x16x32_bf16 v[132:135], v[48:51], v[56:59], v[132:135]
    v_mfma_f32_16x16x32_bf16 v[172:175], v[48:51], v[60:63], v[172:175]
    v_mfma_f32_16x16x32_bf16 v[212:215], v[48:51], v[64:67], v[212:215]
    v_mfma_f32_16x16x32_bf16 v[252:255], v[48:51], v[68:71], v[252:255]
    ds_read_b64_tr_b16 v[48:49], v28 offset:14720
    ds_read_b64_tr_b16 v[50:51], v28 offset:16512
    s_waitcnt lgkmcnt(8)
    v_mfma_f32_16x16x32_bf16 v[96:99], v[32:35], v[72:75], v[96:99]
    v_mfma_f32_16x16x32_bf16 v[136:139], v[32:35], v[76:79], v[136:139]
    v_mfma_f32_16x16x32_bf16 v[176:179], v[32:35], v[80:83], v[176:179]
    v_mfma_f32_16x16x32_bf16 v[216:219], v[32:35], v[84:87], v[216:219]
    ds_read_b64_tr_b16 v[32:33], v29 offset:14752
    ds_read_b64_tr_b16 v[34:35], v29 offset:16544
    s_waitcnt lgkmcnt(8)
    v_mfma_f32_16x16x32_bf16 v[100:103], v[36:39], v[72:75], v[100:103]
    v_mfma_f32_16x16x32_bf16 v[140:143], v[36:39], v[76:79], v[140:143]
    v_mfma_f32_16x16x32_bf16 v[180:183], v[36:39], v[80:83], v[180:183]
    v_mfma_f32_16x16x32_bf16 v[220:223], v[36:39], v[84:87], v[220:223]
    ds_read_b64_tr_b16 v[36:37], v26 offset:6208
    ds_read_b64_tr_b16 v[38:39], v26 offset:6976
    s_waitcnt lgkmcnt(8)
    v_mfma_f32_16x16x32_bf16 v[104:107], v[40:43], v[72:75], v[104:107]
    v_mfma_f32_16x16x32_bf16 v[144:147], v[40:43], v[76:79], v[144:147]
    v_mfma_f32_16x16x32_bf16 v[184:187], v[40:43], v[80:83], v[184:187]
    v_mfma_f32_16x16x32_bf16 v[224:227], v[40:43], v[84:87], v[224:227]
    ds_read_b64_tr_b16 v[40:41], v27 offset:6240
    ds_read_b64_tr_b16 v[42:43], v27 offset:7008
    s_waitcnt lgkmcnt(8)
    v_mfma_f32_16x16x32_bf16 v[108:111], v[44:47], v[72:75], v[108:111]
    v_mfma_f32_16x16x32_bf16 v[148:151], v[44:47], v[76:79], v[148:151]
    v_mfma_f32_16x16x32_bf16 v[188:191], v[44:47], v[80:83], v[188:191]
    v_mfma_f32_16x16x32_bf16 v[228:231], v[44:47], v[84:87], v[228:231]
    ds_read_b64_tr_b16 v[44:45], v26 offset:6272
    ds_read_b64_tr_b16 v[46:47], v26 offset:7040
    s_waitcnt lgkmcnt(8)
    v_mfma_f32_16x16x32_bf16 v[112:115], v[48:51], v[72:75], v[112:115]
    v_mfma_f32_16x16x32_bf16 v[152:155], v[48:51], v[76:79], v[152:155]
    v_mfma_f32_16x16x32_bf16 v[192:195], v[48:51], v[80:83], v[192:195]
    v_mfma_f32_16x16x32_bf16 v[232:235], v[48:51], v[84:87], v[232:235]
    ds_read_b64_tr_b16 v[48:49], v27 offset:6304
    ds_read_b64_tr_b16 v[50:51], v27 offset:7072
    s_waitcnt lgkmcnt(8)
    v_mfma_f32_16x16x32_bf16 v[116:119], v[32:35], v[72:75], v[116:119]
    v_mfma_f32_16x16x32_bf16 v[156:159], v[32:35], v[76:79], v[156:159]
    v_mfma_f32_16x16x32_bf16 v[196:199], v[32:35], v[80:83], v[196:199]
    v_mfma_f32_16x16x32_bf16 v[236:239], v[32:35], v[84:87], v[236:239]
    s_waitcnt lgkmcnt(0) vmcnt(0)
    s_barrier
    ds_read_b128 v[56:59], v24 offset:32768
    ds_read_b128 v[60:63], v24 offset:34816
    ds_read_b128 v[64:67], v24 offset:36864
    ds_read_b128 v[68:71], v24 offset:38912
    ds_read_b64_tr_b16 v[32:33], v28 offset:41088
    ds_read_b64_tr_b16 v[34:35], v28 offset:42880
    v_mfma_f32_16x16x32_bf16 v[120:123], v[36:39], v[72:75], v[120:123]
    v_mfma_f32_16x16x32_bf16 v[160:163], v[36:39], v[76:79], v[160:163]
    v_mfma_f32_16x16x32_bf16 v[200:203], v[36:39], v[80:83], v[200:203]
    v_mfma_f32_16x16x32_bf16 v[240:243], v[36:39], v[84:87], v[240:243]
    ds_read_b64_tr_b16 v[36:37], v29 offset:41120
    ds_read_b64_tr_b16 v[38:39], v29 offset:42912
    v_mfma_f32_16x16x32_bf16 v[124:127], v[40:43], v[72:75], v[124:127]
    v_mfma_f32_16x16x32_bf16 v[164:167], v[40:43], v[76:79], v[164:167]
    v_mfma_f32_16x16x32_bf16 v[204:207], v[40:43], v[80:83], v[204:207]
    v_mfma_f32_16x16x32_bf16 v[244:247], v[40:43], v[84:87], v[244:247]
    ds_read_b64_tr_b16 v[40:41], v28 offset:41152
    ds_read_b64_tr_b16 v[42:43], v28 offset:42944
    v_mfma_f32_16x16x32_bf16 v[128:131], v[44:47], v[72:75], v[128:131]
    v_mfma_f32_16x16x32_bf16 v[168:171], v[44:47], v[76:79], v[168:171]
    v_mfma_f32_16x16x32_bf16 v[208:211], v[44:47], v[80:83], v[208:211]
    v_mfma_f32_16x16x32_bf16 v[248:251], v[44:47], v[84:87], v[248:251]
    ds_read_b64_tr_b16 v[44:45], v29 offset:41312
    ds_read_b64_tr_b16 v[46:47], v29 offset:43104
    v_mfma_f32_16x16x32_bf16 v[132:135], v[48:51], v[72:75], v[132:135]
    v_mfma_f32_16x16x32_bf16 v[172:175], v[48:51], v[76:79], v[172:175]
    v_mfma_f32_16x16x32_bf16 v[212:215], v[48:51], v[80:83], v[212:215]
    v_mfma_f32_16x16x32_bf16 v[252:255], v[48:51], v[84:87], v[252:255]
    ds_read_b64_tr_b16 v[48:49], v28 offset:41344
    ds_read_b64_tr_b16 v[50:51], v28 offset:43136
    s_waitcnt lgkmcnt(8)
    v_mfma_f32_16x16x32_bf16 v[96:99], v[32:35], v[56:59], v[96:99]
    v_mfma_f32_16x16x32_bf16 v[136:139], v[32:35], v[60:63], v[136:139]
    v_mfma_f32_16x16x32_bf16 v[176:179], v[32:35], v[64:67], v[176:179]
    v_mfma_f32_16x16x32_bf16 v[216:219], v[32:35], v[68:71], v[216:219]
    ds_read_b64_tr_b16 v[32:33], v29 offset:41376
    ds_read_b64_tr_b16 v[34:35], v29 offset:43168
    s_waitcnt lgkmcnt(8)
    v_mfma_f32_16x16x32_bf16 v[100:103], v[36:39], v[56:59], v[100:103]
    v_mfma_f32_16x16x32_bf16 v[140:143], v[36:39], v[60:63], v[140:143]
    v_mfma_f32_16x16x32_bf16 v[180:183], v[36:39], v[64:67], v[180:183]
    v_mfma_f32_16x16x32_bf16 v[220:223], v[36:39], v[68:71], v[220:223]
    ds_read_b64_tr_b16 v[36:37], v26 offset:41024
    ds_read_b64_tr_b16 v[38:39], v26 offset:41792
    ds_read_b128 v[72:75], v25 offset:32768
    s_waitcnt lgkmcnt(9)
    v_mfma_f32_16x16x32_bf16 v[104:107], v[40:43], v[56:59], v[104:107]
    v_mfma_f32_16x16x32_bf16 v[144:147], v[40:43], v[60:63], v[144:147]
    v_mfma_f32_16x16x32_bf16 v[184:187], v[40:43], v[64:67], v[184:187]
    v_mfma_f32_16x16x32_bf16 v[224:227], v[40:43], v[68:71], v[224:227]
    ds_read_b64_tr_b16 v[40:41], v27 offset:41056
    ds_read_b64_tr_b16 v[42:43], v27 offset:41824
    ds_read_b128 v[76:79], v25 offset:34816
    s_waitcnt lgkmcnt(10)
    v_mfma_f32_16x16x32_bf16 v[108:111], v[44:47], v[56:59], v[108:111]
    v_mfma_f32_16x16x32_bf16 v[148:151], v[44:47], v[60:63], v[148:151]
    v_mfma_f32_16x16x32_bf16 v[188:191], v[44:47], v[64:67], v[188:191]
    v_mfma_f32_16x16x32_bf16 v[228:231], v[44:47], v[68:71], v[228:231]
    ds_read_b64_tr_b16 v[44:45], v26 offset:41088
    ds_read_b64_tr_b16 v[46:47], v26 offset:41856
    ds_read_b128 v[80:83], v25 offset:36864
    s_waitcnt lgkmcnt(11)
    v_mfma_f32_16x16x32_bf16 v[112:115], v[48:51], v[56:59], v[112:115]
    v_mfma_f32_16x16x32_bf16 v[152:155], v[48:51], v[60:63], v[152:155]
    v_mfma_f32_16x16x32_bf16 v[192:195], v[48:51], v[64:67], v[192:195]
    v_mfma_f32_16x16x32_bf16 v[232:235], v[48:51], v[68:71], v[232:235]
    ds_read_b64_tr_b16 v[48:49], v27 offset:41120
    ds_read_b64_tr_b16 v[50:51], v27 offset:41888
    ds_read_b128 v[84:87], v25 offset:38912
    s_waitcnt lgkmcnt(12)
    v_mfma_f32_16x16x32_bf16 v[116:119], v[32:35], v[56:59], v[116:119]
    v_mfma_f32_16x16x32_bf16 v[156:159], v[32:35], v[60:63], v[156:159]
    v_mfma_f32_16x16x32_bf16 v[196:199], v[32:35], v[64:67], v[196:199]
    v_mfma_f32_16x16x32_bf16 v[236:239], v[32:35], v[68:71], v[236:239]
    ds_read_b64_tr_b16 v[32:33], v28 offset:55424
    ds_read_b64_tr_b16 v[34:35], v28 offset:57216
    s_waitcnt lgkmcnt(12)
    v_mfma_f32_16x16x32_bf16 v[120:123], v[36:39], v[56:59], v[120:123]
    v_mfma_f32_16x16x32_bf16 v[160:163], v[36:39], v[60:63], v[160:163]
    v_mfma_f32_16x16x32_bf16 v[200:203], v[36:39], v[64:67], v[200:203]
    v_mfma_f32_16x16x32_bf16 v[240:243], v[36:39], v[68:71], v[240:243]
    ds_read_b64_tr_b16 v[36:37], v29 offset:55456
    ds_read_b64_tr_b16 v[38:39], v29 offset:57248
    s_waitcnt lgkmcnt(11)
    v_mfma_f32_16x16x32_bf16 v[124:127], v[40:43], v[56:59], v[124:127]
    v_mfma_f32_16x16x32_bf16 v[164:167], v[40:43], v[60:63], v[164:167]
    v_mfma_f32_16x16x32_bf16 v[204:207], v[40:43], v[64:67], v[204:207]
    v_mfma_f32_16x16x32_bf16 v[244:247], v[40:43], v[68:71], v[244:247]
    ds_read_b64_tr_b16 v[40:41], v28 offset:55488
    ds_read_b64_tr_b16 v[42:43], v28 offset:57280
    s_waitcnt lgkmcnt(10)
    v_mfma_f32_16x16x32_bf16 v[128:131], v[44:47], v[56:59], v[128:131]
    v_mfma_f32_16x16x32_bf16 v[168:171], v[44:47], v[60:63], v[168:171]
    v_mfma_f32_16x16x32_bf16 v[208:211], v[44:47], v[64:67], v[208:211]
    v_mfma_f32_16x16x32_bf16 v[248:251], v[44:47], v[68:71], v[248:251]
    ds_read_b64_tr_b16 v[44:45], v29 offset:55648
    ds_read_b64_tr_b16 v[46:47], v29 offset:57440
    s_waitcnt lgkmcnt(9)
    v_mfma_f32_16x16x32_bf16 v[132:135], v[48:51], v[56:59], v[132:135]
    v_mfma_f32_16x16x32_bf16 v[172:175], v[48:51], v[60:63], v[172:175]
    v_mfma_f32_16x16x32_bf16 v[212:215], v[48:51], v[64:67], v[212:215]
    v_mfma_f32_16x16x32_bf16 v[252:255], v[48:51], v[68:71], v[252:255]
    ds_read_b64_tr_b16 v[48:49], v28 offset:55680
    ds_read_b64_tr_b16 v[50:51], v28 offset:57472
    s_waitcnt lgkmcnt(8)
    v_mfma_f32_16x16x32_bf16 v[96:99], v[32:35], v[72:75], v[96:99]
    v_mfma_f32_16x16x32_bf16 v[136:139], v[32:35], v[76:79], v[136:139]
    v_mfma_f32_16x16x32_bf16 v[176:179], v[32:35], v[80:83], v[176:179]
    v_mfma_f32_16x16x32_bf16 v[216:219], v[32:35], v[84:87], v[216:219]
    ds_read_b64_tr_b16 v[32:33], v29 offset:55712
    ds_read_b64_tr_b16 v[34:35], v29 offset:57504
    s_waitcnt lgkmcnt(8)
    v_mfma_f32_16x16x32_bf16 v[100:103], v[36:39], v[72:75], v[100:103]
    v_mfma_f32_16x16x32_bf16 v[140:143], v[36:39], v[76:79], v[140:143]
    v_mfma_f32_16x16x32_bf16 v[180:183], v[36:39], v[80:83], v[180:183]
    v_mfma_f32_16x16x32_bf16 v[220:223], v[36:39], v[84:87], v[220:223]
    ds_read_b64_tr_b16 v[36:37], v26 offset:47168
    ds_read_b64_tr_b16 v[38:39], v26 offset:47936
    s_waitcnt lgkmcnt(8)
    v_mfma_f32_16x16x32_bf16 v[104:107], v[40:43], v[72:75], v[104:107]
    v_mfma_f32_16x16x32_bf16 v[144:147], v[40:43], v[76:79], v[144:147]
    v_mfma_f32_16x16x32_bf16 v[184:187], v[40:43], v[80:83], v[184:187]
    v_mfma_f32_16x16x32_bf16 v[224:227], v[40:43], v[84:87], v[224:227]
    ds_read_b64_tr_b16 v[40:41], v27 offset:47200
    ds_read_b64_tr_b16 v[42:43], v27 offset:47968
    s_waitcnt lgkmcnt(8)
    v_mfma_f32_16x16x32_bf16 v[108:111], v[44:47], v[72:75], v[108:111]
    v_mfma_f32_16x16x32_bf16 v[148:151], v[44:47], v[76:79], v[148:151]
    v_mfma_f32_16x16x32_bf16 v[188:191], v[44:47], v[80:83], v[188:191]
    v_mfma_f32_16x16x32_bf16 v[228:231], v[44:47], v[84:87], v[228:231]
    ds_read_b64_tr_b16 v[44:45], v26 offset:47232
    ds_read_b64_tr_b16 v[46:47], v26 offset:48000
    s_waitcnt lgkmcnt(8)
    v_mfma_f32_16x16x32_bf16 v[112:115], v[48:51], v[72:75], v[112:115]
    v_mfma_f32_16x16x32_bf16 v[152:155], v[48:51], v[76:79], v[152:155]
    v_mfma_f32_16x16x32_bf16 v[192:195], v[48:51], v[80:83], v[192:195]
    v_mfma_f32_16x16x32_bf16 v[232:235], v[48:51], v[84:87], v[232:235]
    ds_read_b64_tr_b16 v[48:49], v27 offset:47264
    ds_read_b64_tr_b16 v[50:51], v27 offset:48032
    s_waitcnt lgkmcnt(8)
    v_mfma_f32_16x16x32_bf16 v[116:119], v[32:35], v[72:75], v[116:119]
    v_mfma_f32_16x16x32_bf16 v[156:159], v[32:35], v[76:79], v[156:159]
    v_mfma_f32_16x16x32_bf16 v[196:199], v[32:35], v[80:83], v[196:199]
    v_mfma_f32_16x16x32_bf16 v[236:239], v[32:35], v[84:87], v[236:239]
    s_waitcnt lgkmcnt(6)
    v_mfma_f32_16x16x32_bf16 v[120:123], v[36:39], v[72:75], v[120:123]
    v_mfma_f32_16x16x32_bf16 v[160:163], v[36:39], v[76:79], v[160:163]
    v_mfma_f32_16x16x32_bf16 v[200:203], v[36:39], v[80:83], v[200:203]
    v_mfma_f32_16x16x32_bf16 v[240:243], v[36:39], v[84:87], v[240:243]
    s_waitcnt lgkmcnt(4)
    v_mfma_f32_16x16x32_bf16 v[124:127], v[40:43], v[72:75], v[124:127]
    v_mfma_f32_16x16x32_bf16 v[164:167], v[40:43], v[76:79], v[164:167]
    v_mfma_f32_16x16x32_bf16 v[204:207], v[40:43], v[80:83], v[204:207]
    v_mfma_f32_16x16x32_bf16 v[244:247], v[40:43], v[84:87], v[244:247]
    s_waitcnt lgkmcnt(2)
    v_mfma_f32_16x16x32_bf16 v[128:131], v[44:47], v[72:75], v[128:131]
    v_mfma_f32_16x16x32_bf16 v[168:171], v[44:47], v[76:79], v[168:171]
    v_mfma_f32_16x16x32_bf16 v[208:211], v[44:47], v[80:83], v[208:211]
    v_mfma_f32_16x16x32_bf16 v[248:251], v[44:47], v[84:87], v[248:251]
    s_waitcnt lgkmcnt(0)
    v_mfma_f32_16x16x32_bf16 v[132:135], v[48:51], v[72:75], v[132:135]
    v_mfma_f32_16x16x32_bf16 v[172:175], v[48:51], v[76:79], v[172:175]
    v_mfma_f32_16x16x32_bf16 v[212:215], v[48:51], v[80:83], v[212:215]
    v_mfma_f32_16x16x32_bf16 v[252:255], v[48:51], v[84:87], v[252:255]
    s_nop 7
    s_nop 7
    v_and_b32 v2, 15, v0
    v_lshrrev_b32 v3, 4, v0
    s_and_b32 s33, s14, 3
    s_lshl_b32 s33, s33, 6
    s_lshl_b32 s34, s16, 8
    s_add_u32 s33, s33, s34
    v_add_u32 v2, s33, v2
    v_and_b32 v4, 1, v3
    v_lshlrev_b32 v4, 5, v4
    v_lshrrev_b32 v5, 1, v3
    v_lshl_add_u32 v4, v5, 4, v4
    v_lshlrev_b32 v5, 3, v3
    s_mul_i32 s33, s15, 224
    s_add_u32 s33, s33, 16777216
    s_add_u32 s36, s12, s33
    s_addc_u32 s37, s13, 0
    v_mul_u32_u24 v6, 7168, v2
    v_add_u32 v7, v6, v5
    v_add_u32 v6, v6, v4
    s_mul_i32 s33, s15, 393216
    s_add_u32 s38, s12, s33
    s_addc_u32 s39, s13, 0
    v_lshl_add_u32 v8, v2, 6, v4
    s_mov_b32 s40, 0xc0135761
    s_mov_b32 s42, 0xbdd2d3e8
    s_mov_b32 s43, 0xbdd2d3e8
    v_mov_b32 v10, s40
    v_mov_b32 v11, s40
    v_cvt_pk_bf16_f32 v96, 0, v96
    v_cvt_pk_bf16_f32 v97, 0, v97
    v_cvt_pk_bf16_f32 v98, 0, v98
    v_cvt_pk_bf16_f32 v99, 0, v99
    v_cvt_pk_bf16_f32 v108, 0, v108
    v_cvt_pk_bf16_f32 v109, 0, v109
    v_cvt_pk_bf16_f32 v110, 0, v110
    v_cvt_pk_bf16_f32 v111, 0, v111
    v_pk_mul_f32 v[32:33], v[96:97], v[96:97]
    v_pk_mul_f32 v[34:35], v[98:99], v[98:99]
    v_pk_fma_f32 v[32:33], v[32:33], s[42:43], v[10:11]
    v_pk_fma_f32 v[34:35], v[34:35], s[42:43], v[10:11]
    v_pk_mul_f32 v[32:33], v[32:33], v[96:97]
    v_pk_mul_f32 v[34:35], v[34:35], v[98:99]
    v_exp_f32 v32, v32
    v_exp_f32 v33, v33
    v_exp_f32 v34, v34
    v_exp_f32 v35, v35
    s_nop 0
    v_pk_add_f32 v[32:33], v[32:33], 1.0 op_sel_hi:[1,0]
    v_pk_add_f32 v[34:35], v[34:35], 1.0 op_sel_hi:[1,0]
    v_rcp_f32 v32, v32
    v_rcp_f32 v33, v33
    v_rcp_f32 v34, v34
    v_rcp_f32 v35, v35
    s_nop 0
    v_pk_mul_f32 v[32:33], v[32:33], v[96:97]
    v_pk_mul_f32 v[34:35], v[34:35], v[98:99]
    v_cvt_pk_bf16_f32 v32, 0, v32
    v_cvt_pk_bf16_f32 v33, 0, v33
    v_cvt_pk_bf16_f32 v34, 0, v34
    v_cvt_pk_bf16_f32 v35, 0, v35
    v_pk_mul_f32 v[32:33], v[32:33], v[108:109]
    v_pk_mul_f32 v[34:35], v[34:35], v[110:111]
    v_cvt_pk_bf16_f32 v48, v32, v33
    v_cvt_pk_bf16_f32 v49, v34, v35
    v_cvt_pk_bf16_f32 v100, 0, v100
    v_cvt_pk_bf16_f32 v101, 0, v101
    v_cvt_pk_bf16_f32 v102, 0, v102
    v_cvt_pk_bf16_f32 v103, 0, v103
    v_cvt_pk_bf16_f32 v112, 0, v112
    v_cvt_pk_bf16_f32 v113, 0, v113
    v_cvt_pk_bf16_f32 v114, 0, v114
    v_cvt_pk_bf16_f32 v115, 0, v115
    v_pk_mul_f32 v[36:37], v[100:101], v[100:101]
    v_pk_mul_f32 v[38:39], v[102:103], v[102:103]
    v_pk_fma_f32 v[36:37], v[36:37], s[42:43], v[10:11]
    v_pk_fma_f32 v[38:39], v[38:39], s[42:43], v[10:11]
    v_pk_mul_f32 v[36:37], v[36:37], v[100:101]
    v_pk_mul_f32 v[38:39], v[38:39], v[102:103]
    v_exp_f32 v36, v36
    v_exp_f32 v37, v37
    v_exp_f32 v38, v38
    v_exp_f32 v39, v39
    s_nop 0
    v_pk_add_f32 v[36:37], v[36:37], 1.0 op_sel_hi:[1,0]
    v_pk_add_f32 v[38:39], v[38:39], 1.0 op_sel_hi:[1,0]
    v_rcp_f32 v36, v36
    v_rcp_f32 v37, v37
    v_rcp_f32 v38, v38
    v_rcp_f32 v39, v39
    s_nop 0
    v_pk_mul_f32 v[36:37], v[36:37], v[100:101]
    v_pk_mul_f32 v[38:39], v[38:39], v[102:103]
    v_cvt_pk_bf16_f32 v36, 0, v36
    v_cvt_pk_bf16_f32 v37, 0, v37
    v_cvt_pk_bf16_f32 v38, 0, v38
    v_cvt_pk_bf16_f32 v39, 0, v39
    v_pk_mul_f32 v[36:37], v[36:37], v[112:113]
    v_pk_mul_f32 v[38:39], v[38:39], v[114:115]
    v_cvt_pk_bf16_f32 v50, v36, v37
    v_cvt_pk_bf16_f32 v51, v38, v39
    v_cvt_pk_bf16_f32 v104, 0, v104
    v_cvt_pk_bf16_f32 v105, 0, v105
    v_cvt_pk_bf16_f32 v106, 0, v106
    v_cvt_pk_bf16_f32 v107, 0, v107
    v_cvt_pk_bf16_f32 v116, 0, v116
    v_cvt_pk_bf16_f32 v117, 0, v117
    v_cvt_pk_bf16_f32 v118, 0, v118
    v_cvt_pk_bf16_f32 v119, 0, v119
    v_pk_mul_f32 v[32:33], v[104:105], v[104:105]
    v_pk_mul_f32 v[34:35], v[106:107], v[106:107]
    v_pk_fma_f32 v[32:33], v[32:33], s[42:43], v[10:11]
    v_pk_fma_f32 v[34:35], v[34:35], s[42:43], v[10:11]
    v_pk_mul_f32 v[32:33], v[32:33], v[104:105]
    v_pk_mul_f32 v[34:35], v[34:35], v[106:107]
    v_exp_f32 v32, v32
    v_exp_f32 v33, v33
    v_exp_f32 v34, v34
    v_exp_f32 v35, v35
    s_nop 0
    v_pk_add_f32 v[32:33], v[32:33], 1.0 op_sel_hi:[1,0]
    v_pk_add_f32 v[34:35], v[34:35], 1.0 op_sel_hi:[1,0]
    v_rcp_f32 v32, v32
    v_rcp_f32 v33, v33
    v_rcp_f32 v34, v34
    v_rcp_f32 v35, v35
    s_nop 0
    v_pk_mul_f32 v[32:33], v[32:33], v[104:105]
    v_pk_mul_f32 v[34:35], v[34:35], v[106:107]
    v_cvt_pk_bf16_f32 v32, 0, v32
    v_cvt_pk_bf16_f32 v33, 0, v33
    v_cvt_pk_bf16_f32 v34, 0, v34
    v_cvt_pk_bf16_f32 v35, 0, v35
    v_pk_mul_f32 v[32:33], v[32:33], v[116:117]
    v_pk_mul_f32 v[34:35], v[34:35], v[118:119]
    v_cvt_pk_bf16_f32 v52, v32, v33
    v_cvt_pk_bf16_f32 v53, v34, v35
    s_nop 1
    v_permlane16_swap_b32 v48, v50
    v_permlane16_swap_b32 v49, v51
    global_store_dwordx4 v6, v[48:51], s[36:37] offset:128
    global_store_dwordx2 v7, v[52:53], s[36:37] offset:192
    v_cvt_pk_bf16_f32 v56, v120, v121
    v_cvt_pk_bf16_f32 v57, v122, v123
    v_cvt_pk_bf16_f32 v58, v124, v125
    v_cvt_pk_bf16_f32 v59, v126, v127
    s_nop 1
    v_permlane16_swap_b32 v56, v58
    v_permlane16_swap_b32 v57, v59
    v_add_u32 v1, 131072, v8
    global_store_dwordx4 v1, v[56:59], s[38:39]
    v_cvt_pk_bf16_f32 v60, v128, v129
    v_cvt_pk_bf16_f32 v61, v130, v131
    v_cvt_pk_bf16_f32 v62, v132, v133
    v_cvt_pk_bf16_f32 v63, v134, v135
    s_nop 1
    v_permlane16_swap_b32 v60, v62
    v_permlane16_swap_b32 v61, v63
    v_add_u32 v1, 262144, v8
    global_store_dwordx4 v1, v[60:63], s[38:39]
    v_add_u32 v6, 114688, v6
    v_add_u32 v7, 114688, v7
    v_add_u32 v8, 1024, v8
    s_nop 1
    v_cvt_pk_bf16_f32 v136, 0, v136
    v_cvt_pk_bf16_f32 v137, 0, v137
    v_cvt_pk_bf16_f32 v138, 0, v138
    v_cvt_pk_bf16_f32 v139, 0, v139
    v_cvt_pk_bf16_f32 v148, 0, v148
    v_cvt_pk_bf16_f32 v149, 0, v149
    v_cvt_pk_bf16_f32 v150, 0, v150
    v_cvt_pk_bf16_f32 v151, 0, v151
    v_pk_mul_f32 v[32:33], v[136:137], v[136:137]
    v_pk_mul_f32 v[34:35], v[138:139], v[138:139]
    v_pk_fma_f32 v[32:33], v[32:33], s[42:43], v[10:11]
    v_pk_fma_f32 v[34:35], v[34:35], s[42:43], v[10:11]
    v_pk_mul_f32 v[32:33], v[32:33], v[136:137]
    v_pk_mul_f32 v[34:35], v[34:35], v[138:139]
    v_exp_f32 v32, v32
    v_exp_f32 v33, v33
    v_exp_f32 v34, v34
    v_exp_f32 v35, v35
    s_nop 0
    v_pk_add_f32 v[32:33], v[32:33], 1.0 op_sel_hi:[1,0]
    v_pk_add_f32 v[34:35], v[34:35], 1.0 op_sel_hi:[1,0]
    v_rcp_f32 v32, v32
    v_rcp_f32 v33, v33
    v_rcp_f32 v34, v34
    v_rcp_f32 v35, v35
    s_nop 0
    v_pk_mul_f32 v[32:33], v[32:33], v[136:137]
    v_pk_mul_f32 v[34:35], v[34:35], v[138:139]
    v_cvt_pk_bf16_f32 v32, 0, v32
    v_cvt_pk_bf16_f32 v33, 0, v33
    v_cvt_pk_bf16_f32 v34, 0, v34
    v_cvt_pk_bf16_f32 v35, 0, v35
    v_pk_mul_f32 v[32:33], v[32:33], v[148:149]
    v_pk_mul_f32 v[34:35], v[34:35], v[150:151]
    v_cvt_pk_bf16_f32 v48, v32, v33
    v_cvt_pk_bf16_f32 v49, v34, v35
    v_cvt_pk_bf16_f32 v140, 0, v140
    v_cvt_pk_bf16_f32 v141, 0, v141
    v_cvt_pk_bf16_f32 v142, 0, v142
    v_cvt_pk_bf16_f32 v143, 0, v143
    v_cvt_pk_bf16_f32 v152, 0, v152
    v_cvt_pk_bf16_f32 v153, 0, v153
    v_cvt_pk_bf16_f32 v154, 0, v154
    v_cvt_pk_bf16_f32 v155, 0, v155
    v_pk_mul_f32 v[36:37], v[140:141], v[140:141]
    v_pk_mul_f32 v[38:39], v[142:143], v[142:143]
    v_pk_fma_f32 v[36:37], v[36:37], s[42:43], v[10:11]
    v_pk_fma_f32 v[38:39], v[38:39], s[42:43], v[10:11]
    v_pk_mul_f32 v[36:37], v[36:37], v[140:141]
    v_pk_mul_f32 v[38:39], v[38:39], v[142:143]
    v_exp_f32 v36, v36
    v_exp_f32 v37, v37
    v_exp_f32 v38, v38
    v_exp_f32 v39, v39
    s_nop 0
    v_pk_add_f32 v[36:37], v[36:37], 1.0 op_sel_hi:[1,0]
    v_pk_add_f32 v[38:39], v[38:39], 1.0 op_sel_hi:[1,0]
    v_rcp_f32 v36, v36
    v_rcp_f32 v37, v37
    v_rcp_f32 v38, v38
    v_rcp_f32 v39, v39
    s_nop 0
    v_pk_mul_f32 v[36:37], v[36:37], v[140:141]
    v_pk_mul_f32 v[38:39], v[38:39], v[142:143]
    v_cvt_pk_bf16_f32 v36, 0, v36
    v_cvt_pk_bf16_f32 v37, 0, v37
    v_cvt_pk_bf16_f32 v38, 0, v38
    v_cvt_pk_bf16_f32 v39, 0, v39
    v_pk_mul_f32 v[36:37], v[36:37], v[152:153]
    v_pk_mul_f32 v[38:39], v[38:39], v[154:155]
    v_cvt_pk_bf16_f32 v50, v36, v37
    v_cvt_pk_bf16_f32 v51, v38, v39
    v_cvt_pk_bf16_f32 v144, 0, v144
    v_cvt_pk_bf16_f32 v145, 0, v145
    v_cvt_pk_bf16_f32 v146, 0, v146
    v_cvt_pk_bf16_f32 v147, 0, v147
    v_cvt_pk_bf16_f32 v156, 0, v156
    v_cvt_pk_bf16_f32 v157, 0, v157
    v_cvt_pk_bf16_f32 v158, 0, v158
    v_cvt_pk_bf16_f32 v159, 0, v159
    v_pk_mul_f32 v[32:33], v[144:145], v[144:145]
    v_pk_mul_f32 v[34:35], v[146:147], v[146:147]
    v_pk_fma_f32 v[32:33], v[32:33], s[42:43], v[10:11]
    v_pk_fma_f32 v[34:35], v[34:35], s[42:43], v[10:11]
    v_pk_mul_f32 v[32:33], v[32:33], v[144:145]
    v_pk_mul_f32 v[34:35], v[34:35], v[146:147]
    v_exp_f32 v32, v32
    v_exp_f32 v33, v33
    v_exp_f32 v34, v34
    v_exp_f32 v35, v35
    s_nop 0
    v_pk_add_f32 v[32:33], v[32:33], 1.0 op_sel_hi:[1,0]
    v_pk_add_f32 v[34:35], v[34:35], 1.0 op_sel_hi:[1,0]
    v_rcp_f32 v32, v32
    v_rcp_f32 v33, v33
    v_rcp_f32 v34, v34
    v_rcp_f32 v35, v35
    s_nop 0
    v_pk_mul_f32 v[32:33], v[32:33], v[144:145]
    v_pk_mul_f32 v[34:35], v[34:35], v[146:147]
    v_cvt_pk_bf16_f32 v32, 0, v32
    v_cvt_pk_bf16_f32 v33, 0, v33
    v_cvt_pk_bf16_f32 v34, 0, v34
    v_cvt_pk_bf16_f32 v35, 0, v35
    v_pk_mul_f32 v[32:33], v[32:33], v[156:157]
    v_pk_mul_f32 v[34:35], v[34:35], v[158:159]
    v_cvt_pk_bf16_f32 v52, v32, v33
    v_cvt_pk_bf16_f32 v53, v34, v35
    s_nop 1
    v_permlane16_swap_b32 v48, v50
    v_permlane16_swap_b32 v49, v51
    global_store_dwordx4 v6, v[48:51], s[36:37] offset:128
    global_store_dwordx2 v7, v[52:53], s[36:37] offset:192
    v_cvt_pk_bf16_f32 v56, v160, v161
    v_cvt_pk_bf16_f32 v57, v162, v163
    v_cvt_pk_bf16_f32 v58, v164, v165
    v_cvt_pk_bf16_f32 v59, v166, v167
    s_nop 1
    v_permlane16_swap_b32 v56, v58
    v_permlane16_swap_b32 v57, v59
    v_add_u32 v1, 131072, v8
    global_store_dwordx4 v1, v[56:59], s[38:39]
    v_cvt_pk_bf16_f32 v60, v168, v169
    v_cvt_pk_bf16_f32 v61, v170, v171
    v_cvt_pk_bf16_f32 v62, v172, v173
    v_cvt_pk_bf16_f32 v63, v174, v175
    s_nop 1
    v_permlane16_swap_b32 v60, v62
    v_permlane16_swap_b32 v61, v63
    v_add_u32 v1, 262144, v8
    global_store_dwordx4 v1, v[60:63], s[38:39]
    v_add_u32 v6, 114688, v6
    v_add_u32 v7, 114688, v7
    v_add_u32 v8, 1024, v8
    s_nop 1
    v_cvt_pk_bf16_f32 v176, 0, v176
    v_cvt_pk_bf16_f32 v177, 0, v177
    v_cvt_pk_bf16_f32 v178, 0, v178
    v_cvt_pk_bf16_f32 v179, 0, v179
    v_cvt_pk_bf16_f32 v188, 0, v188
    v_cvt_pk_bf16_f32 v189, 0, v189
    v_cvt_pk_bf16_f32 v190, 0, v190
    v_cvt_pk_bf16_f32 v191, 0, v191
    v_pk_mul_f32 v[32:33], v[176:177], v[176:177]
    v_pk_mul_f32 v[34:35], v[178:179], v[178:179]
    v_pk_fma_f32 v[32:33], v[32:33], s[42:43], v[10:11]
    v_pk_fma_f32 v[34:35], v[34:35], s[42:43], v[10:11]
    v_pk_mul_f32 v[32:33], v[32:33], v[176:177]
    v_pk_mul_f32 v[34:35], v[34:35], v[178:179]
    v_exp_f32 v32, v32
    v_exp_f32 v33, v33
    v_exp_f32 v34, v34
    v_exp_f32 v35, v35
    s_nop 0
    v_pk_add_f32 v[32:33], v[32:33], 1.0 op_sel_hi:[1,0]
    v_pk_add_f32 v[34:35], v[34:35], 1.0 op_sel_hi:[1,0]
    v_rcp_f32 v32, v32
    v_rcp_f32 v33, v33
    v_rcp_f32 v34, v34
    v_rcp_f32 v35, v35
    s_nop 0
    v_pk_mul_f32 v[32:33], v[32:33], v[176:177]
    v_pk_mul_f32 v[34:35], v[34:35], v[178:179]
    v_cvt_pk_bf16_f32 v32, 0, v32
    v_cvt_pk_bf16_f32 v33, 0, v33
    v_cvt_pk_bf16_f32 v34, 0, v34
    v_cvt_pk_bf16_f32 v35, 0, v35
    v_pk_mul_f32 v[32:33], v[32:33], v[188:189]
    v_pk_mul_f32 v[34:35], v[34:35], v[190:191]
    v_cvt_pk_bf16_f32 v48, v32, v33
    v_cvt_pk_bf16_f32 v49, v34, v35
    v_cvt_pk_bf16_f32 v180, 0, v180
    v_cvt_pk_bf16_f32 v181, 0, v181
    v_cvt_pk_bf16_f32 v182, 0, v182
    v_cvt_pk_bf16_f32 v183, 0, v183
    v_cvt_pk_bf16_f32 v192, 0, v192
    v_cvt_pk_bf16_f32 v193, 0, v193
    v_cvt_pk_bf16_f32 v194, 0, v194
    v_cvt_pk_bf16_f32 v195, 0, v195
    v_pk_mul_f32 v[36:37], v[180:181], v[180:181]
    v_pk_mul_f32 v[38:39], v[182:183], v[182:183]
    v_pk_fma_f32 v[36:37], v[36:37], s[42:43], v[10:11]
    v_pk_fma_f32 v[38:39], v[38:39], s[42:43], v[10:11]
    v_pk_mul_f32 v[36:37], v[36:37], v[180:181]
    v_pk_mul_f32 v[38:39], v[38:39], v[182:183]
    v_exp_f32 v36, v36
    v_exp_f32 v37, v37
    v_exp_f32 v38, v38
    v_exp_f32 v39, v39
    s_nop 0
    v_pk_add_f32 v[36:37], v[36:37], 1.0 op_sel_hi:[1,0]
    v_pk_add_f32 v[38:39], v[38:39], 1.0 op_sel_hi:[1,0]
    v_rcp_f32 v36, v36
    v_rcp_f32 v37, v37
    v_rcp_f32 v38, v38
    v_rcp_f32 v39, v39
    s_nop 0
    v_pk_mul_f32 v[36:37], v[36:37], v[180:181]
    v_pk_mul_f32 v[38:39], v[38:39], v[182:183]
    v_cvt_pk_bf16_f32 v36, 0, v36
    v_cvt_pk_bf16_f32 v37, 0, v37
    v_cvt_pk_bf16_f32 v38, 0, v38
    v_cvt_pk_bf16_f32 v39, 0, v39
    v_pk_mul_f32 v[36:37], v[36:37], v[192:193]
    v_pk_mul_f32 v[38:39], v[38:39], v[194:195]
    v_cvt_pk_bf16_f32 v50, v36, v37
    v_cvt_pk_bf16_f32 v51, v38, v39
    v_cvt_pk_bf16_f32 v184, 0, v184
    v_cvt_pk_bf16_f32 v185, 0, v185
    v_cvt_pk_bf16_f32 v186, 0, v186
    v_cvt_pk_bf16_f32 v187, 0, v187
    v_cvt_pk_bf16_f32 v196, 0, v196
    v_cvt_pk_bf16_f32 v197, 0, v197
    v_cvt_pk_bf16_f32 v198, 0, v198
    v_cvt_pk_bf16_f32 v199, 0, v199
    v_pk_mul_f32 v[32:33], v[184:185], v[184:185]
    v_pk_mul_f32 v[34:35], v[186:187], v[186:187]
    v_pk_fma_f32 v[32:33], v[32:33], s[42:43], v[10:11]
    v_pk_fma_f32 v[34:35], v[34:35], s[42:43], v[10:11]
    v_pk_mul_f32 v[32:33], v[32:33], v[184:185]
    v_pk_mul_f32 v[34:35], v[34:35], v[186:187]
    v_exp_f32 v32, v32
    v_exp_f32 v33, v33
    v_exp_f32 v34, v34
    v_exp_f32 v35, v35
    s_nop 0
    v_pk_add_f32 v[32:33], v[32:33], 1.0 op_sel_hi:[1,0]
    v_pk_add_f32 v[34:35], v[34:35], 1.0 op_sel_hi:[1,0]
    v_rcp_f32 v32, v32
    v_rcp_f32 v33, v33
    v_rcp_f32 v34, v34
    v_rcp_f32 v35, v35
    s_nop 0
    v_pk_mul_f32 v[32:33], v[32:33], v[184:185]
    v_pk_mul_f32 v[34:35], v[34:35], v[186:187]
    v_cvt_pk_bf16_f32 v32, 0, v32
    v_cvt_pk_bf16_f32 v33, 0, v33
    v_cvt_pk_bf16_f32 v34, 0, v34
    v_cvt_pk_bf16_f32 v35, 0, v35
    v_pk_mul_f32 v[32:33], v[32:33], v[196:197]
    v_pk_mul_f32 v[34:35], v[34:35], v[198:199]
    v_cvt_pk_bf16_f32 v52, v32, v33
    v_cvt_pk_bf16_f32 v53, v34, v35
    s_nop 1
    v_permlane16_swap_b32 v48, v50
    v_permlane16_swap_b32 v49, v51
    global_store_dwordx4 v6, v[48:51], s[36:37] offset:128
    global_store_dwordx2 v7, v[52:53], s[36:37] offset:192
    v_cvt_pk_bf16_f32 v56, v200, v201
    v_cvt_pk_bf16_f32 v57, v202, v203
    v_cvt_pk_bf16_f32 v58, v204, v205
    v_cvt_pk_bf16_f32 v59, v206, v207
    s_nop 1
    v_permlane16_swap_b32 v56, v58
    v_permlane16_swap_b32 v57, v59
    v_add_u32 v1, 131072, v8
    global_store_dwordx4 v1, v[56:59], s[38:39]
    v_cvt_pk_bf16_f32 v60, v208, v209
    v_cvt_pk_bf16_f32 v61, v210, v211
    v_cvt_pk_bf16_f32 v62, v212, v213
    v_cvt_pk_bf16_f32 v63, v214, v215
    s_nop 1
    v_permlane16_swap_b32 v60, v62
    v_permlane16_swap_b32 v61, v63
    v_add_u32 v1, 262144, v8
    global_store_dwordx4 v1, v[60:63], s[38:39]
    v_add_u32 v6, 114688, v6
    v_add_u32 v7, 114688, v7
    v_add_u32 v8, 1024, v8
    s_nop 1
    v_cvt_pk_bf16_f32 v216, 0, v216
    v_cvt_pk_bf16_f32 v217, 0, v217
    v_cvt_pk_bf16_f32 v218, 0, v218
    v_cvt_pk_bf16_f32 v219, 0, v219
    v_cvt_pk_bf16_f32 v228, 0, v228
    v_cvt_pk_bf16_f32 v229, 0, v229
    v_cvt_pk_bf16_f32 v230, 0, v230
    v_cvt_pk_bf16_f32 v231, 0, v231
    v_pk_mul_f32 v[32:33], v[216:217], v[216:217]
    v_pk_mul_f32 v[34:35], v[218:219], v[218:219]
    v_pk_fma_f32 v[32:33], v[32:33], s[42:43], v[10:11]
    v_pk_fma_f32 v[34:35], v[34:35], s[42:43], v[10:11]
    v_pk_mul_f32 v[32:33], v[32:33], v[216:217]
    v_pk_mul_f32 v[34:35], v[34:35], v[218:219]
    v_exp_f32 v32, v32
    v_exp_f32 v33, v33
    v_exp_f32 v34, v34
    v_exp_f32 v35, v35
    s_nop 0
    v_pk_add_f32 v[32:33], v[32:33], 1.0 op_sel_hi:[1,0]
    v_pk_add_f32 v[34:35], v[34:35], 1.0 op_sel_hi:[1,0]
    v_rcp_f32 v32, v32
    v_rcp_f32 v33, v33
    v_rcp_f32 v34, v34
    v_rcp_f32 v35, v35
    s_nop 0
    v_pk_mul_f32 v[32:33], v[32:33], v[216:217]
    v_pk_mul_f32 v[34:35], v[34:35], v[218:219]
    v_cvt_pk_bf16_f32 v32, 0, v32
    v_cvt_pk_bf16_f32 v33, 0, v33
    v_cvt_pk_bf16_f32 v34, 0, v34
    v_cvt_pk_bf16_f32 v35, 0, v35
    v_pk_mul_f32 v[32:33], v[32:33], v[228:229]
    v_pk_mul_f32 v[34:35], v[34:35], v[230:231]
    v_cvt_pk_bf16_f32 v48, v32, v33
    v_cvt_pk_bf16_f32 v49, v34, v35
    v_cvt_pk_bf16_f32 v220, 0, v220
    v_cvt_pk_bf16_f32 v221, 0, v221
    v_cvt_pk_bf16_f32 v222, 0, v222
    v_cvt_pk_bf16_f32 v223, 0, v223
    v_cvt_pk_bf16_f32 v232, 0, v232
    v_cvt_pk_bf16_f32 v233, 0, v233
    v_cvt_pk_bf16_f32 v234, 0, v234
    v_cvt_pk_bf16_f32 v235, 0, v235
    v_pk_mul_f32 v[36:37], v[220:221], v[220:221]
    v_pk_mul_f32 v[38:39], v[222:223], v[222:223]
    v_pk_fma_f32 v[36:37], v[36:37], s[42:43], v[10:11]
    v_pk_fma_f32 v[38:39], v[38:39], s[42:43], v[10:11]
    v_pk_mul_f32 v[36:37], v[36:37], v[220:221]
    v_pk_mul_f32 v[38:39], v[38:39], v[222:223]
    v_exp_f32 v36, v36
    v_exp_f32 v37, v37
    v_exp_f32 v38, v38
    v_exp_f32 v39, v39
    s_nop 0
    v_pk_add_f32 v[36:37], v[36:37], 1.0 op_sel_hi:[1,0]
    v_pk_add_f32 v[38:39], v[38:39], 1.0 op_sel_hi:[1,0]
    v_rcp_f32 v36, v36
    v_rcp_f32 v37, v37
    v_rcp_f32 v38, v38
    v_rcp_f32 v39, v39
    s_nop 0
    v_pk_mul_f32 v[36:37], v[36:37], v[220:221]
    v_pk_mul_f32 v[38:39], v[38:39], v[222:223]
    v_cvt_pk_bf16_f32 v36, 0, v36
    v_cvt_pk_bf16_f32 v37, 0, v37
    v_cvt_pk_bf16_f32 v38, 0, v38
    v_cvt_pk_bf16_f32 v39, 0, v39
    v_pk_mul_f32 v[36:37], v[36:37], v[232:233]
    v_pk_mul_f32 v[38:39], v[38:39], v[234:235]
    v_cvt_pk_bf16_f32 v50, v36, v37
    v_cvt_pk_bf16_f32 v51, v38, v39
    v_cvt_pk_bf16_f32 v224, 0, v224
    v_cvt_pk_bf16_f32 v225, 0, v225
    v_cvt_pk_bf16_f32 v226, 0, v226
    v_cvt_pk_bf16_f32 v227, 0, v227
    v_cvt_pk_bf16_f32 v236, 0, v236
    v_cvt_pk_bf16_f32 v237, 0, v237
    v_cvt_pk_bf16_f32 v238, 0, v238
    v_cvt_pk_bf16_f32 v239, 0, v239
    v_pk_mul_f32 v[32:33], v[224:225], v[224:225]
    v_pk_mul_f32 v[34:35], v[226:227], v[226:227]
    v_pk_fma_f32 v[32:33], v[32:33], s[42:43], v[10:11]
    v_pk_fma_f32 v[34:35], v[34:35], s[42:43], v[10:11]
    v_pk_mul_f32 v[32:33], v[32:33], v[224:225]
    v_pk_mul_f32 v[34:35], v[34:35], v[226:227]
    v_exp_f32 v32, v32
    v_exp_f32 v33, v33
    v_exp_f32 v34, v34
    v_exp_f32 v35, v35
    s_nop 0
    v_pk_add_f32 v[32:33], v[32:33], 1.0 op_sel_hi:[1,0]
    v_pk_add_f32 v[34:35], v[34:35], 1.0 op_sel_hi:[1,0]
    v_rcp_f32 v32, v32
    v_rcp_f32 v33, v33
    v_rcp_f32 v34, v34
    v_rcp_f32 v35, v35
    s_nop 0
    v_pk_mul_f32 v[32:33], v[32:33], v[224:225]
    v_pk_mul_f32 v[34:35], v[34:35], v[226:227]
    v_cvt_pk_bf16_f32 v32, 0, v32
    v_cvt_pk_bf16_f32 v33, 0, v33
    v_cvt_pk_bf16_f32 v34, 0, v34
    v_cvt_pk_bf16_f32 v35, 0, v35
    v_pk_mul_f32 v[32:33], v[32:33], v[236:237]
    v_pk_mul_f32 v[34:35], v[34:35], v[238:239]
    v_cvt_pk_bf16_f32 v52, v32, v33
    v_cvt_pk_bf16_f32 v53, v34, v35
    s_nop 1
    v_permlane16_swap_b32 v48, v50
    v_permlane16_swap_b32 v49, v51
    global_store_dwordx4 v6, v[48:51], s[36:37] offset:128
    global_store_dwordx2 v7, v[52:53], s[36:37] offset:192
    v_cvt_pk_bf16_f32 v56, v240, v241
    v_cvt_pk_bf16_f32 v57, v242, v243
    v_cvt_pk_bf16_f32 v58, v244, v245
    v_cvt_pk_bf16_f32 v59, v246, v247
    s_nop 1
    v_permlane16_swap_b32 v56, v58
    v_permlane16_swap_b32 v57, v59
    v_add_u32 v1, 131072, v8
    global_store_dwordx4 v1, v[56:59], s[38:39]
    v_cvt_pk_bf16_f32 v60, v248, v249
    v_cvt_pk_bf16_f32 v61, v250, v251
    v_cvt_pk_bf16_f32 v62, v252, v253
    v_cvt_pk_bf16_f32 v63, v254, v255
    s_nop 1
    v_permlane16_swap_b32 v60, v62
    v_permlane16_swap_b32 v61, v63
    v_add_u32 v1, 262144, v8
    global_store_dwordx4 v1, v[60:63], s[38:39]
    s_endpgm
L1_end:
    s_endpgm
.globl fused_kernel
.p2align 8
.type fused_kernel,@function
fused_kernel:
    s_cmp_ge_u32 s2, 256
    s_cbranch_scc1 LA_end
    s_load_dwordx2 s[4:5], s[0:1], 16
    s_load_dwordx2 s[6:7], s[0:1], 48
    s_load_dwordx2 s[8:9], s[0:1], 64
    s_load_dwordx2 s[12:13], s[0:1], 80
    v_lshrrev_b32 v1, 6, v0
    v_and_b32 v0, 63, v0
    s_nop 0
    v_readfirstlane_b32 s14, v1
    s_and_b32 s33, s2, 7
    s_lshr_b32 s34, s2, 3
    s_and_b32 s35, s34, 3
    s_lshl_b32 s57, s33, 2
    s_add_u32 s57, s57, s35
    s_lshr_b32 s60, s34, 2
    s_lshl_b32 s61, s60, 8
    s_and_b32 s37, s14, 7
    s_lshl_b32 s58, s37, 5
    s_add_u32 s58, s58, s61
    s_sub_u32 s59, s58, 256
    s_and_b32 s19, s34, 1
    s_lshr_b32 s34, s34, 1
    s_lshr_b32 s35, s33, 1
    s_lshl_b32 s35, s35, 2
    s_and_b32 s36, s34, 3
    s_add_u32 s16, s35, s36
    s_and_b32 s35, s33, 1
    s_lshl_b32 s35, s35, 2
    s_lshr_b32 s36, s34, 2
    s_add_u32 s15, s35, s36
    s_and_b32 s17, s14, 1
    s_lshr_b32 s18, s37, 1
    v_and_b32 v2, 15, v0
    v_lshrrev_b32 v3, 4, v0
    s_cmp_ge_u32 s14, 8
    s_cbranch_scc1 LA_att
    v_lshrrev_b32 v6, 3, v0
    v_and_b32 v7, 7, v0
    s_lshl_b32 s33, s37, 4
    s_add_u32 s34, s33, 0
    v_add_u32 v4, s34, v6
    v_bfe_u32 v5, v4, 1, 3
    v_xor_b32 v5, v5, v7
    v_lshlrev_b32 v5, 4, v5
    v_mul_u32_u24 v4, 7168, v4
    v_add_u32 v10, v4, v5
    s_add_u32 s34, s33, 8
    v_add_u32 v4, s34, v6
    v_bfe_u32 v5, v4, 1, 3
    v_xor_b32 v5, v5, v7
    v_lshlrev_b32 v5, 4, v5
    v_mul_u32_u24 v4, 7168, v4
    v_add_u32 v11, v4, v5
    s_lshr_b32 s33, s37, 2
    s_lshl_b32 s33, s33, 6
    s_lshl_b32 s34, s19, 5
    s_add_u32 s33, s33, s34
    s_and_b32 s34, s37, 3
    s_lshl_b32 s34, s34, 3
    s_add_u32 s33, s33, s34
    v_add_u32 v4, s33, v6
    v_bfe_u32 v5, v4, 1, 3
    v_xor_b32 v5, v5, v7
    v_lshlrev_b32 v5, 4, v5
    v_lshl_add_u32 v14, v4, 11, v5
    s_lshl_b32 s31, s33, 7
    s_lshl_b32 s33, s37, 3
    s_add_u32 s34, s33, 0
    v_add_u32 v4, s34, v3
    v_and_b32 v5, 3, v4
    v_bfe_u32 v6, v4, 3, 1
    v_lshl_add_u32 v5, v6, 2, v5
    v_lshlrev_b32 v5, 1, v5
    v_xor_b32 v5, v5, v2
    v_lshlrev_b32 v5, 4, v5
    v_lshl_add_u32 v12, v4, 11, v5
    s_add_u32 s34, s33, 4
    v_add_u32 v4, s34, v3
    v_and_b32 v5, 3, v4
    v_bfe_u32 v6, v4, 3, 1
    v_lshl_add_u32 v5, v6, 2, v5
    v_lshlrev_b32 v5, 1, v5
    v_xor_b32 v5, v5, v2
    v_lshlrev_b32 v5, 4, v5
    v_lshl_add_u32 v13, v4, 11, v5
    s_lshl_b32 s20, s37, 11
    s_add_u32 s21, s20, 49152
    s_waitcnt lgkmcnt(0)
    s_lshl_b32 s33, s16, 18
    s_add_u32 s33, s33, 33554432
    s_add_u32 s22, s12, s33
    s_addc_u32 s23, s13, 0
    s_mul_i32 s33, s16, 917504
    s_add_u32 s33, s33, 16777216
    s_mul_i32 s34, s19, 3584
    s_add_u32 s33, s33, s34
    s_add_u32 s24, s12, s33
    s_addc_u32 s25, s13, 0
    s_lshl_b32 s33, s15, 8
    s_add_u32 s26, s4, s33
    s_addc_u32 s27, s5, 0
    s_mul_i32 s34, s19, 3670016
    s_add_u32 s33, s33, s34
    s_add_u32 s28, s6, s33
    s_addc_u32 s29, s7, 0
    s_add_u32 m0, s21, 0
    s_nop 0
    global_load_lds_dwordx4 v12, s[28:29]
    s_add_u32 m0, s20, 0
    s_nop 0
    global_load_lds_dwordx4 v10, s[24:25]
    s_add_u32 m0, s21, 1024
    s_nop 0
    global_load_lds_dwordx4 v13, s[28:29]
    s_add_u32 s28, s28, 131072
    s_addc_u32 s29, s29, 0
    s_add_u32 m0, s20, 1024
    s_nop 0
    global_load_lds_dwordx4 v11, s[24:25]
    s_add_u32 s24, s24, 128
    s_addc_u32 s25, s25, 0
    s_add_u32 m0, s21, 16384
    s_nop 0
    global_load_lds_dwordx4 v12, s[28:29]
    s_add_u32 m0, s20, 16384
    s_nop 0
    global_load_lds_dwordx4 v10, s[24:25]
    s_add_u32 m0, s21, 17408
    s_nop 0
    global_load_lds_dwordx4 v13, s[28:29]
    s_add_u32 s28, s28, 131072
    s_addc_u32 s29, s29, 0
    s_add_u32 m0, s20, 17408
    s_nop 0
    global_load_lds_dwordx4 v11, s[24:25]
    s_add_u32 s24, s24, 128
    s_addc_u32 s25, s25, 0
    s_add_u32 m0, s21, 32768
    s_nop 0
    global_load_lds_dwordx4 v12, s[28:29]
    s_add_u32 m0, s20, 32768
    s_nop 0
    global_load_lds_dwordx4 v10, s[24:25]
    s_add_u32 m0, s21, 33792
    s_nop 0
    global_load_lds_dwordx4 v13, s[28:29]
    s_add_u32 s28, s28, 131072
    s_addc_u32 s29, s29, 0
    s_add_u32 m0, s20, 33792
    s_nop 0
    global_load_lds_dwordx4 v11, s[24:25]
    s_add_u32 s24, s24, 128
    s_addc_u32 s25, s25, 0
    v_and_b32 v4, 1, v3
    v_lshlrev_b32 v4, 5, v4
    v_lshrrev_b32 v5, 1, v3
    v_lshl_add_u32 v1, v5, 4, v4
    s_lshl_b32 s33, s16, 7
    s_lshl_b32 s34, s17, 6
    s_add_u32 s33, s33, s34
    s_lshl_b32 s34, s19, 5
    s_add_u32 s30, s33, s34
    v_add_u32 v4, s30, v2
    v_lshlrev_b32 v4, 2, v4
    v_add_u32 v4, 41943040, v4
    global_load_dword v20, v4, s[12:13]
    global_load_dword v21, v4, s[12:13] offset:64
    v_lshrrev_b32 v4, 1, v2
    v_xor_b32 v4, v4, v3
    v_lshlrev_b32 v4, 4, v4
    v_lshl_add_u32 v4, v2, 7, v4
    s_lshl_b32 s33, s17, 13
    v_add_u32 v16, s33, v4
    v_xor_b32 v17, 64, v16
    v_bfe_u32 v4, v0, 2, 2
    v_lshl_add_u32 v5, v3, 3, v4
    v_lshlrev_b32 v5, 8, v5
    v_and_b32 v6, 3, v0
    v_lshl_add_u32 v5, v6, 3, v5
    v_add_u32 v5, 49152, v5
    v_and_b32 v6, 1, v3
    v_lshl_add_u32 v4, v6, 2, v4
    s_lshl_b32 s33, s18, 1
    s_add_u32 s34, s33, 0
    v_xor_b32 v6, s34, v4
    v_lshl_add_u32 v18, v6, 5, v5
    s_add_u32 s34, s33, 1
    v_xor_b32 v6, s34, v4
    v_lshl_add_u32 v19, v6, 5, v5
    v_add_u32 v120, 98304, v16
    v_add_u32 v122, 65536, v18
    v_add_u32 v121, 98304, v17
    v_add_u32 v123, 65536, v19
    s_cmp_eq_u32 s19, 1
    s_cbranch_scc1 LA_g1
    s_branch LA_g0
LA_att:
    s_waitcnt lgkmcnt(0)
    s_lshl_b32 s33, s57, 17
    s_add_u32 s62, s12, s33
    s_addc_u32 s63, s13, 0
    s_add_u32 s64, s62, 4194304
    s_addc_u32 s65, s63, 0
    s_add_u32 s66, s62, 8388608
    s_addc_u32 s67, s63, 0
    v_lshlrev_b32 v20, 4, v3
    v_add_u32 v21, s58, v2
    v_lshl_add_u32 v8, v21, 6, v20
    global_load_dwordx4 v[100:103], v8, s[62:63]
    v_lshrrev_b32 v22, 2, v0
    v_and_b32 v23, 3, v0
    s_mov_b32 s56, 0x78
    v_lshlrev_b32 v24, 1, v3
    v_lshrrev_b32 v24, v24, s56
    v_and_b32 v24, 3, v24
    v_xor_b32 v24, v24, v23
    v_lshlrev_b32 v25, 4, v24
    v_and_b32 v24, 1, v3
    v_lshlrev_b32 v24, 1, v24
    v_xor_b32 v24, v24, v23
    v_lshlrev_b32 v26, 4, v24
    s_lshl_b32 s33, s37, 6
    s_add_u32 s33, s33, s61
    s_sub_u32 s33, s33, 256
    v_add_u32 v22, s33, v22
    s_lshl_b32 s34, s37, 12
    v_add_u32 v27, 0, v22
    v_max_i32 v27, 0, v27
    v_lshl_add_u32 v28, v27, 6, v25
    s_add_u32 m0, s34, 131072
    s_nop 0
    global_load_lds_dwordx4 v28, s[64:65]
    v_add_u32 v27, 16, v22
    v_max_i32 v27, 0, v27
    v_lshl_add_u32 v28, v27, 6, v25
    s_add_u32 m0, s34, 132096
    s_nop 0
    global_load_lds_dwordx4 v28, s[64:65]
    v_add_u32 v27, 32, v22
    v_max_i32 v27, 0, v27
    v_lshl_add_u32 v28, v27, 6, v25
    s_add_u32 m0, s34, 133120
    s_nop 0
    global_load_lds_dwordx4 v28, s[64:65]
    v_add_u32 v27, 48, v22
    v_max_i32 v27, 0, v27
    v_lshl_add_u32 v28, v27, 6, v25
    s_add_u32 m0, s34, 134144
    s_nop 0
    global_load_lds_dwordx4 v28, s[64:65]
    v_add_u32 v27, 0, v22
    v_max_i32 v27, 0, v27
    v_lshl_add_u32 v28, v27, 6, v26
    s_add_u32 m0, s34, 98304
    s_nop 0
    global_load_lds_dwordx4 v28, s[66:67]
    v_add_u32 v27, 16, v22
    v_max_i32 v27, 0, v27
    v_lshl_add_u32 v28, v27, 6, v26
    s_add_u32 m0, s34, 99328
    s_nop 0
    global_load_lds_dwordx4 v28, s[66:67]
    v_add_u32 v27, 32, v22
    v_max_i32 v27, 0, v27
    v_lshl_add_u32 v28, v27, 6, v26
    s_add_u32 m0, s34, 100352
    s_nop 0
    global_load_lds_dwordx4 v28, s[66:67]
    v_add_u32 v27, 48, v22
    v_max_i32 v27, 0, v27
    v_lshl_add_u32 v28, v27, 6, v26
    s_add_u32 m0, s34, 101376
    s_nop 0
    global_load_lds_dwordx4 v28, s[66:67]
    v_lshlrev_b32 v20, 2, v3
    v_add_u32 v21, 0, v20
    v_cmp_gt_u32 s[40:41], v21, v2
    v_cmp_le_u32 s[48:49], v21, v2
    v_add_u32 v21, 1, v20
    v_cmp_gt_u32 s[42:43], v21, v2
    v_cmp_le_u32 s[50:51], v21, v2
    v_add_u32 v21, 2, v20
    v_cmp_gt_u32 s[44:45], v21, v2
    v_cmp_le_u32 s[52:53], v21, v2
    v_add_u32 v21, 3, v20
    v_cmp_gt_u32 s[46:47], v21, v2
    v_cmp_le_u32 s[54:55], v21, v2
    v_lshrrev_b32 v20, 2, v2
    v_lshlrev_b32 v20, 1, v20
    v_lshrrev_b32 v20, v20, s56
    v_and_b32 v20, 3, v20
    v_xor_b32 v20, v20, v3
    v_lshlrev_b32 v20, 4, v20
    s_lshl_b32 s33, s37, 5
    v_add_u32 v21, s33, v2
    v_lshl_add_u32 v20, v21, 6, v20
    v_add_u32 v4, 131072, v20
    v_bfe_u32 v20, v0, 2, 2
    v_lshl_add_u32 v20, v3, 2, v20
    v_add_u32 v20, s33, v20
    v_lshlrev_b32 v20, 6, v20
    v_and_b32 v21, 3, v0
    v_lshl_add_u32 v20, v21, 3, v20
    v_add_u32 v20, 98304, v20
    v_and_b32 v21, 1, v3
    v_lshlrev_b32 v21, 5, v21
    v_add_u32 v5, v20, v21
    v_sub_u32 v22, v20, v21
    v_add_u32 v6, 32, v22
    v_lshrrev_b32 v20, 1, v3
    v_lshl_add_u32 v20, v20, 4, v21
    v_add_u32 v22, s58, v2
    v_lshl_add_u32 v7, v22, 11, v20
    s_lshl_b32 s33, s57, 6
    s_add_u32 s33, s33, 33554432
    s_add_u32 s68, s12, s33
    s_addc_u32 s69, s13, 0
    s_mov_b32 s70, 0x3e3504f3
    s_mov_b32 s71, s70
    s_mov_b32 s72, 0x3fb8aa3b
    s_mov_b32 s73, s72
    v_mov_b32 v112, 0xf149f2ca
    s_barrier
    s_waitcnt vmcnt(0)
    s_barrier
    s_mov_b32 s32, 2
LA_la:
    ds_read_b128 v[84:87], v4 offset:0
    ds_read_b128 v[88:91], v4 offset:1024
    ds_read_b128 v[92:95], v4 offset:2048
    s_waitcnt vmcnt(1)
    s_waitcnt lgkmcnt(2)
    v_mfma_f32_16x16x32_bf16 v[16:19], v[84:87], v[100:103], 0
    ds_read_b128 v[96:99], v4 offset:3072
    s_waitcnt lgkmcnt(2)
    v_mfma_f32_16x16x32_bf16 v[20:23], v[88:91], v[100:103], 0
    ds_read_b128 v[84:87], v4 offset:4096
    s_waitcnt lgkmcnt(2)
    v_mfma_f32_16x16x32_bf16 v[24:27], v[92:95], v[100:103], 0
    ds_read_b128 v[88:91], v4 offset:5120
    s_waitcnt lgkmcnt(2)
    v_mfma_f32_16x16x32_bf16 v[28:31], v[96:99], v[100:103], 0
    ds_read_b128 v[92:95], v4 offset:6144
    s_waitcnt lgkmcnt(2)
    v_mfma_f32_16x16x32_bf16 v[32:35], v[84:87], v[100:103], 0
    ds_read_b128 v[96:99], v4 offset:7168
    s_waitcnt lgkmcnt(2)
    v_mfma_f32_16x16x32_bf16 v[36:39], v[88:91], v[100:103], 0
    ds_read_b128 v[84:87], v4 offset:8192
    s_waitcnt lgkmcnt(2)
    v_mfma_f32_16x16x32_bf16 v[40:43], v[92:95], v[100:103], 0
    ds_read_b128 v[88:91], v4 offset:9216
    s_waitcnt lgkmcnt(2)
    v_mfma_f32_16x16x32_bf16 v[44:47], v[96:99], v[100:103], 0
    ds_read_b128 v[92:95], v4 offset:10240
    s_waitcnt lgkmcnt(2)
    v_mfma_f32_16x16x32_bf16 v[48:51], v[84:87], v[100:103], 0
    ds_read_b128 v[96:99], v4 offset:11264
    s_waitcnt lgkmcnt(2)
    v_mfma_f32_16x16x32_bf16 v[52:55], v[88:91], v[100:103], 0
    ds_read_b128 v[84:87], v4 offset:12288
    s_waitcnt lgkmcnt(2)
    v_mfma_f32_16x16x32_bf16 v[56:59], v[92:95], v[100:103], 0
    ds_read_b128 v[88:91], v4 offset:13312
    s_waitcnt lgkmcnt(2)
    v_mfma_f32_16x16x32_bf16 v[60:63], v[96:99], v[100:103], 0
    ds_read_b128 v[92:95], v4 offset:14336
    s_waitcnt lgkmcnt(2)
    v_mfma_f32_16x16x32_bf16 v[64:67], v[84:87], v[100:103], 0
    ds_read_b128 v[96:99], v4 offset:15360
    s_waitcnt lgkmcnt(2)
    v_mfma_f32_16x16x32_bf16 v[68:71], v[88:91], v[100:103], 0
    ds_read_b128 v[84:87], v4 offset:16384
    s_waitcnt lgkmcnt(2)
    v_mfma_f32_16x16x32_bf16 v[72:75], v[92:95], v[100:103], 0
    s_waitcnt lgkmcnt(1)
    v_mfma_f32_16x16x32_bf16 v[76:79], v[96:99], v[100:103], 0
    s_waitcnt lgkmcnt(0)
    v_mfma_f32_16x16x32_bf16 v[80:83], v[84:87], v[100:103], 0
    s_nop 7
    v_add_u32 v8, 1024, v8
    global_load_dwordx4 v[100:103], v8, s[62:63]
    v_cvt_pk_bf16_f32 v16, 0, v16
    v_cvt_pk_bf16_f32 v17, 0, v17
    v_cvt_pk_bf16_f32 v18, 0, v18
    v_cvt_pk_bf16_f32 v19, 0, v19
    v_pk_mul_f32 v[16:17], v[16:17], s[70:71]
    v_pk_mul_f32 v[18:19], v[18:19], s[70:71]
    v_cvt_pk_bf16_f32 v16, 0, v16
    v_cvt_pk_bf16_f32 v17, 0, v17
    v_cvt_pk_bf16_f32 v18, 0, v18
    v_cvt_pk_bf16_f32 v19, 0, v19
    v_cndmask_b32 v16, v112, v16, s[40:41]
    v_cndmask_b32 v17, v112, v17, s[42:43]
    v_cndmask_b32 v18, v112, v18, s[44:45]
    v_cndmask_b32 v19, v112, v19, s[46:47]
    v_cvt_pk_bf16_f32 v20, 0, v20
    v_cvt_pk_bf16_f32 v21, 0, v21
    v_cvt_pk_bf16_f32 v22, 0, v22
    v_cvt_pk_bf16_f32 v23, 0, v23
    v_pk_mul_f32 v[20:21], v[20:21], s[70:71]
    v_pk_mul_f32 v[22:23], v[22:23], s[70:71]
    v_cvt_pk_bf16_f32 v20, 0, v20
    v_cvt_pk_bf16_f32 v21, 0, v21
    v_cvt_pk_bf16_f32 v22, 0, v22
    v_cvt_pk_bf16_f32 v23, 0, v23
    v_cvt_pk_bf16_f32 v24, 0, v24
    v_cvt_pk_bf16_f32 v25, 0, v25
    v_cvt_pk_bf16_f32 v26, 0, v26
    v_cvt_pk_bf16_f32 v27, 0, v27
    v_pk_mul_f32 v[24:25], v[24:25], s[70:71]
    v_pk_mul_f32 v[26:27], v[26:27], s[70:71]
    v_cvt_pk_bf16_f32 v24, 0, v24
    v_cvt_pk_bf16_f32 v25, 0, v25
    v_cvt_pk_bf16_f32 v26, 0, v26
    v_cvt_pk_bf16_f32 v27, 0, v27
    v_cvt_pk_bf16_f32 v28, 0, v28
    v_cvt_pk_bf16_f32 v29, 0, v29
    v_cvt_pk_bf16_f32 v30, 0, v30
    v_cvt_pk_bf16_f32 v31, 0, v31
    v_pk_mul_f32 v[28:29], v[28:29], s[70:71]
    s_barrier
    v_pk_mul_f32 v[30:31], v[30:31], s[70:71]
    v_cvt_pk_bf16_f32 v28, 0, v28
    v_cvt_pk_bf16_f32 v29, 0, v29
    v_cvt_pk_bf16_f32 v30, 0, v30
    v_cvt_pk_bf16_f32 v31, 0, v31
    v_cvt_pk_bf16_f32 v32, 0, v32
    v_cvt_pk_bf16_f32 v33, 0, v33
    v_cvt_pk_bf16_f32 v34, 0, v34
    v_cvt_pk_bf16_f32 v35, 0, v35
    v_pk_mul_f32 v[32:33], v[32:33], s[70:71]
    v_pk_mul_f32 v[34:35], v[34:35], s[70:71]
    v_cvt_pk_bf16_f32 v32, 0, v32
    v_cvt_pk_bf16_f32 v33, 0, v33
    v_cvt_pk_bf16_f32 v34, 0, v34
    v_cvt_pk_bf16_f32 v35, 0, v35
    v_cvt_pk_bf16_f32 v36, 0, v36
    v_cvt_pk_bf16_f32 v37, 0, v37
    v_cvt_pk_bf16_f32 v38, 0, v38
    v_cvt_pk_bf16_f32 v39, 0, v39
    v_pk_mul_f32 v[36:37], v[36:37], s[70:71]
    v_pk_mul_f32 v[38:39], v[38:39], s[70:71]
    v_cvt_pk_bf16_f32 v36, 0, v36
    v_cvt_pk_bf16_f32 v37, 0, v37
    v_cvt_pk_bf16_f32 v38, 0, v38
    v_cvt_pk_bf16_f32 v39, 0, v39
    v_cvt_pk_bf16_f32 v40, 0, v40
    v_cvt_pk_bf16_f32 v41, 0, v41
    v_cvt_pk_bf16_f32 v42, 0, v42
    v_cvt_pk_bf16_f32 v43, 0, v43
    v_pk_mul_f32 v[40:41], v[40:41], s[70:71]
    v_pk_mul_f32 v[42:43], v[42:43], s[70:71]
    v_cvt_pk_bf16_f32 v40, 0, v40
    v_cvt_pk_bf16_f32 v41, 0, v41
    v_cvt_pk_bf16_f32 v42, 0, v42
    v_cvt_pk_bf16_f32 v43, 0, v43
    v_cvt_pk_bf16_f32 v44, 0, v44
    v_cvt_pk_bf16_f32 v45, 0, v45
    v_cvt_pk_bf16_f32 v46, 0, v46
    v_cvt_pk_bf16_f32 v47, 0, v47
    v_pk_mul_f32 v[44:45], v[44:45], s[70:71]
    v_pk_mul_f32 v[46:47], v[46:47], s[70:71]
    v_cvt_pk_bf16_f32 v44, 0, v44
    v_cvt_pk_bf16_f32 v45, 0, v45
    v_cvt_pk_bf16_f32 v46, 0, v46
    v_cvt_pk_bf16_f32 v47, 0, v47
    v_cvt_pk_bf16_f32 v48, 0, v48
    v_cvt_pk_bf16_f32 v49, 0, v49
    v_cvt_pk_bf16_f32 v50, 0, v50
    v_cvt_pk_bf16_f32 v51, 0, v51
    v_pk_mul_f32 v[48:49], v[48:49], s[70:71]
    v_pk_mul_f32 v[50:51], v[50:51], s[70:71]
    v_cvt_pk_bf16_f32 v48, 0, v48
    v_cvt_pk_bf16_f32 v49, 0, v49
    v_cvt_pk_bf16_f32 v50, 0, v50
    v_cvt_pk_bf16_f32 v51, 0, v51
    v_cvt_pk_bf16_f32 v52, 0, v52
    v_cvt_pk_bf16_f32 v53, 0, v53
    v_cvt_pk_bf16_f32 v54, 0, v54
    v_cvt_pk_bf16_f32 v55, 0, v55
    v_pk_mul_f32 v[52:53], v[52:53], s[70:71]
    v_pk_mul_f32 v[54:55], v[54:55], s[70:71]
    v_cvt_pk_bf16_f32 v52, 0, v52
    v_cvt_pk_bf16_f32 v53, 0, v53
    v_cvt_pk_bf16_f32 v54, 0, v54
    v_cvt_pk_bf16_f32 v55, 0, v55
    v_cvt_pk_bf16_f32 v56, 0, v56
    v_cvt_pk_bf16_f32 v57, 0, v57
    v_cvt_pk_bf16_f32 v58, 0, v58
    v_cvt_pk_bf16_f32 v59, 0, v59
    v_pk_mul_f32 v[56:57], v[56:57], s[70:71]
    v_pk_mul_f32 v[58:59], v[58:59], s[70:71]
    v_cvt_pk_bf16_f32 v56, 0, v56
    v_cvt_pk_bf16_f32 v57, 0, v57
    v_cvt_pk_bf16_f32 v58, 0, v58
    v_cvt_pk_bf16_f32 v59, 0, v59
    s_barrier
    v_cvt_pk_bf16_f32 v60, 0, v60
    v_cvt_pk_bf16_f32 v61, 0, v61
    v_cvt_pk_bf16_f32 v62, 0, v62
    v_cvt_pk_bf16_f32 v63, 0, v63
    v_pk_mul_f32 v[60:61], v[60:61], s[70:71]
    v_pk_mul_f32 v[62:63], v[62:63], s[70:71]
    v_cvt_pk_bf16_f32 v60, 0, v60
    v_cvt_pk_bf16_f32 v61, 0, v61
    v_cvt_pk_bf16_f32 v62, 0, v62
    v_cvt_pk_bf16_f32 v63, 0, v63
    v_cvt_pk_bf16_f32 v64, 0, v64
    v_cvt_pk_bf16_f32 v65, 0, v65
    v_cvt_pk_bf16_f32 v66, 0, v66
    v_cvt_pk_bf16_f32 v67, 0, v67
    v_pk_mul_f32 v[64:65], v[64:65], s[70:71]
    v_pk_mul_f32 v[66:67], v[66:67], s[70:71]
    v_cvt_pk_bf16_f32 v64, 0, v64
    v_cvt_pk_bf16_f32 v65, 0, v65
    v_cvt_pk_bf16_f32 v66, 0, v66
    v_cvt_pk_bf16_f32 v67, 0, v67
    v_cvt_pk_bf16_f32 v68, 0, v68
    v_cvt_pk_bf16_f32 v69, 0, v69
    v_cvt_pk_bf16_f32 v70, 0, v70
    v_cvt_pk_bf16_f32 v71, 0, v71
    v_pk_mul_f32 v[68:69], v[68:69], s[70:71]
    v_pk_mul_f32 v[70:71], v[70:71], s[70:71]
    v_cvt_pk_bf16_f32 v68, 0, v68
    v_cvt_pk_bf16_f32 v69, 0, v69
    v_cvt_pk_bf16_f32 v70, 0, v70
    v_cvt_pk_bf16_f32 v71, 0, v71
    v_cvt_pk_bf16_f32 v72, 0, v72
    v_cvt_pk_bf16_f32 v73, 0, v73
    v_cvt_pk_bf16_f32 v74, 0, v74
    v_cvt_pk_bf16_f32 v75, 0, v75
    v_pk_mul_f32 v[72:73], v[72:73], s[70:71]
    v_pk_mul_f32 v[74:75], v[74:75], s[70:71]
    v_cvt_pk_bf16_f32 v72, 0, v72
    v_cvt_pk_bf16_f32 v73, 0, v73
    v_cvt_pk_bf16_f32 v74, 0, v74
    v_cvt_pk_bf16_f32 v75, 0, v75
    v_cvt_pk_bf16_f32 v76, 0, v76
    v_cvt_pk_bf16_f32 v77, 0, v77
    v_cvt_pk_bf16_f32 v78, 0, v78
    v_cvt_pk_bf16_f32 v79, 0, v79
    v_pk_mul_f32 v[76:77], v[76:77], s[70:71]
    v_pk_mul_f32 v[78:79], v[78:79], s[70:71]
    v_cvt_pk_bf16_f32 v76, 0, v76
    v_cvt_pk_bf16_f32 v77, 0, v77
    v_cvt_pk_bf16_f32 v78, 0, v78
    v_cvt_pk_bf16_f32 v79, 0, v79
    v_cvt_pk_bf16_f32 v80, 0, v80
    v_cvt_pk_bf16_f32 v81, 0, v81
    v_cvt_pk_bf16_f32 v82, 0, v82
    v_cvt_pk_bf16_f32 v83, 0, v83
    v_pk_mul_f32 v[80:81], v[80:81], s[70:71]
    v_pk_mul_f32 v[82:83], v[82:83], s[70:71]
    v_cvt_pk_bf16_f32 v80, 0, v80
    v_cvt_pk_bf16_f32 v81, 0, v81
    v_cvt_pk_bf16_f32 v82, 0, v82
    v_cvt_pk_bf16_f32 v83, 0, v83
    v_cndmask_b32 v80, v112, v80, s[48:49]
    v_cndmask_b32 v81, v112, v81, s[50:51]
    v_cndmask_b32 v82, v112, v82, s[52:53]
    v_cndmask_b32 v83, v112, v83, s[54:55]
    s_cmp_ge_i32 s59, 0
    s_cbranch_scc1 LA_nn0_0
    s_cmp_ge_i32 s59, 0
    s_cbranch_scc1 LA_nn0_0
    v_mov_b32 v16, v112
    v_mov_b32 v17, v112
    v_mov_b32 v18, v112
    v_mov_b32 v19, v112
    s_cmp_ge_i32 s59, -16
    s_cbranch_scc1 LA_nn0_0
    v_mov_b32 v20, v112
    v_mov_b32 v21, v112
    v_mov_b32 v22, v112
    v_mov_b32 v23, v112
    s_cmp_ge_i32 s59, -32
    s_cbranch_scc1 LA_nn0_0
    v_mov_b32 v24, v112
    v_mov_b32 v25, v112
    v_mov_b32 v26, v112
    v_mov_b32 v27, v112
    s_cmp_ge_i32 s59, -48
    s_cbranch_scc1 LA_nn0_0
    v_mov_b32 v28, v112
    v_mov_b32 v29, v112
    v_mov_b32 v30, v112
    v_mov_b32 v31, v112
    s_cmp_ge_i32 s59, -64
    s_cbranch_scc1 LA_nn0_0
    v_mov_b32 v32, v112
    v_mov_b32 v33, v112
    v_mov_b32 v34, v112
    v_mov_b32 v35, v112
    s_cmp_ge_i32 s59, -80
    s_cbranch_scc1 LA_nn0_0
    v_mov_b32 v36, v112
    v_mov_b32 v37, v112
    v_mov_b32 v38, v112
    v_mov_b32 v39, v112
    s_cmp_ge_i32 s59, -96
    s_cbranch_scc1 LA_nn0_0
    v_mov_b32 v40, v112
    v_mov_b32 v41, v112
    v_mov_b32 v42, v112
    v_mov_b32 v43, v112
    s_cmp_ge_i32 s59, -112
    s_cbranch_scc1 LA_nn0_0
    v_mov_b32 v44, v112
    v_mov_b32 v45, v112
    v_mov_b32 v46, v112
    v_mov_b32 v47, v112
    s_cmp_ge_i32 s59, -128
    s_cbranch_scc1 LA_nn0_0
    v_mov_b32 v48, v112
    v_mov_b32 v49, v112
    v_mov_b32 v50, v112
    v_mov_b32 v51, v112
    s_cmp_ge_i32 s59, -144
    s_cbranch_scc1 LA_nn0_0
    v_mov_b32 v52, v112
    v_mov_b32 v53, v112
    v_mov_b32 v54, v112
    v_mov_b32 v55, v112
    s_cmp_ge_i32 s59, -160
    s_cbranch_scc1 LA_nn0_0
    v_mov_b32 v56, v112
    v_mov_b32 v57, v112
    v_mov_b32 v58, v112
    v_mov_b32 v59, v112
    s_cmp_ge_i32 s59, -176
    s_cbranch_scc1 LA_nn0_0
    v_mov_b32 v60, v112
    v_mov_b32 v61, v112
    v_mov_b32 v62, v112
    v_mov_b32 v63, v112
    s_cmp_ge_i32 s59, -192
    s_cbranch_scc1 LA_nn0_0
    v_mov_b32 v64, v112
    v_mov_b32 v65, v112
    v_mov_b32 v66, v112
    v_mov_b32 v67, v112
    s_cmp_ge_i32 s59, -208
    s_cbranch_scc1 LA_nn0_0
    v_mov_b32 v68, v112
    v_mov_b32 v69, v112
    v_mov_b32 v70, v112
    v_mov_b32 v71, v112
    s_cmp_ge_i32 s59, -224
    s_cbranch_scc1 LA_nn0_0
    v_mov_b32 v72, v112
    v_mov_b32 v73, v112
    v_mov_b32 v74, v112
    v_mov_b32 v75, v112
    s_cmp_ge_i32 s59, -240
    s_cbranch_scc1 LA_nn0_0
    v_mov_b32 v76, v112
    v_mov_b32 v77, v112
    v_mov_b32 v78, v112
    v_mov_b32 v79, v112
LA_nn0_0:
    v_max3_f32 v114, v16, v17, v18
    v_max3_f32 v115, v19, v20, v21
    v_max3_f32 v114, v114, v22, v23
    v_max3_f32 v115, v115, v24, v25
    v_max3_f32 v114, v114, v26, v27
    v_max3_f32 v115, v115, v28, v29
    v_max3_f32 v114, v114, v30, v31
    v_max3_f32 v115, v115, v32, v33
    v_max3_f32 v114, v114, v34, v35
    v_max3_f32 v115, v115, v36, v37
    v_max3_f32 v114, v114, v38, v39
    s_barrier
    v_max3_f32 v115, v115, v40, v41
    v_max3_f32 v114, v114, v42, v43
    v_max3_f32 v115, v115, v44, v45
    v_max3_f32 v114, v114, v46, v47
    v_max3_f32 v115, v115, v48, v49
    v_max3_f32 v114, v114, v50, v51
    v_max3_f32 v115, v115, v52, v53
    v_max3_f32 v114, v114, v54, v55
    v_max3_f32 v115, v115, v56, v57
    v_max3_f32 v114, v114, v58, v59
    v_max3_f32 v115, v115, v60, v61
    v_max3_f32 v114, v114, v62, v63
    v_max3_f32 v115, v115, v64, v65
    v_max3_f32 v114, v114, v66, v67
    v_max3_f32 v115, v115, v68, v69
    v_max3_f32 v114, v114, v70, v71
    v_max3_f32 v115, v115, v72, v73
    v_max3_f32 v114, v114, v74, v75
    v_max3_f32 v115, v115, v76, v77
    v_max3_f32 v114, v114, v78, v79
    v_max3_f32 v115, v115, v80, v81
    v_max3_f32 v114, v114, v82, v83
    v_max_f32 v114, v114, v115
    v_mov_b32 v116, v114
    s_nop 1
    v_permlane16_swap_b32 v116, v114
    s_nop 1
    v_max_f32 v114, v114, v116
    v_mov_b32 v116, v114
    s_nop 1
    v_permlane32_swap_b32 v116, v114
    s_nop 1
    v_max_f32 v114, v114, v116
    v_mul_f32 v114, 0xbfb8aa3b, v114
    v_mov_b32 v115, v114
    v_pk_fma_f32 v[16:17], v[16:17], s[72:73], v[114:115]
    v_pk_fma_f32 v[18:19], v[18:19], s[72:73], v[114:115]
    v_pk_fma_f32 v[20:21], v[20:21], s[72:73], v[114:115]
    v_pk_fma_f32 v[22:23], v[22:23], s[72:73], v[114:115]
    v_pk_fma_f32 v[24:25], v[24:25], s[72:73], v[114:115]
    v_pk_fma_f32 v[26:27], v[26:27], s[72:73], v[114:115]
    v_pk_fma_f32 v[28:29], v[28:29], s[72:73], v[114:115]
    v_pk_fma_f32 v[30:31], v[30:31], s[72:73], v[114:115]
    v_pk_fma_f32 v[32:33], v[32:33], s[72:73], v[114:115]
    v_pk_fma_f32 v[34:35], v[34:35], s[72:73], v[114:115]
    v_pk_fma_f32 v[36:37], v[36:37], s[72:73], v[114:115]
    v_pk_fma_f32 v[38:39], v[38:39], s[72:73], v[114:115]
    v_pk_fma_f32 v[40:41], v[40:41], s[72:73], v[114:115]
    v_pk_fma_f32 v[42:43], v[42:43], s[72:73], v[114:115]
    v_pk_fma_f32 v[44:45], v[44:45], s[72:73], v[114:115]
    v_pk_fma_f32 v[46:47], v[46:47], s[72:73], v[114:115]
    v_pk_fma_f32 v[48:49], v[48:49], s[72:73], v[114:115]
    v_pk_fma_f32 v[50:51], v[50:51], s[72:73], v[114:115]
    v_pk_fma_f32 v[52:53], v[52:53], s[72:73], v[114:115]
    v_pk_fma_f32 v[54:55], v[54:55], s[72:73], v[114:115]
    v_pk_fma_f32 v[56:57], v[56:57], s[72:73], v[114:115]
    v_pk_fma_f32 v[58:59], v[58:59], s[72:73], v[114:115]
    v_pk_fma_f32 v[60:61], v[60:61], s[72:73], v[114:115]
    v_pk_fma_f32 v[62:63], v[62:63], s[72:73], v[114:115]
    v_pk_fma_f32 v[64:65], v[64:65], s[72:73], v[114:115]
    v_pk_fma_f32 v[66:67], v[66:67], s[72:73], v[114:115]
    v_pk_fma_f32 v[68:69], v[68:69], s[72:73], v[114:115]
    v_pk_fma_f32 v[70:71], v[70:71], s[72:73], v[114:115]
    v_pk_fma_f32 v[72:73], v[72:73], s[72:73], v[114:115]
    v_pk_fma_f32 v[74:75], v[74:75], s[72:73], v[114:115]
    v_pk_fma_f32 v[76:77], v[76:77], s[72:73], v[114:115]
    v_pk_fma_f32 v[78:79], v[78:79], s[72:73], v[114:115]
    v_pk_fma_f32 v[80:81], v[80:81], s[72:73], v[114:115]
    v_pk_fma_f32 v[82:83], v[82:83], s[72:73], v[114:115]
    v_exp_f32 v16, v16
    v_exp_f32 v17, v17
    v_exp_f32 v18, v18
    s_barrier
    v_exp_f32 v19, v19
    v_exp_f32 v20, v20
    v_exp_f32 v21, v21
    v_exp_f32 v22, v22
    v_exp_f32 v23, v23
    v_exp_f32 v24, v24
    v_exp_f32 v25, v25
    v_exp_f32 v26, v26
    v_exp_f32 v27, v27
    v_exp_f32 v28, v28
    v_exp_f32 v29, v29
    v_exp_f32 v30, v30
    v_exp_f32 v31, v31
    v_exp_f32 v32, v32
    v_exp_f32 v33, v33
    v_exp_f32 v34, v34
    v_exp_f32 v35, v35
    v_exp_f32 v36, v36
    v_exp_f32 v37, v37
    v_exp_f32 v38, v38
    v_exp_f32 v39, v39
    v_exp_f32 v40, v40
    v_exp_f32 v41, v41
    v_exp_f32 v42, v42
    v_exp_f32 v43, v43
    v_exp_f32 v44, v44
    v_exp_f32 v45, v45
    v_exp_f32 v46, v46
    v_exp_f32 v47, v47
    v_exp_f32 v48, v48
    v_exp_f32 v49, v49
    v_exp_f32 v50, v50
    v_exp_f32 v51, v51
    v_exp_f32 v52, v52
    v_exp_f32 v53, v53
    v_exp_f32 v54, v54
    v_exp_f32 v55, v55
    v_exp_f32 v56, v56
    s_barrier
    v_exp_f32 v57, v57
    v_exp_f32 v58, v58
    v_exp_f32 v59, v59
    v_exp_f32 v60, v60
    v_exp_f32 v61, v61
    v_exp_f32 v62, v62
    v_exp_f32 v63, v63
    v_exp_f32 v64, v64
    v_exp_f32 v65, v65
    v_exp_f32 v66, v66
    v_exp_f32 v67, v67
    v_exp_f32 v68, v68
    v_exp_f32 v69, v69
    v_exp_f32 v70, v70
    v_exp_f32 v71, v71
    v_exp_f32 v72, v72
    v_exp_f32 v73, v73
    v_exp_f32 v74, v74
    v_exp_f32 v75, v75
    v_exp_f32 v76, v76
    v_exp_f32 v77, v77
    v_exp_f32 v78, v78
    v_exp_f32 v79, v79
    v_exp_f32 v80, v80
    v_exp_f32 v81, v81
    v_exp_f32 v82, v82
    v_exp_f32 v83, v83
    s_nop 0
    v_pk_add_f32 v[118:119], v[16:17], v[18:19]
    v_pk_add_f32 v[116:117], v[20:21], v[22:23]
    v_pk_add_f32 v[118:119], v[118:119], v[24:25]
    v_pk_add_f32 v[116:117], v[116:117], v[26:27]
    v_pk_add_f32 v[118:119], v[118:119], v[28:29]
    v_pk_add_f32 v[116:117], v[116:117], v[30:31]
    v_pk_add_f32 v[118:119], v[118:119], v[32:33]
    v_pk_add_f32 v[116:117], v[116:117], v[34:35]
    v_pk_add_f32 v[118:119], v[118:119], v[36:37]
    v_pk_add_f32 v[116:117], v[116:117], v[38:39]
    v_pk_add_f32 v[118:119], v[118:119], v[40:41]
    v_pk_add_f32 v[116:117], v[116:117], v[42:43]
    v_pk_add_f32 v[118:119], v[118:119], v[44:45]
    v_pk_add_f32 v[116:117], v[116:117], v[46:47]
    v_pk_add_f32 v[118:119], v[118:119], v[48:49]
    v_pk_add_f32 v[116:117], v[116:117], v[50:51]
    v_pk_add_f32 v[118:119], v[118:119], v[52:53]
    v_pk_add_f32 v[116:117], v[116:117], v[54:55]
    v_pk_add_f32 v[118:119], v[118:119], v[56:57]
    v_pk_add_f32 v[116:117], v[116:117], v[58:59]
    s_barrier
    v_pk_add_f32 v[118:119], v[118:119], v[60:61]
    v_pk_add_f32 v[116:117], v[116:117], v[62:63]
    v_pk_add_f32 v[118:119], v[118:119], v[64:65]
    v_pk_add_f32 v[116:117], v[116:117], v[66:67]
    v_pk_add_f32 v[118:119], v[118:119], v[68:69]
    v_pk_add_f32 v[116:117], v[116:117], v[70:71]
    v_pk_add_f32 v[118:119], v[118:119], v[72:73]
    v_pk_add_f32 v[116:117], v[116:117], v[74:75]
    v_pk_add_f32 v[118:119], v[118:119], v[76:77]
    v_pk_add_f32 v[116:117], v[116:117], v[78:79]
    v_pk_add_f32 v[118:119], v[118:119], v[80:81]
    v_pk_add_f32 v[116:117], v[116:117], v[82:83]
    v_pk_add_f32 v[118:119], v[118:119], v[116:117]
    v_add_f32 v118, v118, v119
    v_mov_b32 v116, v118
    s_nop 1
    v_permlane16_swap_b32 v116, v118
    s_nop 1
    v_add_f32 v118, v118, v116
    v_mov_b32 v116, v118
    s_nop 1
    v_permlane32_swap_b32 v116, v118
    s_nop 1
    v_add_f32 v118, v118, v116
    v_rcp_f32 v118, v118
    s_nop 0
    v_mov_b32 v119, v118
    v_pk_mul_f32 v[16:17], v[16:17], v[118:119]
    v_pk_mul_f32 v[18:19], v[18:19], v[118:119]
    v_cvt_pk_bf16_f32 v12, v16, v17
    v_cvt_pk_bf16_f32 v13, v18, v19
    v_pk_mul_f32 v[20:21], v[20:21], v[118:119]
    v_pk_mul_f32 v[22:23], v[22:23], v[118:119]
    v_cvt_pk_bf16_f32 v14, v20, v21
    v_cvt_pk_bf16_f32 v15, v22, v23
    v_pk_mul_f32 v[24:25], v[24:25], v[118:119]
    v_pk_mul_f32 v[26:27], v[26:27], v[118:119]
    v_cvt_pk_bf16_f32 v16, v24, v25
    v_cvt_pk_bf16_f32 v17, v26, v27
    v_pk_mul_f32 v[28:29], v[28:29], v[118:119]
    v_pk_mul_f32 v[30:31], v[30:31], v[118:119]
    v_cvt_pk_bf16_f32 v18, v28, v29
    v_cvt_pk_bf16_f32 v19, v30, v31
    v_pk_mul_f32 v[32:33], v[32:33], v[118:119]
    v_pk_mul_f32 v[34:35], v[34:35], v[118:119]
    v_cvt_pk_bf16_f32 v20, v32, v33
    v_cvt_pk_bf16_f32 v21, v34, v35
    v_pk_mul_f32 v[36:37], v[36:37], v[118:119]
    v_pk_mul_f32 v[38:39], v[38:39], v[118:119]
    v_cvt_pk_bf16_f32 v22, v36, v37
    v_cvt_pk_bf16_f32 v23, v38, v39
    v_pk_mul_f32 v[40:41], v[40:41], v[118:119]
    v_pk_mul_f32 v[42:43], v[42:43], v[118:119]
    v_cvt_pk_bf16_f32 v24, v40, v41
    v_cvt_pk_bf16_f32 v25, v42, v43
    v_pk_mul_f32 v[44:45], v[44:45], v[118:119]
    v_pk_mul_f32 v[46:47], v[46:47], v[118:119]
    v_cvt_pk_bf16_f32 v26, v44, v45
    v_cvt_pk_bf16_f32 v27, v46, v47
    v_pk_mul_f32 v[48:49], v[48:49], v[118:119]
    v_pk_mul_f32 v[50:51], v[50:51], v[118:119]
    v_cvt_pk_bf16_f32 v28, v48, v49
    v_cvt_pk_bf16_f32 v29, v50, v51
    v_pk_mul_f32 v[52:53], v[52:53], v[118:119]
    v_pk_mul_f32 v[54:55], v[54:55], v[118:119]
    v_cvt_pk_bf16_f32 v30, v52, v53
    v_cvt_pk_bf16_f32 v31, v54, v55
    v_pk_mul_f32 v[56:57], v[56:57], v[118:119]
    v_pk_mul_f32 v[58:59], v[58:59], v[118:119]
    v_cvt_pk_bf16_f32 v32, v56, v57
    v_cvt_pk_bf16_f32 v33, v58, v59
    v_pk_mul_f32 v[60:61], v[60:61], v[118:119]
    v_pk_mul_f32 v[62:63], v[62:63], v[118:119]
    v_cvt_pk_bf16_f32 v34, v60, v61
    s_barrier
    v_cvt_pk_bf16_f32 v35, v62, v63
    v_pk_mul_f32 v[64:65], v[64:65], v[118:119]
    v_pk_mul_f32 v[66:67], v[66:67], v[118:119]
    v_cvt_pk_bf16_f32 v36, v64, v65
    v_cvt_pk_bf16_f32 v37, v66, v67
    v_pk_mul_f32 v[68:69], v[68:69], v[118:119]
    v_pk_mul_f32 v[70:71], v[70:71], v[118:119]
    v_cvt_pk_bf16_f32 v38, v68, v69
    v_cvt_pk_bf16_f32 v39, v70, v71
    v_pk_mul_f32 v[72:73], v[72:73], v[118:119]
    v_pk_mul_f32 v[74:75], v[74:75], v[118:119]
    v_cvt_pk_bf16_f32 v40, v72, v73
    v_cvt_pk_bf16_f32 v41, v74, v75
    ds_read_b64_tr_b16 v[84:85], v5 offset:0
    ds_read_b64_tr_b16 v[86:87], v5 offset:1024
    v_pk_mul_f32 v[76:77], v[76:77], v[118:119]
    v_pk_mul_f32 v[78:79], v[78:79], v[118:119]
    v_cvt_pk_bf16_f32 v42, v76, v77
    v_cvt_pk_bf16_f32 v43, v78, v79
    ds_read_b64_tr_b16 v[88:89], v6 offset:0
    ds_read_b64_tr_b16 v[90:91], v6 offset:1024
    v_pk_mul_f32 v[80:81], v[80:81], v[118:119]
    v_pk_mul_f32 v[82:83], v[82:83], v[118:119]
    v_cvt_pk_bf16_f32 v44, v80, v81
    v_cvt_pk_bf16_f32 v45, v82, v83
    ds_read_b64_tr_b16 v[92:93], v5 offset:2048
    ds_read_b64_tr_b16 v[94:95], v5 offset:3072
    v_mov_b32 v46, 0
    v_mov_b32 v47, 0
    s_nop 1
    s_waitcnt lgkmcnt(4)
    v_mfma_f32_16x16x32_bf16 v[104:107], v[84:87], v[12:15], 0
    ds_read_b64_tr_b16 v[96:97], v6 offset:2048
    ds_read_b64_tr_b16 v[98:99], v6 offset:3072
    s_waitcnt lgkmcnt(4)
    v_mfma_f32_16x16x32_bf16 v[108:111], v[88:91], v[12:15], 0
    ds_read_b64_tr_b16 v[84:85], v5 offset:4096
    ds_read_b64_tr_b16 v[86:87], v5 offset:5120
    s_waitcnt lgkmcnt(4)
    v_mfma_f32_16x16x32_bf16 v[104:107], v[92:95], v[16:19], v[104:107]
    ds_read_b64_tr_b16 v[88:89], v6 offset:4096
    ds_read_b64_tr_b16 v[90:91], v6 offset:5120
    s_waitcnt lgkmcnt(4)
    v_mfma_f32_16x16x32_bf16 v[108:111], v[96:99], v[16:19], v[108:111]
    ds_read_b64_tr_b16 v[92:93], v5 offset:6144
    ds_read_b64_tr_b16 v[94:95], v5 offset:7168
    s_waitcnt lgkmcnt(4)
    v_mfma_f32_16x16x32_bf16 v[104:107], v[84:87], v[20:23], v[104:107]
    ds_read_b64_tr_b16 v[96:97], v6 offset:6144
    ds_read_b64_tr_b16 v[98:99], v6 offset:7168
    s_waitcnt lgkmcnt(4)
    v_mfma_f32_16x16x32_bf16 v[108:111], v[88:91], v[20:23], v[108:111]
    ds_read_b64_tr_b16 v[84:85], v5 offset:8192
    ds_read_b64_tr_b16 v[86:87], v5 offset:9216
    s_waitcnt lgkmcnt(4)
    v_mfma_f32_16x16x32_bf16 v[104:107], v[92:95], v[24:27], v[104:107]
    ds_read_b64_tr_b16 v[88:89], v6 offset:8192
    ds_read_b64_tr_b16 v[90:91], v6 offset:9216
    s_waitcnt lgkmcnt(4)
    v_mfma_f32_16x16x32_bf16 v[108:111], v[96:99], v[24:27], v[108:111]
    ds_read_b64_tr_b16 v[92:93], v5 offset:10240
    ds_read_b64_tr_b16 v[94:95], v5 offset:11264
    s_waitcnt lgkmcnt(4)
    v_mfma_f32_16x16x32_bf16 v[104:107], v[84:87], v[28:31], v[104:107]
    ds_read_b64_tr_b16 v[96:97], v6 offset:10240
    ds_read_b64_tr_b16 v[98:99], v6 offset:11264
    s_waitcnt lgkmcnt(4)
    v_mfma_f32_16x16x32_bf16 v[108:111], v[88:91], v[28:31], v[108:111]
    ds_read_b64_tr_b16 v[84:85], v5 offset:12288
    ds_read_b64_tr_b16 v[86:87], v5 offset:13312
    s_waitcnt lgkmcnt(4)
    v_mfma_f32_16x16x32_bf16 v[104:107], v[92:95], v[32:35], v[104:107]
    ds_read_b64_tr_b16 v[88:89], v6 offset:12288
    ds_read_b64_tr_b16 v[90:91], v6 offset:13312
    s_waitcnt lgkmcnt(4)
    v_mfma_f32_16x16x32_bf16 v[108:111], v[96:99], v[32:35], v[108:111]
    ds_read_b64_tr_b16 v[92:93], v5 offset:14336
    ds_read_b64_tr_b16 v[94:95], v5 offset:15360
    s_waitcnt lgkmcnt(4)
    v_mfma_f32_16x16x32_bf16 v[104:107], v[84:87], v[36:39], v[104:107]
    ds_read_b64_tr_b16 v[96:97], v6 offset:14336
    ds_read_b64_tr_b16 v[98:99], v6 offset:15360
    s_waitcnt lgkmcnt(4)
    v_mfma_f32_16x16x32_bf16 v[108:111], v[88:91], v[36:39], v[108:111]
    ds_read_b64_tr_b16 v[84:85], v5 offset:16384
    ds_read_b64_tr_b16 v[86:87], v5 offset:17408
    s_waitcnt lgkmcnt(4)
    v_mfma_f32_16x16x32_bf16 v[104:107], v[92:95], v[40:43], v[104:107]
    ds_read_b64_tr_b16 v[88:89], v6 offset:16384
    ds_read_b64_tr_b16 v[90:91], v6 offset:17408
    s_waitcnt lgkmcnt(4)
    v_mfma_f32_16x16x32_bf16 v[108:111], v[96:99], v[40:43], v[108:111]
    s_waitcnt lgkmcnt(2)
    v_mfma_f32_16x16x32_bf16 v[104:107], v[84:87], v[44:47], v[104:107]
    s_waitcnt lgkmcnt(0)
    v_mfma_f32_16x16x32_bf16 v[108:111], v[88:91], v[44:47], v[108:111]
    s_nop 7
    v_cvt_pk_bf16_f32 v120, v104, v105
    v_cvt_pk_bf16_f32 v121, v106, v107
    v_cvt_pk_bf16_f32 v122, v108, v109
    v_cvt_pk_bf16_f32 v123, v110, v111
    s_nop 1
    v_permlane16_swap_b32 v120, v122
    v_permlane16_swap_b32 v121, v123
    global_store_dwordx4 v7, v[120:123], s[68:69] sc1
    v_add_u32 v7, 32768, v7
    v_add_u32 v4, 1024, v4
    v_add_u32 v5, 1024, v5
    v_add_u32 v6, 1024, v6
    s_add_u32 s59, s59, 16
    s_nop 1
    s_barrier
    s_sub_u32 s32, s32, 1
    s_cmp_lg_u32 s32, 0
    s_cbranch_scc1 LA_la
    s_waitcnt vmcnt(0)
    s_barrier
    s_endpgm
LA_g0:
    s_waitcnt vmcnt(10)
    s_barrier
    ds_read_b128 v[24:27], v16 offset:0
    ds_read_b128 v[28:31], v16 offset:2048
    ds_read_b128 v[32:35], v16 offset:4096
    ds_read_b128 v[36:39], v16 offset:6144
    ds_read_b64_tr_b16 v[40:41], v18 offset:0
    ds_read_b64_tr_b16 v[42:43], v18 offset:1024
    ds_read_b64_tr_b16 v[44:45], v19 offset:0
    ds_read_b64_tr_b16 v[46:47], v19 offset:1024
    s_waitcnt lgkmcnt(0)
    v_mfma_f32_16x16x32_bf16 v[72:75], v[40:43], v[24:27], 0
    ds_read_b128 v[48:51], v17 offset:0
    ds_read_b128 v[52:55], v17 offset:2048
    v_mfma_f32_16x16x32_bf16 v[80:83], v[40:43], v[28:31], 0
    ds_read_b128 v[56:59], v17 offset:4096
    ds_read_b128 v[60:63], v17 offset:6144
    v_mfma_f32_16x16x32_bf16 v[88:91], v[40:43], v[32:35], 0
    ds_read_b64_tr_b16 v[64:65], v18 offset:8192
    ds_read_b64_tr_b16 v[66:67], v18 offset:9216
    v_mfma_f32_16x16x32_bf16 v[96:99], v[40:43], v[36:39], 0
    ds_read_b64_tr_b16 v[68:69], v19 offset:8192
    ds_read_b64_tr_b16 v[70:71], v19 offset:9216
    v_mfma_f32_16x16x32_bf16 v[76:79], v[44:47], v[24:27], 0
    v_mfma_f32_16x16x32_bf16 v[84:87], v[44:47], v[28:31], 0
    v_mfma_f32_16x16x32_bf16 v[92:95], v[44:47], v[32:35], 0
    v_mfma_f32_16x16x32_bf16 v[100:103], v[44:47], v[36:39], 0
    s_waitcnt vmcnt(6) lgkmcnt(0)
    s_barrier
    v_mfma_f32_16x16x32_bf16 v[72:75], v[64:67], v[48:51], v[72:75]
    ds_read_b128 v[24:27], v16 offset:16384
    ds_read_b128 v[28:31], v16 offset:18432
    v_mfma_f32_16x16x32_bf16 v[80:83], v[64:67], v[52:55], v[80:83]
    ds_read_b128 v[32:35], v16 offset:20480
    ds_read_b128 v[36:39], v16 offset:22528
    v_mfma_f32_16x16x32_bf16 v[88:91], v[64:67], v[56:59], v[88:91]
    ds_read_b64_tr_b16 v[40:41], v18 offset:16384
    ds_read_b64_tr_b16 v[42:43], v18 offset:17408
    v_mfma_f32_16x16x32_bf16 v[96:99], v[64:67], v[60:63], v[96:99]
    ds_read_b64_tr_b16 v[44:45], v19 offset:16384
    ds_read_b64_tr_b16 v[46:47], v19 offset:17408
    v_mfma_f32_16x16x32_bf16 v[76:79], v[68:71], v[48:51], v[76:79]
    s_add_u32 m0, s21, 0
    s_nop 0
    global_load_lds_dwordx4 v12, s[28:29]
    s_add_u32 m0, s20, 0
    s_nop 0
    global_load_lds_dwordx4 v10, s[24:25]
    v_mfma_f32_16x16x32_bf16 v[84:87], v[68:71], v[52:55], v[84:87]
    v_mfma_f32_16x16x32_bf16 v[92:95], v[68:71], v[56:59], v[92:95]
    v_mfma_f32_16x16x32_bf16 v[100:103], v[68:71], v[60:63], v[100:103]
    s_mov_b32 s32, 5
LA_lb0:
    s_waitcnt lgkmcnt(0)
    v_mfma_f32_16x16x32_bf16 v[72:75], v[40:43], v[24:27], v[72:75]
    ds_read_b128 v[48:51], v17 offset:16384
    ds_read_b128 v[52:55], v17 offset:18432
    v_mfma_f32_16x16x32_bf16 v[80:83], v[40:43], v[28:31], v[80:83]
    ds_read_b128 v[56:59], v17 offset:20480
    ds_read_b128 v[60:63], v17 offset:22528
    v_mfma_f32_16x16x32_bf16 v[88:91], v[40:43], v[32:35], v[88:91]
    ds_read_b64_tr_b16 v[64:65], v18 offset:24576
    ds_read_b64_tr_b16 v[66:67], v18 offset:25600
    v_mfma_f32_16x16x32_bf16 v[96:99], v[40:43], v[36:39], v[96:99]
    ds_read_b64_tr_b16 v[68:69], v19 offset:24576
    ds_read_b64_tr_b16 v[70:71], v19 offset:25600
    v_mfma_f32_16x16x32_bf16 v[76:79], v[44:47], v[24:27], v[76:79]
    s_add_u32 m0, s21, 1024
    s_nop 0
    global_load_lds_dwordx4 v13, s[28:29]
    s_add_u32 s28, s28, 131072
    s_addc_u32 s29, s29, 0
    s_add_u32 m0, s20, 1024
    s_nop 0
    global_load_lds_dwordx4 v11, s[24:25]
    s_add_u32 s24, s24, 128
    s_addc_u32 s25, s25, 0
    v_mfma_f32_16x16x32_bf16 v[84:87], v[44:47], v[28:31], v[84:87]
    v_mfma_f32_16x16x32_bf16 v[92:95], v[44:47], v[32:35], v[92:95]
    v_mfma_f32_16x16x32_bf16 v[100:103], v[44:47], v[36:39], v[100:103]
    s_waitcnt vmcnt(4) lgkmcnt(0)
    s_barrier
    v_mfma_f32_16x16x32_bf16 v[72:75], v[64:67], v[48:51], v[72:75]
    ds_read_b128 v[24:27], v16 offset:32768
    ds_read_b128 v[28:31], v16 offset:34816
    v_mfma_f32_16x16x32_bf16 v[80:83], v[64:67], v[52:55], v[80:83]
    ds_read_b128 v[32:35], v16 offset:36864
    ds_read_b128 v[36:39], v16 offset:38912
    v_mfma_f32_16x16x32_bf16 v[88:91], v[64:67], v[56:59], v[88:91]
    ds_read_b64_tr_b16 v[40:41], v18 offset:32768
    ds_read_b64_tr_b16 v[42:43], v18 offset:33792
    v_mfma_f32_16x16x32_bf16 v[96:99], v[64:67], v[60:63], v[96:99]
    ds_read_b64_tr_b16 v[44:45], v19 offset:32768
    ds_read_b64_tr_b16 v[46:47], v19 offset:33792
    v_mfma_f32_16x16x32_bf16 v[76:79], v[68:71], v[48:51], v[76:79]
    s_add_u32 m0, s21, 16384
    s_nop 0
    global_load_lds_dwordx4 v12, s[28:29]
    s_add_u32 m0, s20, 16384
    s_nop 0
    global_load_lds_dwordx4 v10, s[24:25]
    v_mfma_f32_16x16x32_bf16 v[84:87], v[68:71], v[52:55], v[84:87]
    v_mfma_f32_16x16x32_bf16 v[92:95], v[68:71], v[56:59], v[92:95]
    v_mfma_f32_16x16x32_bf16 v[100:103], v[68:71], v[60:63], v[100:103]
    s_waitcnt lgkmcnt(0)
    v_mfma_f32_16x16x32_bf16 v[72:75], v[40:43], v[24:27], v[72:75]
    ds_read_b128 v[48:51], v17 offset:32768
    ds_read_b128 v[52:55], v17 offset:34816
    v_mfma_f32_16x16x32_bf16 v[80:83], v[40:43], v[28:31], v[80:83]
    ds_read_b128 v[56:59], v17 offset:36864
    ds_read_b128 v[60:63], v17 offset:38912
    v_mfma_f32_16x16x32_bf16 v[88:91], v[40:43], v[32:35], v[88:91]
    ds_read_b64_tr_b16 v[64:65], v18 offset:40960
    ds_read_b64_tr_b16 v[66:67], v18 offset:41984
    v_mfma_f32_16x16x32_bf16 v[96:99], v[40:43], v[36:39], v[96:99]
    ds_read_b64_tr_b16 v[68:69], v19 offset:40960
    ds_read_b64_tr_b16 v[70:71], v19 offset:41984
    v_mfma_f32_16x16x32_bf16 v[76:79], v[44:47], v[24:27], v[76:79]
    s_add_u32 m0, s21, 17408
    s_nop 0
    global_load_lds_dwordx4 v13, s[28:29]
    s_add_u32 s28, s28, 131072
    s_addc_u32 s29, s29, 0
    s_add_u32 m0, s20, 17408
    s_nop 0
    global_load_lds_dwordx4 v11, s[24:25]
    s_add_u32 s24, s24, 128
    s_addc_u32 s25, s25, 0
    v_mfma_f32_16x16x32_bf16 v[84:87], v[44:47], v[28:31], v[84:87]
    v_mfma_f32_16x16x32_bf16 v[92:95], v[44:47], v[32:35], v[92:95]
    v_mfma_f32_16x16x32_bf16 v[100:103], v[44:47], v[36:39], v[100:103]
    s_waitcnt vmcnt(4) lgkmcnt(0)
    s_barrier
    v_mfma_f32_16x16x32_bf16 v[72:75], v[64:67], v[48:51], v[72:75]
    ds_read_b128 v[24:27], v16 offset:0
    ds_read_b128 v[28:31], v16 offset:2048
    v_mfma_f32_16x16x32_bf16 v[80:83], v[64:67], v[52:55], v[80:83]
    ds_read_b128 v[32:35], v16 offset:4096
    ds_read_b128 v[36:39], v16 offset:6144
    v_mfma_f32_16x16x32_bf16 v[88:91], v[64:67], v[56:59], v[88:91]
    ds_read_b64_tr_b16 v[40:41], v18 offset:0
    ds_read_b64_tr_b16 v[42:43], v18 offset:1024
    v_mfma_f32_16x16x32_bf16 v[96:99], v[64:67], v[60:63], v[96:99]
    ds_read_b64_tr_b16 v[44:45], v19 offset:0
    ds_read_b64_tr_b16 v[46:47], v19 offset:1024
    v_mfma_f32_16x16x32_bf16 v[76:79], v[68:71], v[48:51], v[76:79]
    s_add_u32 m0, s21, 32768
    s_nop 0
    global_load_lds_dwordx4 v12, s[28:29]
    s_add_u32 m0, s20, 32768
    s_nop 0
    global_load_lds_dwordx4 v10, s[24:25]
    v_mfma_f32_16x16x32_bf16 v[84:87], v[68:71], v[52:55], v[84:87]
    v_mfma_f32_16x16x32_bf16 v[92:95], v[68:71], v[56:59], v[92:95]
    v_mfma_f32_16x16x32_bf16 v[100:103], v[68:71], v[60:63], v[100:103]
    s_waitcnt lgkmcnt(0)
    v_mfma_f32_16x16x32_bf16 v[72:75], v[40:43], v[24:27], v[72:75]
    ds_read_b128 v[48:51], v17 offset:0
    ds_read_b128 v[52:55], v17 offset:2048
    v_mfma_f32_16x16x32_bf16 v[80:83], v[40:43], v[28:31], v[80:83]
    ds_read_b128 v[56:59], v17 offset:4096
    ds_read_b128 v[60:63], v17 offset:6144
    v_mfma_f32_16x16x32_bf16 v[88:91], v[40:43], v[32:35], v[88:91]
    ds_read_b64_tr_b16 v[64:65], v18 offset:8192
    ds_read_b64_tr_b16 v[66:67], v18 offset:9216
    v_mfma_f32_16x16x32_bf16 v[96:99], v[40:43], v[36:39], v[96:99]
    ds_read_b64_tr_b16 v[68:69], v19 offset:8192
    ds_read_b64_tr_b16 v[70:71], v19 offset:9216
    v_mfma_f32_16x16x32_bf16 v[76:79], v[44:47], v[24:27], v[76:79]
    s_add_u32 m0, s21, 33792
    s_nop 0
    global_load_lds_dwordx4 v13, s[28:29]
    s_add_u32 s28, s28, 131072
    s_addc_u32 s29, s29, 0
    s_add_u32 m0, s20, 33792
    s_nop 0
    global_load_lds_dwordx4 v11, s[24:25]
    s_add_u32 s24, s24, 128
    s_addc_u32 s25, s25, 0
    v_mfma_f32_16x16x32_bf16 v[84:87], v[44:47], v[28:31], v[84:87]
    v_mfma_f32_16x16x32_bf16 v[92:95], v[44:47], v[32:35], v[92:95]
    v_mfma_f32_16x16x32_bf16 v[100:103], v[44:47], v[36:39], v[100:103]
    s_waitcnt vmcnt(4) lgkmcnt(0)
    s_barrier
    v_mfma_f32_16x16x32_bf16 v[72:75], v[64:67], v[48:51], v[72:75]
    ds_read_b128 v[24:27], v16 offset:16384
    ds_read_b128 v[28:31], v16 offset:18432
    v_mfma_f32_16x16x32_bf16 v[80:83], v[64:67], v[52:55], v[80:83]
    ds_read_b128 v[32:35], v16 offset:20480
    ds_read_b128 v[36:39], v16 offset:22528
    v_mfma_f32_16x16x32_bf16 v[88:91], v[64:67], v[56:59], v[88:91]
    ds_read_b64_tr_b16 v[40:41], v18 offset:16384
    ds_read_b64_tr_b16 v[42:43], v18 offset:17408
    v_mfma_f32_16x16x32_bf16 v[96:99], v[64:67], v[60:63], v[96:99]
    ds_read_b64_tr_b16 v[44:45], v19 offset:16384
    ds_read_b64_tr_b16 v[46:47], v19 offset:17408
    v_mfma_f32_16x16x32_bf16 v[76:79], v[68:71], v[48:51], v[76:79]
    s_add_u32 m0, s21, 0
    s_nop 0
    global_load_lds_dwordx4 v12, s[28:29]
    s_add_u32 m0, s20, 0
    s_nop 0
    global_load_lds_dwordx4 v10, s[24:25]
    v_mfma_f32_16x16x32_bf16 v[84:87], v[68:71], v[52:55], v[84:87]
    v_mfma_f32_16x16x32_bf16 v[92:95], v[68:71], v[56:59], v[92:95]
    v_mfma_f32_16x16x32_bf16 v[100:103], v[68:71], v[60:63], v[100:103]
    s_sub_u32 s32, s32, 1
    s_cmp_lg_u32 s32, 0
    s_cbranch_scc1 LA_lb0
    s_waitcnt lgkmcnt(0)
    v_mfma_f32_16x16x32_bf16 v[72:75], v[40:43], v[24:27], v[72:75]
    ds_read_b128 v[48:51], v17 offset:16384
    ds_read_b128 v[52:55], v17 offset:18432
    v_mfma_f32_16x16x32_bf16 v[80:83], v[40:43], v[28:31], v[80:83]
    ds_read_b128 v[56:59], v17 offset:20480
    ds_read_b128 v[60:63], v17 offset:22528
    v_mfma_f32_16x16x32_bf16 v[88:91], v[40:43], v[32:35], v[88:91]
    ds_read_b64_tr_b16 v[64:65], v18 offset:24576
    ds_read_b64_tr_b16 v[66:67], v18 offset:25600
    v_mfma_f32_16x16x32_bf16 v[96:99], v[40:43], v[36:39], v[96:99]
    ds_read_b64_tr_b16 v[68:69], v19 offset:24576
    ds_read_b64_tr_b16 v[70:71], v19 offset:25600
    v_mfma_f32_16x16x32_bf16 v[76:79], v[44:47], v[24:27], v[76:79]
    s_add_u32 m0, s21, 1024
    s_nop 0
    global_load_lds_dwordx4 v13, s[28:29]
    s_add_u32 s28, s28, 131072
    s_addc_u32 s29, s29, 0
    s_add_u32 m0, s20, 1024
    s_nop 0
    global_load_lds_dwordx4 v11, s[24:25]
    s_add_u32 s24, s24, 128
    s_addc_u32 s25, s25, 0
    v_mfma_f32_16x16x32_bf16 v[84:87], v[44:47], v[28:31], v[84:87]
    v_mfma_f32_16x16x32_bf16 v[92:95], v[44:47], v[32:35], v[92:95]
    v_mfma_f32_16x16x32_bf16 v[100:103], v[44:47], v[36:39], v[100:103]
    s_waitcnt vmcnt(4) lgkmcnt(0)
    s_barrier
    v_mfma_f32_16x16x32_bf16 v[72:75], v[64:67], v[48:51], v[72:75]
    ds_read_b128 v[24:27], v16 offset:32768
    ds_read_b128 v[28:31], v16 offset:34816
    v_mfma_f32_16x16x32_bf16 v[80:83], v[64:67], v[52:55], v[80:83]
    ds_read_b128 v[32:35], v16 offset:36864
    ds_read_b128 v[36:39], v16 offset:38912
    v_mfma_f32_16x16x32_bf16 v[88:91], v[64:67], v[56:59], v[88:91]
    ds_read_b64_tr_b16 v[40:41], v18 offset:32768
    ds_read_b64_tr_b16 v[42:43], v18 offset:33792
    v_mfma_f32_16x16x32_bf16 v[96:99], v[64:67], v[60:63], v[96:99]
    ds_read_b64_tr_b16 v[44:45], v19 offset:32768
    ds_read_b64_tr_b16 v[46:47], v19 offset:33792
    v_mfma_f32_16x16x32_bf16 v[76:79], v[68:71], v[48:51], v[76:79]
    s_add_u32 m0, s21, 16384
    s_nop 0
    global_load_lds_dwordx4 v12, s[28:29]
    s_add_u32 m0, s20, 16384
    s_nop 0
    global_load_lds_dwordx4 v10, s[24:25]
    v_mfma_f32_16x16x32_bf16 v[84:87], v[68:71], v[52:55], v[84:87]
    v_mfma_f32_16x16x32_bf16 v[92:95], v[68:71], v[56:59], v[92:95]
    v_mfma_f32_16x16x32_bf16 v[100:103], v[68:71], v[60:63], v[100:103]
    s_waitcnt lgkmcnt(0)
    v_mfma_f32_16x16x32_bf16 v[72:75], v[40:43], v[24:27], v[72:75]
    ds_read_b128 v[48:51], v17 offset:32768
    ds_read_b128 v[52:55], v17 offset:34816
    v_mfma_f32_16x16x32_bf16 v[80:83], v[40:43], v[28:31], v[80:83]
    ds_read_b128 v[56:59], v17 offset:36864
    ds_read_b128 v[60:63], v17 offset:38912
    v_mfma_f32_16x16x32_bf16 v[88:91], v[40:43], v[32:35], v[88:91]
    ds_read_b64_tr_b16 v[64:65], v18 offset:40960
    ds_read_b64_tr_b16 v[66:67], v18 offset:41984
    v_mfma_f32_16x16x32_bf16 v[96:99], v[40:43], v[36:39], v[96:99]
    ds_read_b64_tr_b16 v[68:69], v19 offset:40960
    ds_read_b64_tr_b16 v[70:71], v19 offset:41984
    v_mfma_f32_16x16x32_bf16 v[76:79], v[44:47], v[24:27], v[76:79]
    s_add_u32 m0, s21, 17408
    s_nop 0
    global_load_lds_dwordx4 v13, s[28:29]
    s_add_u32 s28, s28, 131072
    s_addc_u32 s29, s29, 0
    s_add_u32 m0, s20, 17408
    s_nop 0
    global_load_lds_dwordx4 v11, s[24:25]
    s_add_u32 s24, s24, 128
    s_addc_u32 s25, s25, 0
    v_mfma_f32_16x16x32_bf16 v[84:87], v[44:47], v[28:31], v[84:87]
    v_mfma_f32_16x16x32_bf16 v[92:95], v[44:47], v[32:35], v[92:95]
    v_mfma_f32_16x16x32_bf16 v[100:103], v[44:47], v[36:39], v[100:103]
    s_waitcnt vmcnt(4) lgkmcnt(0)
    s_barrier
    s_cmp_lg_u32 s14, 0
    s_cbranch_scc1 LA_s0
    s_lshl_b32 s33, s60, 8
    s_add_u32 s33, s33, 46137472
    v_mov_b32 v7, s33
    v_mov_b32 v8, 1
    v_cmp_eq_u32 vcc, 0, v0
    s_and_saveexec_b64 s[38:39], vcc
    global_atomic_add v7, v8, s[12:13] sc1
    s_mov_b64 exec, s[38:39]
LA_s0:
    v_mfma_f32_16x16x32_bf16 v[72:75], v[64:67], v[48:51], v[72:75]
    ds_read_b128 v[24:27], v16 offset:0
    ds_read_b128 v[28:31], v16 offset:2048
    v_mfma_f32_16x16x32_bf16 v[80:83], v[64:67], v[52:55], v[80:83]
    ds_read_b128 v[32:35], v16 offset:4096
    ds_read_b128 v[36:39], v16 offset:6144
    v_mfma_f32_16x16x32_bf16 v[88:91], v[64:67], v[56:59], v[88:91]
    ds_read_b64_tr_b16 v[40:41], v18 offset:0
    ds_read_b64_tr_b16 v[42:43], v18 offset:1024
    v_mfma_f32_16x16x32_bf16 v[96:99], v[64:67], v[60:63], v[96:99]
    ds_read_b64_tr_b16 v[44:45], v19 offset:0
    ds_read_b64_tr_b16 v[46:47], v19 offset:1024
    v_mfma_f32_16x16x32_bf16 v[76:79], v[68:71], v[48:51], v[76:79]
    s_add_u32 m0, s21, 32768
    s_nop 0
    global_load_lds_dwordx4 v12, s[28:29]
    s_add_u32 m0, s20, 32768
    s_nop 0
    global_load_lds_dwordx4 v10, s[24:25]
    v_mfma_f32_16x16x32_bf16 v[84:87], v[68:71], v[52:55], v[84:87]
    s_add_u32 m0, s21, 33792
    s_nop 0
    global_load_lds_dwordx4 v13, s[28:29]
    s_add_u32 s28, s28, 131072
    s_addc_u32 s29, s29, 0
    s_add_u32 m0, s20, 33792
    s_nop 0
    global_load_lds_dwordx4 v11, s[24:25]
    s_add_u32 s24, s24, 128
    s_addc_u32 s25, s25, 0
    v_mfma_f32_16x16x32_bf16 v[92:95], v[68:71], v[56:59], v[92:95]
    v_mfma_f32_16x16x32_bf16 v[100:103], v[68:71], v[60:63], v[100:103]
    s_waitcnt lgkmcnt(0)
    v_mfma_f32_16x16x32_bf16 v[72:75], v[40:43], v[24:27], v[72:75]
    ds_read_b128 v[48:51], v17 offset:0
    ds_read_b128 v[52:55], v17 offset:2048
    v_mfma_f32_16x16x32_bf16 v[80:83], v[40:43], v[28:31], v[80:83]
    ds_read_b128 v[56:59], v17 offset:4096
    ds_read_b128 v[60:63], v17 offset:6144
    v_mfma_f32_16x16x32_bf16 v[88:91], v[40:43], v[32:35], v[88:91]
    ds_read_b64_tr_b16 v[64:65], v18 offset:8192
    ds_read_b64_tr_b16 v[66:67], v18 offset:9216
    v_mfma_f32_16x16x32_bf16 v[96:99], v[40:43], v[36:39], v[96:99]
    ds_read_b64_tr_b16 v[68:69], v19 offset:8192
    ds_read_b64_tr_b16 v[70:71], v19 offset:9216
    v_mfma_f32_16x16x32_bf16 v[76:79], v[44:47], v[24:27], v[76:79]
    s_add_u32 m0, s21, 65536
    s_nop 0
    global_load_lds_dwordx4 v12, s[28:29]
    s_add_u32 m0, s20, 98304
    s_nop 0
    global_load_lds_dwordx4 v10, s[24:25]
    v_mfma_f32_16x16x32_bf16 v[84:87], v[44:47], v[28:31], v[84:87]
    s_add_u32 m0, s21, 66560
    s_nop 0
    global_load_lds_dwordx4 v13, s[28:29]
    s_add_u32 s28, s28, 131072
    s_addc_u32 s29, s29, 0
    s_add_u32 m0, s20, 99328
    s_nop 0
    global_load_lds_dwordx4 v11, s[24:25]
    s_add_u32 s24, s24, 128
    s_addc_u32 s25, s25, 0
    v_mfma_f32_16x16x32_bf16 v[92:95], v[44:47], v[32:35], v[92:95]
    v_mfma_f32_16x16x32_bf16 v[100:103], v[44:47], v[36:39], v[100:103]
    s_waitcnt vmcnt(8) lgkmcnt(0)
    s_barrier
    v_mfma_f32_16x16x32_bf16 v[72:75], v[64:67], v[48:51], v[72:75]
    ds_read_b128 v[24:27], v16 offset:16384
    ds_read_b128 v[28:31], v16 offset:18432
    v_mfma_f32_16x16x32_bf16 v[80:83], v[64:67], v[52:55], v[80:83]
    ds_read_b128 v[32:35], v16 offset:20480
    ds_read_b128 v[36:39], v16 offset:22528
    v_mfma_f32_16x16x32_bf16 v[88:91], v[64:67], v[56:59], v[88:91]
    ds_read_b64_tr_b16 v[40:41], v18 offset:16384
    ds_read_b64_tr_b16 v[42:43], v18 offset:17408
    v_mfma_f32_16x16x32_bf16 v[96:99], v[64:67], v[60:63], v[96:99]
    ds_read_b64_tr_b16 v[44:45], v19 offset:16384
    ds_read_b64_tr_b16 v[46:47], v19 offset:17408
    v_mfma_f32_16x16x32_bf16 v[76:79], v[68:71], v[48:51], v[76:79]
    v_mfma_f32_16x16x32_bf16 v[84:87], v[68:71], v[52:55], v[84:87]
    v_mfma_f32_16x16x32_bf16 v[92:95], v[68:71], v[56:59], v[92:95]
    v_mfma_f32_16x16x32_bf16 v[100:103], v[68:71], v[60:63], v[100:103]
    s_waitcnt lgkmcnt(0)
    v_mfma_f32_16x16x32_bf16 v[72:75], v[40:43], v[24:27], v[72:75]
    ds_read_b128 v[48:51], v17 offset:16384
    ds_read_b128 v[52:55], v17 offset:18432
    v_mfma_f32_16x16x32_bf16 v[80:83], v[40:43], v[28:31], v[80:83]
    ds_read_b128 v[56:59], v17 offset:20480
    ds_read_b128 v[60:63], v17 offset:22528
    v_mfma_f32_16x16x32_bf16 v[88:91], v[40:43], v[32:35], v[88:91]
    ds_read_b64_tr_b16 v[64:65], v18 offset:24576
    ds_read_b64_tr_b16 v[66:67], v18 offset:25600
    v_mfma_f32_16x16x32_bf16 v[96:99], v[40:43], v[36:39], v[96:99]
    ds_read_b64_tr_b16 v[68:69], v19 offset:24576
    ds_read_b64_tr_b16 v[70:71], v19 offset:25600
    v_mfma_f32_16x16x32_bf16 v[76:79], v[44:47], v[24:27], v[76:79]
    v_mfma_f32_16x16x32_bf16 v[84:87], v[44:47], v[28:31], v[84:87]
    v_mfma_f32_16x16x32_bf16 v[92:95], v[44:47], v[32:35], v[92:95]
    v_mfma_f32_16x16x32_bf16 v[100:103], v[44:47], v[36:39], v[100:103]
    s_cmp_lg_u32 s14, 0
    s_cbranch_scc1 LA_w0
    s_lshr_b32 s33, s16, 1
    s_lshl_b32 s33, s33, 8
    s_add_u32 s33, s33, 46137472
    v_mov_b32 v7, s33
LA_w0p:
    global_load_dword v8, v7, s[12:13] sc1
    s_waitcnt vmcnt(0)
    v_cmp_gt_u32 vcc, 32, v8
    s_cbranch_vccz LA_w0
    s_sleep 1
    s_branch LA_w0p
LA_w0:
    s_waitcnt vmcnt(4) lgkmcnt(0)
    s_barrier
    v_mfma_f32_16x16x32_bf16 v[72:75], v[64:67], v[48:51], v[72:75]
    ds_read_b128 v[24:27], v16 offset:32768
    ds_read_b128 v[28:31], v16 offset:34816
    v_mfma_f32_16x16x32_bf16 v[80:83], v[64:67], v[52:55], v[80:83]
    ds_read_b128 v[32:35], v16 offset:36864
    ds_read_b128 v[36:39], v16 offset:38912
    v_mfma_f32_16x16x32_bf16 v[88:91], v[64:67], v[56:59], v[88:91]
    ds_read_b64_tr_b16 v[40:41], v18 offset:32768
    ds_read_b64_tr_b16 v[42:43], v18 offset:33792
    v_mfma_f32_16x16x32_bf16 v[96:99], v[64:67], v[60:63], v[96:99]
    ds_read_b64_tr_b16 v[44:45], v19 offset:32768
    ds_read_b64_tr_b16 v[46:47], v19 offset:33792
    v_mfma_f32_16x16x32_bf16 v[76:79], v[68:71], v[48:51], v[76:79]
    s_add_u32 m0, s21, 98304
    s_nop 0
    global_load_lds_dwordx4 v12, s[26:27]
    s_add_u32 m0, s21, 99328
    s_nop 0
    global_load_lds_dwordx4 v13, s[26:27]
    s_add_u32 s26, s26, 131072
    s_addc_u32 s27, s27, 0
    v_mfma_f32_16x16x32_bf16 v[84:87], v[68:71], v[52:55], v[84:87]
    s_add_u32 m0, s31, 131072
    s_nop 0
    global_load_lds_dwordx4 v14, s[22:23] sc1
    s_add_u32 s22, s22, 128
    s_addc_u32 s23, s23, 0
    s_add_u32 m0, s21, 0
    s_nop 0
    global_load_lds_dwordx4 v12, s[28:29]
    v_mfma_f32_16x16x32_bf16 v[92:95], v[68:71], v[56:59], v[92:95]
    s_add_u32 m0, s20, 0
    s_nop 0
    global_load_lds_dwordx4 v10, s[24:25]
    v_mfma_f32_16x16x32_bf16 v[100:103], v[68:71], v[60:63], v[100:103]
    s_waitcnt lgkmcnt(0)
    v_mfma_f32_16x16x32_bf16 v[72:75], v[40:43], v[24:27], v[72:75]
    ds_read_b128 v[48:51], v17 offset:32768
    ds_read_b128 v[52:55], v17 offset:34816
    v_mfma_f32_16x16x32_bf16 v[80:83], v[40:43], v[28:31], v[80:83]
    ds_read_b128 v[56:59], v17 offset:36864
    ds_read_b128 v[60:63], v17 offset:38912
    v_mfma_f32_16x16x32_bf16 v[88:91], v[40:43], v[32:35], v[88:91]
    ds_read_b64_tr_b16 v[64:65], v18 offset:40960
    ds_read_b64_tr_b16 v[66:67], v18 offset:41984
    v_mfma_f32_16x16x32_bf16 v[96:99], v[40:43], v[36:39], v[96:99]
    ds_read_b64_tr_b16 v[68:69], v19 offset:40960
    ds_read_b64_tr_b16 v[70:71], v19 offset:41984
    v_mfma_f32_16x16x32_bf16 v[76:79], v[44:47], v[24:27], v[76:79]
    s_add_u32 m0, s21, 1024
    s_nop 0
    global_load_lds_dwordx4 v13, s[28:29]
    s_add_u32 s28, s28, 131072
    s_addc_u32 s29, s29, 0
    s_add_u32 m0, s20, 1024
    s_nop 0
    global_load_lds_dwordx4 v11, s[24:25]
    s_add_u32 s24, s24, 128
    s_addc_u32 s25, s25, 0
    v_mfma_f32_16x16x32_bf16 v[84:87], v[44:47], v[28:31], v[84:87]
    s_add_u32 m0, s21, 16384
    s_nop 0
    global_load_lds_dwordx4 v12, s[26:27]
    s_add_u32 m0, s21, 17408
    s_nop 0
    global_load_lds_dwordx4 v13, s[26:27]
    s_add_u32 s26, s26, 131072
    s_addc_u32 s27, s27, 0
    v_mfma_f32_16x16x32_bf16 v[92:95], v[44:47], v[32:35], v[92:95]
    s_add_u32 m0, s31, 16384
    s_nop 0
    global_load_lds_dwordx4 v14, s[22:23] sc1
    s_add_u32 s22, s22, 128
    s_addc_u32 s23, s23, 0
    v_mfma_f32_16x16x32_bf16 v[100:103], v[44:47], v[36:39], v[100:103]
    s_waitcnt vmcnt(10) lgkmcnt(0)
    s_barrier
    v_mfma_f32_16x16x32_bf16 v[72:75], v[64:67], v[48:51], v[72:75]
    ds_read_b128 v[24:27], v120 offset:0
    ds_read_b128 v[28:31], v120 offset:2048
    v_mfma_f32_16x16x32_bf16 v[80:83], v[64:67], v[52:55], v[80:83]
    ds_read_b128 v[32:35], v120 offset:4096
    ds_read_b128 v[36:39], v120 offset:6144
    v_mfma_f32_16x16x32_bf16 v[88:91], v[64:67], v[56:59], v[88:91]
    ds_read_b64_tr_b16 v[40:41], v122 offset:0
    ds_read_b64_tr_b16 v[42:43], v122 offset:1024
    v_mfma_f32_16x16x32_bf16 v[96:99], v[64:67], v[60:63], v[96:99]
    ds_read_b64_tr_b16 v[44:45], v123 offset:0
    ds_read_b64_tr_b16 v[46:47], v123 offset:1024
    v_mfma_f32_16x16x32_bf16 v[76:79], v[68:71], v[48:51], v[76:79]
    s_add_u32 m0, s21, 32768
    s_nop 0
    global_load_lds_dwordx4 v12, s[28:29]
    s_add_u32 m0, s20, 32768
    s_nop 0
    global_load_lds_dwordx4 v10, s[24:25]
    v_mfma_f32_16x16x32_bf16 v[84:87], v[68:71], v[52:55], v[84:87]
    v_mfma_f32_16x16x32_bf16 v[92:95], v[68:71], v[56:59], v[92:95]
    v_mfma_f32_16x16x32_bf16 v[100:103], v[68:71], v[60:63], v[100:103]
    s_waitcnt lgkmcnt(0)
    v_mfma_f32_16x16x32_bf16 v[72:75], v[40:43], v[24:27], v[72:75]
    ds_read_b128 v[48:51], v121 offset:0
    ds_read_b128 v[52:55], v121 offset:2048
    v_mfma_f32_16x16x32_bf16 v[80:83], v[40:43], v[28:31], v[80:83]
    ds_read_b128 v[56:59], v121 offset:4096
    ds_read_b128 v[60:63], v121 offset:6144
    v_mfma_f32_16x16x32_bf16 v[88:91], v[40:43], v[32:35], v[88:91]
    ds_read_b64_tr_b16 v[64:65], v122 offset:8192
    ds_read_b64_tr_b16 v[66:67], v122 offset:9216
    v_mfma_f32_16x16x32_bf16 v[96:99], v[40:43], v[36:39], v[96:99]
    ds_read_b64_tr_b16 v[68:69], v123 offset:8192
    ds_read_b64_tr_b16 v[70:71], v123 offset:9216
    v_mfma_f32_16x16x32_bf16 v[76:79], v[44:47], v[24:27], v[76:79]
    s_add_u32 m0, s21, 33792
    s_nop 0
    global_load_lds_dwordx4 v13, s[28:29]
    s_add_u32 s28, s28, 131072
    s_addc_u32 s29, s29, 0
    s_add_u32 m0, s20, 33792
    s_nop 0
    global_load_lds_dwordx4 v11, s[24:25]
    s_add_u32 s24, s24, 128
    s_addc_u32 s25, s25, 0
    v_mfma_f32_16x16x32_bf16 v[84:87], v[44:47], v[28:31], v[84:87]
    v_mfma_f32_16x16x32_bf16 v[92:95], v[44:47], v[32:35], v[92:95]
    v_mfma_f32_16x16x32_bf16 v[100:103], v[44:47], v[36:39], v[100:103]
    s_waitcnt vmcnt(11) lgkmcnt(0)
    s_barrier
    v_mfma_f32_16x16x32_bf16 v[72:75], v[64:67], v[48:51], v[72:75]
    ds_read_b128 v[24:27], v120 offset:32768
    ds_read_b128 v[28:31], v120 offset:34816
    v_mfma_f32_16x16x32_bf16 v[80:83], v[64:67], v[52:55], v[80:83]
    ds_read_b64_tr_b16 v[40:41], v122 offset:32768
    ds_read_b64_tr_b16 v[42:43], v122 offset:33792
    v_mfma_f32_16x16x32_bf16 v[88:91], v[64:67], v[56:59], v[88:91]
    ds_read_b64_tr_b16 v[44:45], v123 offset:32768
    ds_read_b64_tr_b16 v[46:47], v123 offset:33792
    v_mfma_f32_16x16x32_bf16 v[96:99], v[64:67], v[60:63], v[96:99]
    s_add_u32 m0, s21, 65536
    s_nop 0
    global_load_lds_dwordx4 v12, s[26:27]
    s_add_u32 m0, s21, 66560
    s_nop 0
    global_load_lds_dwordx4 v13, s[26:27]
    s_add_u32 s26, s26, 131072
    s_addc_u32 s27, s27, 0
    v_mfma_f32_16x16x32_bf16 v[76:79], v[68:71], v[48:51], v[76:79]
    v_mfma_f32_16x16x32_bf16 v[84:87], v[68:71], v[52:55], v[84:87]
    v_mfma_f32_16x16x32_bf16 v[92:95], v[68:71], v[56:59], v[92:95]
    v_mfma_f32_16x16x32_bf16 v[100:103], v[68:71], v[60:63], v[100:103]
    s_waitcnt lgkmcnt(0)
    v_mfma_f32_16x16x32_bf16 v[104:107], v[40:43], v[24:27], 0
    ds_read_b128 v[48:51], v121 offset:32768
    ds_read_b128 v[52:55], v121 offset:34816
    ds_read_b64_tr_b16 v[64:65], v122 offset:40960
    v_mfma_f32_16x16x32_bf16 v[112:115], v[40:43], v[28:31], 0
    ds_read_b64_tr_b16 v[66:67], v122 offset:41984
    ds_read_b64_tr_b16 v[68:69], v123 offset:40960
    ds_read_b64_tr_b16 v[70:71], v123 offset:41984
    v_mfma_f32_16x16x32_bf16 v[108:111], v[44:47], v[24:27], 0
    s_add_u32 m0, s31, 98304
    s_nop 0
    global_load_lds_dwordx4 v14, s[22:23] sc1
    s_add_u32 s22, s22, 128
    s_addc_u32 s23, s23, 0
    v_mfma_f32_16x16x32_bf16 v[116:119], v[44:47], v[28:31], 0
    s_waitcnt vmcnt(10) lgkmcnt(0)
    s_barrier
    v_mfma_f32_16x16x32_bf16 v[104:107], v[64:67], v[48:51], v[104:107]
    ds_read_b128 v[24:27], v16 offset:0
    ds_read_b128 v[28:31], v16 offset:2048
    ds_read_b128 v[32:35], v16 offset:4096
    v_mfma_f32_16x16x32_bf16 v[112:115], v[64:67], v[52:55], v[112:115]
    ds_read_b128 v[36:39], v16 offset:6144
    ds_read_b64_tr_b16 v[40:41], v18 offset:0
    ds_read_b64_tr_b16 v[42:43], v18 offset:1024
    v_mfma_f32_16x16x32_bf16 v[108:111], v[68:71], v[48:51], v[108:111]
    ds_read_b64_tr_b16 v[44:45], v19 offset:0
    ds_read_b64_tr_b16 v[46:47], v19 offset:1024
    s_add_u32 m0, s21, 98304
    s_nop 0
    global_load_lds_dwordx4 v12, s[28:29]
    v_mfma_f32_16x16x32_bf16 v[116:119], v[68:71], v[52:55], v[116:119]
    s_add_u32 m0, s20, 131072
    s_nop 0
    global_load_lds_dwordx4 v10, s[24:25]
    s_waitcnt lgkmcnt(0)
    v_mfma_f32_16x16x32_bf16 v[72:75], v[40:43], v[24:27], v[72:75]
    ds_read_b128 v[48:51], v17 offset:0
    ds_read_b128 v[52:55], v17 offset:2048
    v_mfma_f32_16x16x32_bf16 v[80:83], v[40:43], v[28:31], v[80:83]
    ds_read_b128 v[56:59], v17 offset:4096
    ds_read_b128 v[60:63], v17 offset:6144
    v_mfma_f32_16x16x32_bf16 v[88:91], v[40:43], v[32:35], v[88:91]
    ds_read_b64_tr_b16 v[64:65], v18 offset:8192
    ds_read_b64_tr_b16 v[66:67], v18 offset:9216
    v_mfma_f32_16x16x32_bf16 v[96:99], v[40:43], v[36:39], v[96:99]
    ds_read_b64_tr_b16 v[68:69], v19 offset:8192
    ds_read_b64_tr_b16 v[70:71], v19 offset:9216
    v_mfma_f32_16x16x32_bf16 v[76:79], v[44:47], v[24:27], v[76:79]
    s_add_u32 m0, s21, 99328
    s_nop 0
    global_load_lds_dwordx4 v13, s[28:29]
    s_add_u32 s28, s28, 131072
    s_addc_u32 s29, s29, 0
    s_add_u32 m0, s20, 132096
    s_nop 0
    global_load_lds_dwordx4 v11, s[24:25]
    s_add_u32 s24, s24, 128
    s_addc_u32 s25, s25, 0
    v_mfma_f32_16x16x32_bf16 v[84:87], v[44:47], v[28:31], v[84:87]
    v_mfma_f32_16x16x32_bf16 v[92:95], v[44:47], v[32:35], v[92:95]
    v_mfma_f32_16x16x32_bf16 v[100:103], v[44:47], v[36:39], v[100:103]
    s_waitcnt vmcnt(11) lgkmcnt(0)
    s_barrier
    v_mfma_f32_16x16x32_bf16 v[72:75], v[64:67], v[48:51], v[72:75]
    ds_read_b128 v[24:27], v16 offset:16384
    ds_read_b128 v[28:31], v16 offset:18432
    v_mfma_f32_16x16x32_bf16 v[80:83], v[64:67], v[52:55], v[80:83]
    ds_read_b64_tr_b16 v[40:41], v18 offset:16384
    ds_read_b64_tr_b16 v[42:43], v18 offset:17408
    v_mfma_f32_16x16x32_bf16 v[88:91], v[64:67], v[56:59], v[88:91]
    ds_read_b64_tr_b16 v[44:45], v19 offset:16384
    ds_read_b64_tr_b16 v[46:47], v19 offset:17408
    v_mfma_f32_16x16x32_bf16 v[96:99], v[64:67], v[60:63], v[96:99]
    s_add_u32 m0, s21, 0
    s_nop 0
    global_load_lds_dwordx4 v12, s[26:27]
    s_add_u32 m0, s21, 1024
    s_nop 0
    global_load_lds_dwordx4 v13, s[26:27]
    s_add_u32 s26, s26, 131072
    s_addc_u32 s27, s27, 0
    v_mfma_f32_16x16x32_bf16 v[76:79], v[68:71], v[48:51], v[76:79]
    v_mfma_f32_16x16x32_bf16 v[84:87], v[68:71], v[52:55], v[84:87]
    v_mfma_f32_16x16x32_bf16 v[92:95], v[68:71], v[56:59], v[92:95]
    v_mfma_f32_16x16x32_bf16 v[100:103], v[68:71], v[60:63], v[100:103]
    s_waitcnt lgkmcnt(0)
    v_mfma_f32_16x16x32_bf16 v[104:107], v[40:43], v[24:27], v[104:107]
    ds_read_b128 v[48:51], v17 offset:16384
    ds_read_b128 v[52:55], v17 offset:18432
    ds_read_b64_tr_b16 v[64:65], v18 offset:24576
    v_mfma_f32_16x16x32_bf16 v[112:115], v[40:43], v[28:31], v[112:115]
    ds_read_b64_tr_b16 v[66:67], v18 offset:25600
    ds_read_b64_tr_b16 v[68:69], v19 offset:24576
    ds_read_b64_tr_b16 v[70:71], v19 offset:25600
    v_mfma_f32_16x16x32_bf16 v[108:111], v[44:47], v[24:27], v[108:111]
    s_add_u32 m0, s31, 0
    s_nop 0
    global_load_lds_dwordx4 v14, s[22:23] sc1
    s_add_u32 s22, s22, 128
    s_addc_u32 s23, s23, 0
    v_mfma_f32_16x16x32_bf16 v[116:119], v[44:47], v[28:31], v[116:119]
    s_waitcnt vmcnt(10) lgkmcnt(0)
    s_barrier
    v_mfma_f32_16x16x32_bf16 v[104:107], v[64:67], v[48:51], v[104:107]
    ds_read_b128 v[24:27], v16 offset:32768
    ds_read_b128 v[28:31], v16 offset:34816
    ds_read_b128 v[32:35], v16 offset:36864
    v_mfma_f32_16x16x32_bf16 v[112:115], v[64:67], v[52:55], v[112:115]
    ds_read_b128 v[36:39], v16 offset:38912
    ds_read_b64_tr_b16 v[40:41], v18 offset:32768
    ds_read_b64_tr_b16 v[42:43], v18 offset:33792
    v_mfma_f32_16x16x32_bf16 v[108:111], v[68:71], v[48:51], v[108:111]
    ds_read_b64_tr_b16 v[44:45], v19 offset:32768
    ds_read_b64_tr_b16 v[46:47], v19 offset:33792
    s_add_u32 m0, s21, 16384
    s_nop 0
    global_load_lds_dwordx4 v12, s[28:29]
    v_mfma_f32_16x16x32_bf16 v[116:119], v[68:71], v[52:55], v[116:119]
    s_add_u32 m0, s20, 16384
    s_nop 0
    global_load_lds_dwordx4 v10, s[24:25]
    s_waitcnt lgkmcnt(0)
    v_mfma_f32_16x16x32_bf16 v[72:75], v[40:43], v[24:27], v[72:75]
    ds_read_b128 v[48:51], v17 offset:32768
    ds_read_b128 v[52:55], v17 offset:34816
    v_mfma_f32_16x16x32_bf16 v[80:83], v[40:43], v[28:31], v[80:83]
    ds_read_b128 v[56:59], v17 offset:36864
    ds_read_b128 v[60:63], v17 offset:38912
    v_mfma_f32_16x16x32_bf16 v[88:91], v[40:43], v[32:35], v[88:91]
    ds_read_b64_tr_b16 v[64:65], v18 offset:40960
    ds_read_b64_tr_b16 v[66:67], v18 offset:41984
    v_mfma_f32_16x16x32_bf16 v[96:99], v[40:43], v[36:39], v[96:99]
    ds_read_b64_tr_b16 v[68:69], v19 offset:40960
    ds_read_b64_tr_b16 v[70:71], v19 offset:41984
    v_mfma_f32_16x16x32_bf16 v[76:79], v[44:47], v[24:27], v[76:79]
    s_add_u32 m0, s21, 17408
    s_nop 0
    global_load_lds_dwordx4 v13, s[28:29]
    s_add_u32 s28, s28, 131072
    s_addc_u32 s29, s29, 0
    s_add_u32 m0, s20, 17408
    s_nop 0
    global_load_lds_dwordx4 v11, s[24:25]
    s_add_u32 s24, s24, 128
    s_addc_u32 s25, s25, 0
    v_mfma_f32_16x16x32_bf16 v[84:87], v[44:47], v[28:31], v[84:87]
    v_mfma_f32_16x16x32_bf16 v[92:95], v[44:47], v[32:35], v[92:95]
    v_mfma_f32_16x16x32_bf16 v[100:103], v[44:47], v[36:39], v[100:103]
    s_waitcnt vmcnt(11) lgkmcnt(0)
    s_barrier
    v_mfma_f32_16x16x32_bf16 v[72:75], v[64:67], v[48:51], v[72:75]
    ds_read_b128 v[24:27], v120 offset:0
    ds_read_b128 v[28:31], v120 offset:2048
    v_mfma_f32_16x16x32_bf16 v[80:83], v[64:67], v[52:55], v[80:83]
    ds_read_b64_tr_b16 v[40:41], v122 offset:0
    ds_read_b64_tr_b16 v[42:43], v122 offset:1024
    v_mfma_f32_16x16x32_bf16 v[88:91], v[64:67], v[56:59], v[88:91]
    ds_read_b64_tr_b16 v[44:45], v123 offset:0
    ds_read_b64_tr_b16 v[46:47], v123 offset:1024
    v_mfma_f32_16x16x32_bf16 v[96:99], v[64:67], v[60:63], v[96:99]
    s_add_u32 m0, s21, 32768
    s_nop 0
    global_load_lds_dwordx4 v12, s[26:27]
    s_add_u32 m0, s21, 33792
    s_nop 0
    global_load_lds_dwordx4 v13, s[26:27]
    s_add_u32 s26, s26, 131072
    s_addc_u32 s27, s27, 0
    v_mfma_f32_16x16x32_bf16 v[76:79], v[68:71], v[48:51], v[76:79]
    v_mfma_f32_16x16x32_bf16 v[84:87], v[68:71], v[52:55], v[84:87]
    v_mfma_f32_16x16x32_bf16 v[92:95], v[68:71], v[56:59], v[92:95]
    v_mfma_f32_16x16x32_bf16 v[100:103], v[68:71], v[60:63], v[100:103]
    s_waitcnt lgkmcnt(0)
    v_mfma_f32_16x16x32_bf16 v[104:107], v[40:43], v[24:27], v[104:107]
    ds_read_b128 v[48:51], v121 offset:0
    ds_read_b128 v[52:55], v121 offset:2048
    ds_read_b64_tr_b16 v[64:65], v122 offset:8192
    v_mfma_f32_16x16x32_bf16 v[112:115], v[40:43], v[28:31], v[112:115]
    ds_read_b64_tr_b16 v[66:67], v122 offset:9216
    ds_read_b64_tr_b16 v[68:69], v123 offset:8192
    ds_read_b64_tr_b16 v[70:71], v123 offset:9216
    v_mfma_f32_16x16x32_bf16 v[108:111], v[44:47], v[24:27], v[108:111]
    s_add_u32 m0, s31, 32768
    s_nop 0
    global_load_lds_dwordx4 v14, s[22:23] sc1
    s_add_u32 s22, s22, 128
    s_addc_u32 s23, s23, 0
    v_mfma_f32_16x16x32_bf16 v[116:119], v[44:47], v[28:31], v[116:119]
    s_waitcnt vmcnt(10) lgkmcnt(0)
    s_barrier
    v_mfma_f32_16x16x32_bf16 v[104:107], v[64:67], v[48:51], v[104:107]
    ds_read_b128 v[24:27], v120 offset:32768
    ds_read_b128 v[28:31], v120 offset:34816
    ds_read_b128 v[32:35], v120 offset:36864
    v_mfma_f32_16x16x32_bf16 v[112:115], v[64:67], v[52:55], v[112:115]
    ds_read_b128 v[36:39], v120 offset:38912
    ds_read_b64_tr_b16 v[40:41], v122 offset:32768
    ds_read_b64_tr_b16 v[42:43], v122 offset:33792
    v_mfma_f32_16x16x32_bf16 v[108:111], v[68:71], v[48:51], v[108:111]
    ds_read_b64_tr_b16 v[44:45], v123 offset:32768
    ds_read_b64_tr_b16 v[46:47], v123 offset:33792
    s_add_u32 m0, s21, 65536
    s_nop 0
    global_load_lds_dwordx4 v12, s[28:29]
    v_mfma_f32_16x16x32_bf16 v[116:119], v[68:71], v[52:55], v[116:119]
    s_add_u32 m0, s20, 98304
    s_nop 0
    global_load_lds_dwordx4 v10, s[24:25]
    s_waitcnt lgkmcnt(0)
    v_mfma_f32_16x16x32_bf16 v[72:75], v[40:43], v[24:27], v[72:75]
    ds_read_b128 v[48:51], v121 offset:32768
    ds_read_b128 v[52:55], v121 offset:34816
    v_mfma_f32_16x16x32_bf16 v[80:83], v[40:43], v[28:31], v[80:83]
    ds_read_b128 v[56:59], v121 offset:36864
    ds_read_b128 v[60:63], v121 offset:38912
    v_mfma_f32_16x16x32_bf16 v[88:91], v[40:43], v[32:35], v[88:91]
    ds_read_b64_tr_b16 v[64:65], v122 offset:40960
    ds_read_b64_tr_b16 v[66:67], v122 offset:41984
    v_mfma_f32_16x16x32_bf16 v[96:99], v[40:43], v[36:39], v[96:99]
    ds_read_b64_tr_b16 v[68:69], v123 offset:40960
    ds_read_b64_tr_b16 v[70:71], v123 offset:41984
    v_mfma_f32_16x16x32_bf16 v[76:79], v[44:47], v[24:27], v[76:79]
    s_add_u32 m0, s21, 66560
    s_nop 0
    global_load_lds_dwordx4 v13, s[28:29]
    s_add_u32 s28, s28, 131072
    s_addc_u32 s29, s29, 0
    s_add_u32 m0, s20, 99328
    s_nop 0
    global_load_lds_dwordx4 v11, s[24:25]
    s_add_u32 s24, s24, 128
    s_addc_u32 s25, s25, 0
    v_mfma_f32_16x16x32_bf16 v[84:87], v[44:47], v[28:31], v[84:87]
    v_mfma_f32_16x16x32_bf16 v[92:95], v[44:47], v[32:35], v[92:95]
    v_mfma_f32_16x16x32_bf16 v[100:103], v[44:47], v[36:39], v[100:103]
    s_waitcnt vmcnt(11) lgkmcnt(0)
    s_barrier
    v_mfma_f32_16x16x32_bf16 v[72:75], v[64:67], v[48:51], v[72:75]
    ds_read_b128 v[24:27], v16 offset:0
    ds_read_b128 v[28:31], v16 offset:2048
    v_mfma_f32_16x16x32_bf16 v[80:83], v[64:67], v[52:55], v[80:83]
    ds_read_b64_tr_b16 v[40:41], v18 offset:0
    ds_read_b64_tr_b16 v[42:43], v18 offset:1024
    v_mfma_f32_16x16x32_bf16 v[88:91], v[64:67], v[56:59], v[88:91]
    ds_read_b64_tr_b16 v[44:45], v19 offset:0
    ds_read_b64_tr_b16 v[46:47], v19 offset:1024
    v_mfma_f32_16x16x32_bf16 v[96:99], v[64:67], v[60:63], v[96:99]
    s_add_u32 m0, s21, 98304
    s_nop 0
    global_load_lds_dwordx4 v12, s[26:27]
    s_add_u32 m0, s21, 99328
    s_nop 0
    global_load_lds_dwordx4 v13, s[26:27]
    s_add_u32 s26, s26, 131072
    s_addc_u32 s27, s27, 0
    v_mfma_f32_16x16x32_bf16 v[76:79], v[68:71], v[48:51], v[76:79]
    v_mfma_f32_16x16x32_bf16 v[84:87], v[68:71], v[52:55], v[84:87]
    v_mfma_f32_16x16x32_bf16 v[92:95], v[68:71], v[56:59], v[92:95]
    v_mfma_f32_16x16x32_bf16 v[100:103], v[68:71], v[60:63], v[100:103]
    s_waitcnt lgkmcnt(0)
    v_mfma_f32_16x16x32_bf16 v[104:107], v[40:43], v[24:27], v[104:107]
    ds_read_b128 v[48:51], v17 offset:0
    ds_read_b128 v[52:55], v17 offset:2048
    ds_read_b64_tr_b16 v[64:65], v18 offset:8192
    v_mfma_f32_16x16x32_bf16 v[112:115], v[40:43], v[28:31], v[112:115]
    ds_read_b64_tr_b16 v[66:67], v18 offset:9216
    ds_read_b64_tr_b16 v[68:69], v19 offset:8192
    ds_read_b64_tr_b16 v[70:71], v19 offset:9216
    v_mfma_f32_16x16x32_bf16 v[108:111], v[44:47], v[24:27], v[108:111]
    s_add_u32 m0, s31, 131072
    s_nop 0
    global_load_lds_dwordx4 v14, s[22:23] sc1
    s_add_u32 s22, s22, 128
    s_addc_u32 s23, s23, 0
    v_mfma_f32_16x16x32_bf16 v[116:119], v[44:47], v[28:31], v[116:119]
    s_waitcnt vmcnt(10) lgkmcnt(0)
    s_barrier
    v_mfma_f32_16x16x32_bf16 v[104:107], v[64:67], v[48:51], v[104:107]
    ds_read_b128 v[24:27], v16 offset:16384
    ds_read_b128 v[28:31], v16 offset:18432
    ds_read_b128 v[32:35], v16 offset:20480
    v_mfma_f32_16x16x32_bf16 v[112:115], v[64:67], v[52:55], v[112:115]
    ds_read_b128 v[36:39], v16 offset:22528
    ds_read_b64_tr_b16 v[40:41], v18 offset:16384
    ds_read_b64_tr_b16 v[42:43], v18 offset:17408
    v_mfma_f32_16x16x32_bf16 v[108:111], v[68:71], v[48:51], v[108:111]
    ds_read_b64_tr_b16 v[44:45], v19 offset:16384
    ds_read_b64_tr_b16 v[46:47], v19 offset:17408
    s_add_u32 m0, s21, 0
    s_nop 0
    global_load_lds_dwordx4 v12, s[28:29]
    v_mfma_f32_16x16x32_bf16 v[116:119], v[68:71], v[52:55], v[116:119]
    s_add_u32 m0, s20, 0
    s_nop 0
    global_load_lds_dwordx4 v10, s[24:25]
    s_waitcnt lgkmcnt(0)
    v_mfma_f32_16x16x32_bf16 v[72:75], v[40:43], v[24:27], v[72:75]
    ds_read_b128 v[48:51], v17 offset:16384
    ds_read_b128 v[52:55], v17 offset:18432
    v_mfma_f32_16x16x32_bf16 v[80:83], v[40:43], v[28:31], v[80:83]
    ds_read_b128 v[56:59], v17 offset:20480
    ds_read_b128 v[60:63], v17 offset:22528
    v_mfma_f32_16x16x32_bf16 v[88:91], v[40:43], v[32:35], v[88:91]
    ds_read_b64_tr_b16 v[64:65], v18 offset:24576
    ds_read_b64_tr_b16 v[66:67], v18 offset:25600
    v_mfma_f32_16x16x32_bf16 v[96:99], v[40:43], v[36:39], v[96:99]
    ds_read_b64_tr_b16 v[68:69], v19 offset:24576
    ds_read_b64_tr_b16 v[70:71], v19 offset:25600
    v_mfma_f32_16x16x32_bf16 v[76:79], v[44:47], v[24:27], v[76:79]
    s_add_u32 m0, s21, 1024
    s_nop 0
    global_load_lds_dwordx4 v13, s[28:29]
    s_add_u32 s28, s28, 131072
    s_addc_u32 s29, s29, 0
    s_add_u32 m0, s20, 1024
    s_nop 0
    global_load_lds_dwordx4 v11, s[24:25]
    s_add_u32 s24, s24, 128
    s_addc_u32 s25, s25, 0
    v_mfma_f32_16x16x32_bf16 v[84:87], v[44:47], v[28:31], v[84:87]
    v_mfma_f32_16x16x32_bf16 v[92:95], v[44:47], v[32:35], v[92:95]
    v_mfma_f32_16x16x32_bf16 v[100:103], v[44:47], v[36:39], v[100:103]
    s_waitcnt vmcnt(11) lgkmcnt(0)
    s_barrier
    v_mfma_f32_16x16x32_bf16 v[72:75], v[64:67], v[48:51], v[72:75]
    ds_read_b128 v[24:27], v16 offset:32768
    ds_read_b128 v[28:31], v16 offset:34816
    v_mfma_f32_16x16x32_bf16 v[80:83], v[64:67], v[52:55], v[80:83]
    ds_read_b64_tr_b16 v[40:41], v18 offset:32768
    ds_read_b64_tr_b16 v[42:43], v18 offset:33792
    v_mfma_f32_16x16x32_bf16 v[88:91], v[64:67], v[56:59], v[88:91]
    ds_read_b64_tr_b16 v[44:45], v19 offset:32768
    ds_read_b64_tr_b16 v[46:47], v19 offset:33792
    v_mfma_f32_16x16x32_bf16 v[96:99], v[64:67], v[60:63], v[96:99]
    s_add_u32 m0, s21, 16384
    s_nop 0
    global_load_lds_dwordx4 v12, s[26:27]
    s_add_u32 m0, s21, 17408
    s_nop 0
    global_load_lds_dwordx4 v13, s[26:27]
    s_add_u32 s26, s26, 131072
    s_addc_u32 s27, s27, 0
    v_mfma_f32_16x16x32_bf16 v[76:79], v[68:71], v[48:51], v[76:79]
    v_mfma_f32_16x16x32_bf16 v[84:87], v[68:71], v[52:55], v[84:87]
    v_mfma_f32_16x16x32_bf16 v[92:95], v[68:71], v[56:59], v[92:95]
    v_mfma_f32_16x16x32_bf16 v[100:103], v[68:71], v[60:63], v[100:103]
    s_waitcnt lgkmcnt(0)
    v_mfma_f32_16x16x32_bf16 v[104:107], v[40:43], v[24:27], v[104:107]
    ds_read_b128 v[48:51], v17 offset:32768
    ds_read_b128 v[52:55], v17 offset:34816
    ds_read_b64_tr_b16 v[64:65], v18 offset:40960
    v_mfma_f32_16x16x32_bf16 v[112:115], v[40:43], v[28:31], v[112:115]
    ds_read_b64_tr_b16 v[66:67], v18 offset:41984
    ds_read_b64_tr_b16 v[68:69], v19 offset:40960
    ds_read_b64_tr_b16 v[70:71], v19 offset:41984
    v_mfma_f32_16x16x32_bf16 v[108:111], v[44:47], v[24:27], v[108:111]
    s_add_u32 m0, s31, 16384
    s_nop 0
    global_load_lds_dwordx4 v14, s[22:23] sc1
    s_add_u32 s22, s22, 128
    s_addc_u32 s23, s23, 0
    v_mfma_f32_16x16x32_bf16 v[116:119], v[44:47], v[28:31], v[116:119]
    s_waitcnt vmcnt(10) lgkmcnt(0)
    s_barrier
    v_mfma_f32_16x16x32_bf16 v[104:107], v[64:67], v[48:51], v[104:107]
    ds_read_b128 v[24:27], v120 offset:0
    ds_read_b128 v[28:31], v120 offset:2048
    ds_read_b128 v[32:35], v120 offset:4096
    v_mfma_f32_16x16x32_bf16 v[112:115], v[64:67], v[52:55], v[112:115]
    ds_read_b128 v[36:39], v120 offset:6144
    ds_read_b64_tr_b16 v[40:41], v122 offset:0
    ds_read_b64_tr_b16 v[42:43], v122 offset:1024
    v_mfma_f32_16x16x32_bf16 v[108:111], v[68:71], v[48:51], v[108:111]
    ds_read_b64_tr_b16 v[44:45], v123 offset:0
    ds_read_b64_tr_b16 v[46:47], v123 offset:1024
    s_add_u32 m0, s21, 32768
    s_nop 0
    global_load_lds_dwordx4 v12, s[26:27]
    v_mfma_f32_16x16x32_bf16 v[116:119], v[68:71], v[52:55], v[116:119]
    s_add_u32 m0, s21, 33792
    s_nop 0
    global_load_lds_dwordx4 v13, s[26:27]
    s_add_u32 s26, s26, 131072
    s_addc_u32 s27, s27, 0
    s_waitcnt lgkmcnt(0)
    v_mfma_f32_16x16x32_bf16 v[72:75], v[40:43], v[24:27], v[72:75]
    ds_read_b128 v[48:51], v121 offset:0
    ds_read_b128 v[52:55], v121 offset:2048
    v_mfma_f32_16x16x32_bf16 v[80:83], v[40:43], v[28:31], v[80:83]
    ds_read_b128 v[56:59], v121 offset:4096
    ds_read_b128 v[60:63], v121 offset:6144
    v_mfma_f32_16x16x32_bf16 v[88:91], v[40:43], v[32:35], v[88:91]
    ds_read_b64_tr_b16 v[64:65], v122 offset:8192
    ds_read_b64_tr_b16 v[66:67], v122 offset:9216
    v_mfma_f32_16x16x32_bf16 v[96:99], v[40:43], v[36:39], v[96:99]
    ds_read_b64_tr_b16 v[68:69], v123 offset:8192
    ds_read_b64_tr_b16 v[70:71], v123 offset:9216
    v_mfma_f32_16x16x32_bf16 v[76:79], v[44:47], v[24:27], v[76:79]
    s_add_u32 m0, s31, 32768
    s_nop 0
    global_load_lds_dwordx4 v14, s[22:23] sc1
    s_add_u32 s22, s22, 128
    s_addc_u32 s23, s23, 0
    v_mfma_f32_16x16x32_bf16 v[84:87], v[44:47], v[28:31], v[84:87]
    v_mfma_f32_16x16x32_bf16 v[92:95], v[44:47], v[32:35], v[92:95]
    v_mfma_f32_16x16x32_bf16 v[100:103], v[44:47], v[36:39], v[100:103]
    s_waitcnt vmcnt(10) lgkmcnt(0)
    s_barrier
    v_mfma_f32_16x16x32_bf16 v[72:75], v[64:67], v[48:51], v[72:75]
    ds_read_b128 v[24:27], v120 offset:32768
    ds_read_b128 v[28:31], v120 offset:34816
    v_mfma_f32_16x16x32_bf16 v[80:83], v[64:67], v[52:55], v[80:83]
    ds_read_b64_tr_b16 v[40:41], v122 offset:32768
    ds_read_b64_tr_b16 v[42:43], v122 offset:33792
    v_mfma_f32_16x16x32_bf16 v[88:91], v[64:67], v[56:59], v[88:91]
    ds_read_b64_tr_b16 v[44:45], v123 offset:32768
    ds_read_b64_tr_b16 v[46:47], v123 offset:33792
    v_mfma_f32_16x16x32_bf16 v[96:99], v[64:67], v[60:63], v[96:99]
    s_add_u32 m0, s21, 65536
    s_nop 0
    global_load_lds_dwordx4 v12, s[26:27]
    s_add_u32 m0, s21, 66560
    s_nop 0
    global_load_lds_dwordx4 v13, s[26:27]
    s_add_u32 s26, s26, 131072
    s_addc_u32 s27, s27, 0
    v_mfma_f32_16x16x32_bf16 v[76:79], v[68:71], v[48:51], v[76:79]
    v_mfma_f32_16x16x32_bf16 v[84:87], v[68:71], v[52:55], v[84:87]
    v_mfma_f32_16x16x32_bf16 v[92:95], v[68:71], v[56:59], v[92:95]
    v_mfma_f32_16x16x32_bf16 v[100:103], v[68:71], v[60:63], v[100:103]
    s_waitcnt lgkmcnt(0)
    v_mfma_f32_16x16x32_bf16 v[104:107], v[40:43], v[24:27], v[104:107]
    ds_read_b128 v[48:51], v121 offset:32768
    ds_read_b128 v[52:55], v121 offset:34816
    ds_read_b64_tr_b16 v[64:65], v122 offset:40960
    v_mfma_f32_16x16x32_bf16 v[112:115], v[40:43], v[28:31], v[112:115]
    ds_read_b64_tr_b16 v[66:67], v122 offset:41984
    ds_read_b64_tr_b16 v[68:69], v123 offset:40960
    ds_read_b64_tr_b16 v[70:71], v123 offset:41984
    v_mfma_f32_16x16x32_bf16 v[108:111], v[44:47], v[24:27], v[108:111]
    s_add_u32 m0, s31, 98304
    s_nop 0
    global_load_lds_dwordx4 v14, s[22:23] sc1
    s_add_u32 s22, s22, 128
    s_addc_u32 s23, s23, 0
    v_mfma_f32_16x16x32_bf16 v[116:119], v[44:47], v[28:31], v[116:119]
    s_waitcnt vmcnt(9) lgkmcnt(0)
    s_barrier
    v_mfma_f32_16x16x32_bf16 v[104:107], v[64:67], v[48:51], v[104:107]
    ds_read_b128 v[24:27], v16 offset:0
    ds_read_b128 v[28:31], v16 offset:2048
    ds_read_b128 v[32:35], v16 offset:4096
    v_mfma_f32_16x16x32_bf16 v[112:115], v[64:67], v[52:55], v[112:115]
    ds_read_b128 v[36:39], v16 offset:6144
    ds_read_b64_tr_b16 v[40:41], v18 offset:0
    ds_read_b64_tr_b16 v[42:43], v18 offset:1024
    v_mfma_f32_16x16x32_bf16 v[108:111], v[68:71], v[48:51], v[108:111]
    ds_read_b64_tr_b16 v[44:45], v19 offset:0
    ds_read_b64_tr_b16 v[46:47], v19 offset:1024
    s_add_u32 m0, s21, 98304
    s_nop 0
    global_load_lds_dwordx4 v12, s[26:27]
    v_mfma_f32_16x16x32_bf16 v[116:119], v[68:71], v[52:55], v[116:119]
    s_add_u32 m0, s21, 99328
    s_nop 0
    global_load_lds_dwordx4 v13, s[26:27]
    s_add_u32 s26, s26, 131072
    s_addc_u32 s27, s27, 0
    s_waitcnt lgkmcnt(0)
    v_mfma_f32_16x16x32_bf16 v[72:75], v[40:43], v[24:27], v[72:75]
    ds_read_b128 v[48:51], v17 offset:0
    ds_read_b128 v[52:55], v17 offset:2048
    v_mfma_f32_16x16x32_bf16 v[80:83], v[40:43], v[28:31], v[80:83]
    ds_read_b128 v[56:59], v17 offset:4096
    ds_read_b128 v[60:63], v17 offset:6144
    v_mfma_f32_16x16x32_bf16 v[88:91], v[40:43], v[32:35], v[88:91]
    ds_read_b64_tr_b16 v[64:65], v18 offset:8192
    ds_read_b64_tr_b16 v[66:67], v18 offset:9216
    v_mfma_f32_16x16x32_bf16 v[96:99], v[40:43], v[36:39], v[96:99]
    ds_read_b64_tr_b16 v[68:69], v19 offset:8192
    ds_read_b64_tr_b16 v[70:71], v19 offset:9216
    v_mfma_f32_16x16x32_bf16 v[76:79], v[44:47], v[24:27], v[76:79]
    s_add_u32 m0, s31, 131072
    s_nop 0
    global_load_lds_dwordx4 v14, s[22:23] sc1
    s_add_u32 s22, s22, 128
    s_addc_u32 s23, s23, 0
    v_mfma_f32_16x16x32_bf16 v[84:87], v[44:47], v[28:31], v[84:87]
    v_mfma_f32_16x16x32_bf16 v[92:95], v[44:47], v[32:35], v[92:95]
    v_mfma_f32_16x16x32_bf16 v[100:103], v[44:47], v[36:39], v[100:103]
    s_waitcnt vmcnt(9) lgkmcnt(0)
    s_barrier
    v_mfma_f32_16x16x32_bf16 v[72:75], v[64:67], v[48:51], v[72:75]
    ds_read_b128 v[24:27], v16 offset:16384
    ds_read_b128 v[28:31], v16 offset:18432
    v_mfma_f32_16x16x32_bf16 v[80:83], v[64:67], v[52:55], v[80:83]
    ds_read_b64_tr_b16 v[40:41], v18 offset:16384
    ds_read_b64_tr_b16 v[42:43], v18 offset:17408
    v_mfma_f32_16x16x32_bf16 v[88:91], v[64:67], v[56:59], v[88:91]
    ds_read_b64_tr_b16 v[44:45], v19 offset:16384
    ds_read_b64_tr_b16 v[46:47], v19 offset:17408
    v_mfma_f32_16x16x32_bf16 v[96:99], v[64:67], v[60:63], v[96:99]
    s_add_u32 m0, s21, 0
    s_nop 0
    global_load_lds_dwordx4 v12, s[26:27]
    s_add_u32 m0, s21, 1024
    s_nop 0
    global_load_lds_dwordx4 v13, s[26:27]
    s_add_u32 s26, s26, 131072
    s_addc_u32 s27, s27, 0
    v_mfma_f32_16x16x32_bf16 v[76:79], v[68:71], v[48:51], v[76:79]
    v_mfma_f32_16x16x32_bf16 v[84:87], v[68:71], v[52:55], v[84:87]
    v_mfma_f32_16x16x32_bf16 v[92:95], v[68:71], v[56:59], v[92:95]
    v_mfma_f32_16x16x32_bf16 v[100:103], v[68:71], v[60:63], v[100:103]
    s_waitcnt lgkmcnt(0)
    v_mfma_f32_16x16x32_bf16 v[104:107], v[40:43], v[24:27], v[104:107]
    ds_read_b128 v[48:51], v17 offset:16384
    ds_read_b128 v[52:55], v17 offset:18432
    ds_read_b64_tr_b16 v[64:65], v18 offset:24576
    v_mfma_f32_16x16x32_bf16 v[112:115], v[40:43], v[28:31], v[112:115]
    ds_read_b64_tr_b16 v[66:67], v18 offset:25600
    ds_read_b64_tr_b16 v[68:69], v19 offset:24576
    ds_read_b64_tr_b16 v[70:71], v19 offset:25600
    v_mfma_f32_16x16x32_bf16 v[108:111], v[44:47], v[24:27], v[108:111]
    s_nop 7
    s_lshl_b32 s33, s2, 16
    s_lshl_b32 s34, s14, 13
    s_add_u32 s33, s33, s34
    s_add_u32 s33, s33, 50331648
    v_lshlrev_b32 v4, 4, v0
    v_add_u32 v5, s33, v4
    s_xor_b32 s33, s33, 524288
    v_add_u32 v6, s33, v4
    global_store_dwordx4 v5, v[88:91], s[12:13] offset:0 sc1
    global_store_dwordx4 v5, v[92:95], s[12:13] offset:1024 sc1
    v_mfma_f32_16x16x32_bf16 v[116:119], v[44:47], v[28:31], v[116:119]
    global_store_dwordx4 v5, v[96:99], s[12:13] offset:2048 sc1
    global_store_dwordx4 v5, v[100:103], s[12:13] offset:3072 sc1
    s_add_u32 m0, s31, 0
    s_nop 0
    global_load_lds_dwordx4 v14, s[22:23] sc1
    s_add_u32 s22, s22, 128
    s_addc_u32 s23, s23, 0
    s_waitcnt vmcnt(13) lgkmcnt(0)
    s_barrier
    v_mfma_f32_16x16x32_bf16 v[104:107], v[64:67], v[48:51], v[104:107]
    ds_read_b128 v[24:27], v16 offset:32768
    ds_read_b128 v[28:31], v16 offset:34816
    ds_read_b64_tr_b16 v[40:41], v18 offset:32768
    v_mfma_f32_16x16x32_bf16 v[112:115], v[64:67], v[52:55], v[112:115]
    ds_read_b64_tr_b16 v[42:43], v18 offset:33792
    ds_read_b64_tr_b16 v[44:45], v19 offset:32768
    ds_read_b64_tr_b16 v[46:47], v19 offset:33792
    v_mfma_f32_16x16x32_bf16 v[108:111], v[68:71], v[48:51], v[108:111]
    s_add_u32 m0, s21, 16384
    s_nop 0
    global_load_lds_dwordx4 v12, s[26:27]
    s_add_u32 m0, s21, 17408
    s_nop 0
    global_load_lds_dwordx4 v13, s[26:27]
    s_add_u32 s26, s26, 131072
    s_addc_u32 s27, s27, 0
    v_mfma_f32_16x16x32_bf16 v[116:119], v[68:71], v[52:55], v[116:119]
    s_waitcnt lgkmcnt(0)
    v_mfma_f32_16x16x32_bf16 v[104:107], v[40:43], v[24:27], v[104:107]
    ds_read_b128 v[48:51], v17 offset:32768
    ds_read_b128 v[52:55], v17 offset:34816
    ds_read_b64_tr_b16 v[64:65], v18 offset:40960
    v_mfma_f32_16x16x32_bf16 v[112:115], v[40:43], v[28:31], v[112:115]
    ds_read_b64_tr_b16 v[66:67], v18 offset:41984
    ds_read_b64_tr_b16 v[68:69], v19 offset:40960
    ds_read_b64_tr_b16 v[70:71], v19 offset:41984
    v_mfma_f32_16x16x32_bf16 v[108:111], v[44:47], v[24:27], v[108:111]
    s_add_u32 m0, s31, 16384
    s_nop 0
    global_load_lds_dwordx4 v14, s[22:23] sc1
    s_add_u32 s22, s22, 128
    s_addc_u32 s23, s23, 0
    v_mfma_f32_16x16x32_bf16 v[116:119], v[44:47], v[28:31], v[116:119]
    s_waitcnt vmcnt(13) lgkmcnt(0)
    s_barrier
    v_mfma_f32_16x16x32_bf16 v[104:107], v[64:67], v[48:51], v[104:107]
    ds_read_b128 v[24:27], v120 offset:0
    ds_read_b128 v[28:31], v120 offset:2048
    ds_read_b64_tr_b16 v[40:41], v122 offset:0
    v_mfma_f32_16x16x32_bf16 v[112:115], v[64:67], v[52:55], v[112:115]
    ds_read_b64_tr_b16 v[42:43], v122 offset:1024
    ds_read_b64_tr_b16 v[44:45], v123 offset:0
    ds_read_b64_tr_b16 v[46:47], v123 offset:1024
    v_mfma_f32_16x16x32_bf16 v[108:111], v[68:71], v[48:51], v[108:111]
    s_add_u32 m0, s21, 32768
    s_nop 0
    global_load_lds_dwordx4 v12, s[26:27]
    s_add_u32 m0, s21, 33792
    s_nop 0
    global_load_lds_dwordx4 v13, s[26:27]
    s_add_u32 s26, s26, 131072
    s_addc_u32 s27, s27, 0
    v_mfma_f32_16x16x32_bf16 v[116:119], v[68:71], v[52:55], v[116:119]
    s_waitcnt lgkmcnt(0)
    v_mfma_f32_16x16x32_bf16 v[104:107], v[40:43], v[24:27], v[104:107]
    ds_read_b128 v[48:51], v121 offset:0
    ds_read_b128 v[52:55], v121 offset:2048
    ds_read_b64_tr_b16 v[64:65], v122 offset:8192
    v_mfma_f32_16x16x32_bf16 v[112:115], v[40:43], v[28:31], v[112:115]
    ds_read_b64_tr_b16 v[66:67], v122 offset:9216
    ds_read_b64_tr_b16 v[68:69], v123 offset:8192
    ds_read_b64_tr_b16 v[70:71], v123 offset:9216
    v_mfma_f32_16x16x32_bf16 v[108:111], v[44:47], v[24:27], v[108:111]
    s_add_u32 m0, s31, 32768
    s_nop 0
    global_load_lds_dwordx4 v14, s[22:23] sc1
    s_add_u32 s22, s22, 128
    s_addc_u32 s23, s23, 0
    v_mfma_f32_16x16x32_bf16 v[116:119], v[44:47], v[28:31], v[116:119]
    s_waitcnt vmcnt(7) lgkmcnt(0)
    s_barrier
    s_cmp_lg_u32 s14, 0
    s_cbranch_scc1 LA_f0
    s_lshl_b32 s33, s2, 8
    s_add_u32 s33, s33, 46137344
    v_mov_b32 v7, s33
    v_mov_b32 v8, 1
    v_cmp_eq_u32 vcc, 0, v0
    s_and_saveexec_b64 s[38:39], vcc
    global_store_dword v7, v8, s[12:13] sc1
    s_mov_b64 exec, s[38:39]
LA_f0:
    v_mfma_f32_16x16x32_bf16 v[104:107], v[64:67], v[48:51], v[104:107]
    ds_read_b128 v[24:27], v120 offset:32768
    ds_read_b128 v[28:31], v120 offset:34816
    ds_read_b64_tr_b16 v[40:41], v122 offset:32768
    v_mfma_f32_16x16x32_bf16 v[112:115], v[64:67], v[52:55], v[112:115]
    ds_read_b64_tr_b16 v[42:43], v122 offset:33792
    ds_read_b64_tr_b16 v[44:45], v123 offset:32768
    ds_read_b64_tr_b16 v[46:47], v123 offset:33792
    v_mfma_f32_16x16x32_bf16 v[108:111], v[68:71], v[48:51], v[108:111]
    s_add_u32 m0, s21, 65536
    s_nop 0
    global_load_lds_dwordx4 v12, s[26:27]
    s_add_u32 m0, s21, 66560
    s_nop 0
    global_load_lds_dwordx4 v13, s[26:27]
    s_add_u32 s26, s26, 131072
    s_addc_u32 s27, s27, 0
    v_mfma_f32_16x16x32_bf16 v[116:119], v[68:71], v[52:55], v[116:119]
    s_waitcnt lgkmcnt(0)
    v_mfma_f32_16x16x32_bf16 v[104:107], v[40:43], v[24:27], v[104:107]
    ds_read_b128 v[48:51], v121 offset:32768
    ds_read_b128 v[52:55], v121 offset:34816
    ds_read_b64_tr_b16 v[64:65], v122 offset:40960
    v_mfma_f32_16x16x32_bf16 v[112:115], v[40:43], v[28:31], v[112:115]
    ds_read_b64_tr_b16 v[66:67], v122 offset:41984
    ds_read_b64_tr_b16 v[68:69], v123 offset:40960
    ds_read_b64_tr_b16 v[70:71], v123 offset:41984
    v_mfma_f32_16x16x32_bf16 v[108:111], v[44:47], v[24:27], v[108:111]
    s_add_u32 m0, s31, 98304
    s_nop 0
    global_load_lds_dwordx4 v14, s[22:23] sc1
    s_add_u32 s22, s22, 128
    s_addc_u32 s23, s23, 0
    v_mfma_f32_16x16x32_bf16 v[116:119], v[44:47], v[28:31], v[116:119]
    s_waitcnt vmcnt(9) lgkmcnt(0)
    s_barrier
    v_mfma_f32_16x16x32_bf16 v[104:107], v[64:67], v[48:51], v[104:107]
    ds_read_b128 v[24:27], v16 offset:0
    ds_read_b128 v[28:31], v16 offset:2048
    ds_read_b64_tr_b16 v[40:41], v18 offset:0
    v_mfma_f32_16x16x32_bf16 v[112:115], v[64:67], v[52:55], v[112:115]
    ds_read_b64_tr_b16 v[42:43], v18 offset:1024
    ds_read_b64_tr_b16 v[44:45], v19 offset:0
    ds_read_b64_tr_b16 v[46:47], v19 offset:1024
    v_mfma_f32_16x16x32_bf16 v[108:111], v[68:71], v[48:51], v[108:111]
    s_add_u32 m0, s21, 98304
    s_nop 0
    global_load_lds_dwordx4 v12, s[26:27]
    s_add_u32 m0, s21, 99328
    s_nop 0
    global_load_lds_dwordx4 v13, s[26:27]
    s_add_u32 s26, s26, 131072
    s_addc_u32 s27, s27, 0
    v_mfma_f32_16x16x32_bf16 v[116:119], v[68:71], v[52:55], v[116:119]
    s_waitcnt lgkmcnt(0)
    v_mfma_f32_16x16x32_bf16 v[104:107], v[40:43], v[24:27], v[104:107]
    ds_read_b128 v[48:51], v17 offset:0
    ds_read_b128 v[52:55], v17 offset:2048
    ds_read_b64_tr_b16 v[64:65], v18 offset:8192
    v_mfma_f32_16x16x32_bf16 v[112:115], v[40:43], v[28:31], v[112:115]
    ds_read_b64_tr_b16 v[66:67], v18 offset:9216
    ds_read_b64_tr_b16 v[68:69], v19 offset:8192
    ds_read_b64_tr_b16 v[70:71], v19 offset:9216
    v_mfma_f32_16x16x32_bf16 v[108:111], v[44:47], v[24:27], v[108:111]
    s_add_u32 m0, s31, 131072
    s_nop 0
    global_load_lds_dwordx4 v14, s[22:23] sc1
    s_add_u32 s22, s22, 128
    s_addc_u32 s23, s23, 0
    v_mfma_f32_16x16x32_bf16 v[116:119], v[44:47], v[28:31], v[116:119]
    s_waitcnt vmcnt(9) lgkmcnt(0)
    s_barrier
    v_mfma_f32_16x16x32_bf16 v[104:107], v[64:67], v[48:51], v[104:107]
    ds_read_b128 v[24:27], v16 offset:16384
    ds_read_b128 v[28:31], v16 offset:18432
    ds_read_b64_tr_b16 v[40:41], v18 offset:16384
    v_mfma_f32_16x16x32_bf16 v[112:115], v[64:67], v[52:55], v[112:115]
    ds_read_b64_tr_b16 v[42:43], v18 offset:17408
    ds_read_b64_tr_b16 v[44:45], v19 offset:16384
    ds_read_b64_tr_b16 v[46:47], v19 offset:17408
    v_mfma_f32_16x16x32_bf16 v[108:111], v[68:71], v[48:51], v[108:111]
    s_add_u32 m0, s21, 0
    s_nop 0
    global_load_lds_dwordx4 v12, s[26:27]
    s_add_u32 m0, s21, 1024
    s_nop 0
    global_load_lds_dwordx4 v13, s[26:27]
    s_add_u32 s26, s26, 131072
    s_addc_u32 s27, s27, 0
    v_mfma_f32_16x16x32_bf16 v[116:119], v[68:71], v[52:55], v[116:119]
    s_waitcnt lgkmcnt(0)
    v_mfma_f32_16x16x32_bf16 v[104:107], v[40:43], v[24:27], v[104:107]
    ds_read_b128 v[48:51], v17 offset:16384
    ds_read_b128 v[52:55], v17 offset:18432
    ds_read_b64_tr_b16 v[64:65], v18 offset:24576
    v_mfma_f32_16x16x32_bf16 v[112:115], v[40:43], v[28:31], v[112:115]
    ds_read_b64_tr_b16 v[66:67], v18 offset:25600
    ds_read_b64_tr_b16 v[68:69], v19 offset:24576
    ds_read_b64_tr_b16 v[70:71], v19 offset:25600
    v_mfma_f32_16x16x32_bf16 v[108:111], v[44:47], v[24:27], v[108:111]
    s_add_u32 m0, s31, 0
    s_nop 0
    global_load_lds_dwordx4 v14, s[22:23] sc1
    s_add_u32 s22, s22, 128
    s_addc_u32 s23, s23, 0
    v_mfma_f32_16x16x32_bf16 v[116:119], v[44:47], v[28:31], v[116:119]
    s_waitcnt vmcnt(9) lgkmcnt(0)
    s_barrier
    v_mfma_f32_16x16x32_bf16 v[104:107], v[64:67], v[48:51], v[104:107]
    ds_read_b128 v[24:27], v16 offset:32768
    ds_read_b128 v[28:31], v16 offset:34816
    ds_read_b64_tr_b16 v[40:41], v18 offset:32768
    v_mfma_f32_16x16x32_bf16 v[112:115], v[64:67], v[52:55], v[112:115]
    ds_read_b64_tr_b16 v[42:43], v18 offset:33792
    ds_read_b64_tr_b16 v[44:45], v19 offset:32768
    ds_read_b64_tr_b16 v[46:47], v19 offset:33792
    v_mfma_f32_16x16x32_bf16 v[108:111], v[68:71], v[48:51], v[108:111]
    v_mfma_f32_16x16x32_bf16 v[116:119], v[68:71], v[52:55], v[116:119]
    s_waitcnt lgkmcnt(0)
    v_mfma_f32_16x16x32_bf16 v[104:107], v[40:43], v[24:27], v[104:107]
    ds_read_b128 v[48:51], v17 offset:32768
    ds_read_b128 v[52:55], v17 offset:34816
    ds_read_b64_tr_b16 v[64:65], v18 offset:40960
    v_mfma_f32_16x16x32_bf16 v[112:115], v[40:43], v[28:31], v[112:115]
    ds_read_b64_tr_b16 v[66:67], v18 offset:41984
    ds_read_b64_tr_b16 v[68:69], v19 offset:40960
    ds_read_b64_tr_b16 v[70:71], v19 offset:41984
    v_mfma_f32_16x16x32_bf16 v[108:111], v[44:47], v[24:27], v[108:111]
    v_mfma_f32_16x16x32_bf16 v[116:119], v[44:47], v[28:31], v[116:119]
    s_waitcnt vmcnt(6) lgkmcnt(0)
    s_barrier
    v_mfma_f32_16x16x32_bf16 v[104:107], v[64:67], v[48:51], v[104:107]
    ds_read_b128 v[24:27], v120 offset:0
    ds_read_b128 v[28:31], v120 offset:2048
    ds_read_b64_tr_b16 v[40:41], v122 offset:0
    v_mfma_f32_16x16x32_bf16 v[112:115], v[64:67], v[52:55], v[112:115]
    ds_read_b64_tr_b16 v[42:43], v122 offset:1024
    ds_read_b64_tr_b16 v[44:45], v123 offset:0
    ds_read_b64_tr_b16 v[46:47], v123 offset:1024
    v_mfma_f32_16x16x32_bf16 v[108:111], v[68:71], v[48:51], v[108:111]
    v_mfma_f32_16x16x32_bf16 v[116:119], v[68:71], v[52:55], v[116:119]
    s_waitcnt lgkmcnt(0)
    v_mfma_f32_16x16x32_bf16 v[104:107], v[40:43], v[24:27], v[104:107]
    ds_read_b128 v[48:51], v121 offset:0
    ds_read_b128 v[52:55], v121 offset:2048
    ds_read_b64_tr_b16 v[64:65], v122 offset:8192
    v_mfma_f32_16x16x32_bf16 v[112:115], v[40:43], v[28:31], v[112:115]
    ds_read_b64_tr_b16 v[66:67], v122 offset:9216
    ds_read_b64_tr_b16 v[68:69], v123 offset:8192
    ds_read_b64_tr_b16 v[70:71], v123 offset:9216
    v_mfma_f32_16x16x32_bf16 v[108:111], v[44:47], v[24:27], v[108:111]
    v_mfma_f32_16x16x32_bf16 v[116:119], v[44:47], v[28:31], v[116:119]
    s_cmp_lg_u32 s14, 0
    s_cbranch_scc1 LA_x0
    s_xor_b32 s33, s2, 8
    s_lshl_b32 s33, s33, 8
    s_add_u32 s33, s33, 46137344
    v_mov_b32 v7, s33
LA_x0p:
    global_load_dword v8, v7, s[12:13] sc1
    s_waitcnt vmcnt(0)
    v_cmp_eq_u32 vcc, 0, v8
    s_cbranch_vccz LA_x0
    s_sleep 1
    s_branch LA_x0p
LA_x0:
    s_waitcnt vmcnt(3) lgkmcnt(0)
    s_barrier
    v_mfma_f32_16x16x32_bf16 v[104:107], v[64:67], v[48:51], v[104:107]
    ds_read_b128 v[24:27], v120 offset:32768
    ds_read_b128 v[28:31], v120 offset:34816
    ds_read_b64_tr_b16 v[40:41], v122 offset:32768
    v_mfma_f32_16x16x32_bf16 v[112:115], v[64:67], v[52:55], v[112:115]
    ds_read_b64_tr_b16 v[42:43], v122 offset:33792
    ds_read_b64_tr_b16 v[44:45], v123 offset:32768
    ds_read_b64_tr_b16 v[46:47], v123 offset:33792
    v_mfma_f32_16x16x32_bf16 v[108:111], v[68:71], v[48:51], v[108:111]
    v_mfma_f32_16x16x32_bf16 v[116:119], v[68:71], v[52:55], v[116:119]
    s_waitcnt lgkmcnt(0)
    v_mfma_f32_16x16x32_bf16 v[104:107], v[40:43], v[24:27], v[104:107]
    ds_read_b128 v[48:51], v121 offset:32768
    ds_read_b128 v[52:55], v121 offset:34816
    ds_read_b64_tr_b16 v[64:65], v122 offset:40960
    v_mfma_f32_16x16x32_bf16 v[112:115], v[40:43], v[28:31], v[112:115]
    ds_read_b64_tr_b16 v[66:67], v122 offset:41984
    ds_read_b64_tr_b16 v[68:69], v123 offset:40960
    ds_read_b64_tr_b16 v[70:71], v123 offset:41984
    v_mfma_f32_16x16x32_bf16 v[108:111], v[44:47], v[24:27], v[108:111]
    global_load_dwordx4 v[88:91], v6, s[12:13] offset:0 sc1
    global_load_dwordx4 v[92:95], v6, s[12:13] offset:1024 sc1
    global_load_dwordx4 v[96:99], v6, s[12:13] offset:2048 sc1
    v_mfma_f32_16x16x32_bf16 v[116:119], v[44:47], v[28:31], v[116:119]
    global_load_dwordx4 v[100:103], v6, s[12:13] offset:3072 sc1
    s_waitcnt vmcnt(4) lgkmcnt(0)
    s_barrier
    v_mfma_f32_16x16x32_bf16 v[104:107], v[64:67], v[48:51], v[104:107]
    ds_read_b128 v[24:27], v16 offset:0
    ds_read_b128 v[28:31], v16 offset:2048
    ds_read_b64_tr_b16 v[40:41], v18 offset:0
    v_mfma_f32_16x16x32_bf16 v[112:115], v[64:67], v[52:55], v[112:115]
    ds_read_b64_tr_b16 v[42:43], v18 offset:1024
    ds_read_b64_tr_b16 v[44:45], v19 offset:0
    ds_read_b64_tr_b16 v[46:47], v19 offset:1024
    v_mfma_f32_16x16x32_bf16 v[108:111], v[68:71], v[48:51], v[108:111]
    v_mfma_f32_16x16x32_bf16 v[116:119], v[68:71], v[52:55], v[116:119]
    s_waitcnt lgkmcnt(0)
    v_mfma_f32_16x16x32_bf16 v[104:107], v[40:43], v[24:27], v[104:107]
    ds_read_b128 v[48:51], v17 offset:0
    ds_read_b128 v[52:55], v17 offset:2048
    ds_read_b64_tr_b16 v[64:65], v18 offset:8192
    v_mfma_f32_16x16x32_bf16 v[112:115], v[40:43], v[28:31], v[112:115]
    ds_read_b64_tr_b16 v[66:67], v18 offset:9216
    ds_read_b64_tr_b16 v[68:69], v19 offset:8192
    ds_read_b64_tr_b16 v[70:71], v19 offset:9216
    v_mfma_f32_16x16x32_bf16 v[108:111], v[44:47], v[24:27], v[108:111]
    v_mfma_f32_16x16x32_bf16 v[116:119], v[44:47], v[28:31], v[116:119]
    s_waitcnt lgkmcnt(0)
    v_mfma_f32_16x16x32_bf16 v[104:107], v[64:67], v[48:51], v[104:107]
    v_mfma_f32_16x16x32_bf16 v[112:115], v[64:67], v[52:55], v[112:115]
    v_mfma_f32_16x16x32_bf16 v[108:111], v[68:71], v[48:51], v[108:111]
    v_mfma_f32_16x16x32_bf16 v[116:119], v[68:71], v[52:55], v[116:119]
    v_add_u32 v8, s30, v2
    v_lshl_add_u32 v7, v8, 11, v1
    s_lshl_b32 s33, s15, 8
    s_lshl_b32 s34, s18, 6
    s_add_u32 s33, s33, s34
    s_add_u32 s8, s8, s33
    s_addc_u32 s9, s9, 0
    v_sub_f32 v22, 1.0, v20
    v_sub_f32 v23, 1.0, v21
    v_cvt_pk_bf16_f32 v22, 0, v22
    v_cvt_pk_bf16_f32 v23, 0, v23
    s_waitcnt vmcnt(0)
    s_nop 4
    v_add_f32 v72, v72, v88
    v_add_f32 v73, v73, v89
    v_add_f32 v74, v74, v90
    v_add_f32 v75, v75, v91
    v_cvt_pk_bf16_f32 v104, 0, v104
    v_cvt_pk_bf16_f32 v72, 0, v72
    v_cvt_pk_bf16_f32 v105, 0, v105
    v_cvt_pk_bf16_f32 v73, 0, v73
    v_cvt_pk_bf16_f32 v106, 0, v106
    v_cvt_pk_bf16_f32 v74, 0, v74
    v_cvt_pk_bf16_f32 v107, 0, v107
    v_cvt_pk_bf16_f32 v75, 0, v75
    v_mul_f32 v104, v104, v20
    v_mul_f32 v72, v72, v22
    v_mul_f32 v105, v105, v20
    v_mul_f32 v73, v73, v22
    v_mul_f32 v106, v106, v20
    v_mul_f32 v74, v74, v22
    v_mul_f32 v107, v107, v20
    v_mul_f32 v75, v75, v22
    v_cvt_pk_bf16_f32 v104, 0, v104
    v_cvt_pk_bf16_f32 v72, 0, v72
    v_cvt_pk_bf16_f32 v105, 0, v105
    v_cvt_pk_bf16_f32 v73, 0, v73
    v_cvt_pk_bf16_f32 v106, 0, v106
    v_cvt_pk_bf16_f32 v74, 0, v74
    v_cvt_pk_bf16_f32 v107, 0, v107
    v_cvt_pk_bf16_f32 v75, 0, v75
    v_add_f32 v104, v104, v72
    v_add_f32 v105, v105, v73
    v_add_f32 v106, v106, v74
    v_add_f32 v107, v107, v75
    v_cvt_pk_bf16_f32 v24, v104, v105
    v_cvt_pk_bf16_f32 v25, v106, v107
    v_add_f32 v76, v76, v92
    v_add_f32 v77, v77, v93
    v_add_f32 v78, v78, v94
    v_add_f32 v79, v79, v95
    v_cvt_pk_bf16_f32 v108, 0, v108
    v_cvt_pk_bf16_f32 v76, 0, v76
    v_cvt_pk_bf16_f32 v109, 0, v109
    v_cvt_pk_bf16_f32 v77, 0, v77
    v_cvt_pk_bf16_f32 v110, 0, v110
    v_cvt_pk_bf16_f32 v78, 0, v78
    v_cvt_pk_bf16_f32 v111, 0, v111
    v_cvt_pk_bf16_f32 v79, 0, v79
    v_mul_f32 v108, v108, v20
    v_mul_f32 v76, v76, v22
    v_mul_f32 v109, v109, v20
    v_mul_f32 v77, v77, v22
    v_mul_f32 v110, v110, v20
    v_mul_f32 v78, v78, v22
    v_mul_f32 v111, v111, v20
    v_mul_f32 v79, v79, v22
    v_cvt_pk_bf16_f32 v108, 0, v108
    v_cvt_pk_bf16_f32 v76, 0, v76
    v_cvt_pk_bf16_f32 v109, 0, v109
    v_cvt_pk_bf16_f32 v77, 0, v77
    v_cvt_pk_bf16_f32 v110, 0, v110
    v_cvt_pk_bf16_f32 v78, 0, v78
    v_cvt_pk_bf16_f32 v111, 0, v111
    v_cvt_pk_bf16_f32 v79, 0, v79
    v_add_f32 v108, v108, v76
    v_add_f32 v109, v109, v77
    v_add_f32 v110, v110, v78
    v_add_f32 v111, v111, v79
    v_cvt_pk_bf16_f32 v26, v108, v109
    v_cvt_pk_bf16_f32 v27, v110, v111
    s_nop 1
    v_permlane16_swap_b32 v24, v26
    v_permlane16_swap_b32 v25, v27
    global_store_dwordx4 v7, v[24:27], s[8:9]
    v_add_f32 v80, v80, v96
    v_add_f32 v81, v81, v97
    v_add_f32 v82, v82, v98
    v_add_f32 v83, v83, v99
    v_cvt_pk_bf16_f32 v112, 0, v112
    v_cvt_pk_bf16_f32 v80, 0, v80
    v_cvt_pk_bf16_f32 v113, 0, v113
    v_cvt_pk_bf16_f32 v81, 0, v81
    v_cvt_pk_bf16_f32 v114, 0, v114
    v_cvt_pk_bf16_f32 v82, 0, v82
    v_cvt_pk_bf16_f32 v115, 0, v115
    v_cvt_pk_bf16_f32 v83, 0, v83
    v_mul_f32 v112, v112, v21
    v_mul_f32 v80, v80, v23
    v_mul_f32 v113, v113, v21
    v_mul_f32 v81, v81, v23
    v_mul_f32 v114, v114, v21
    v_mul_f32 v82, v82, v23
    v_mul_f32 v115, v115, v21
    v_mul_f32 v83, v83, v23
    v_cvt_pk_bf16_f32 v112, 0, v112
    v_cvt_pk_bf16_f32 v80, 0, v80
    v_cvt_pk_bf16_f32 v113, 0, v113
    v_cvt_pk_bf16_f32 v81, 0, v81
    v_cvt_pk_bf16_f32 v114, 0, v114
    v_cvt_pk_bf16_f32 v82, 0, v82
    v_cvt_pk_bf16_f32 v115, 0, v115
    v_cvt_pk_bf16_f32 v83, 0, v83
    v_add_f32 v112, v112, v80
    v_add_f32 v113, v113, v81
    v_add_f32 v114, v114, v82
    v_add_f32 v115, v115, v83
    v_cvt_pk_bf16_f32 v28, v112, v113
    v_cvt_pk_bf16_f32 v29, v114, v115
    v_add_f32 v84, v84, v100
    v_add_f32 v85, v85, v101
    v_add_f32 v86, v86, v102
    v_add_f32 v87, v87, v103
    v_cvt_pk_bf16_f32 v116, 0, v116
    v_cvt_pk_bf16_f32 v84, 0, v84
    v_cvt_pk_bf16_f32 v117, 0, v117
    v_cvt_pk_bf16_f32 v85, 0, v85
    v_cvt_pk_bf16_f32 v118, 0, v118
    v_cvt_pk_bf16_f32 v86, 0, v86
    v_cvt_pk_bf16_f32 v119, 0, v119
    v_cvt_pk_bf16_f32 v87, 0, v87
    v_mul_f32 v116, v116, v21
    v_mul_f32 v84, v84, v23
    v_mul_f32 v117, v117, v21
    v_mul_f32 v85, v85, v23
    v_mul_f32 v118, v118, v21
    v_mul_f32 v86, v86, v23
    v_mul_f32 v119, v119, v21
    v_mul_f32 v87, v87, v23
    v_cvt_pk_bf16_f32 v116, 0, v116
    v_cvt_pk_bf16_f32 v84, 0, v84
    v_cvt_pk_bf16_f32 v117, 0, v117
    v_cvt_pk_bf16_f32 v85, 0, v85
    v_cvt_pk_bf16_f32 v118, 0, v118
    v_cvt_pk_bf16_f32 v86, 0, v86
    v_cvt_pk_bf16_f32 v119, 0, v119
    v_cvt_pk_bf16_f32 v87, 0, v87
    v_add_f32 v116, v116, v84
    v_add_f32 v117, v117, v85
    v_add_f32 v118, v118, v86
    v_add_f32 v119, v119, v87
    v_cvt_pk_bf16_f32 v30, v116, v117
    v_cvt_pk_bf16_f32 v31, v118, v119
    s_nop 1
    v_permlane16_swap_b32 v28, v30
    v_permlane16_swap_b32 v29, v31
    v_add_u32 v7, 32768, v7
    global_store_dwordx4 v7, v[28:31], s[8:9]
    s_endpgm
LA_g1:
    s_waitcnt vmcnt(10)
    s_barrier
    ds_read_b128 v[24:27], v16 offset:0
    ds_read_b128 v[28:31], v16 offset:2048
    ds_read_b128 v[32:35], v16 offset:4096
    ds_read_b128 v[36:39], v16 offset:6144
    ds_read_b64_tr_b16 v[40:41], v18 offset:0
    ds_read_b64_tr_b16 v[42:43], v18 offset:1024
    ds_read_b64_tr_b16 v[44:45], v19 offset:0
    ds_read_b64_tr_b16 v[46:47], v19 offset:1024
    s_waitcnt lgkmcnt(0)
    v_mfma_f32_16x16x32_bf16 v[72:75], v[40:43], v[24:27], 0
    ds_read_b128 v[48:51], v17 offset:0
    ds_read_b128 v[52:55], v17 offset:2048
    v_mfma_f32_16x16x32_bf16 v[80:83], v[40:43], v[28:31], 0
    ds_read_b128 v[56:59], v17 offset:4096
    ds_read_b128 v[60:63], v17 offset:6144
    v_mfma_f32_16x16x32_bf16 v[88:91], v[40:43], v[32:35], 0
    ds_read_b64_tr_b16 v[64:65], v18 offset:8192
    ds_read_b64_tr_b16 v[66:67], v18 offset:9216
    v_mfma_f32_16x16x32_bf16 v[96:99], v[40:43], v[36:39], 0
    ds_read_b64_tr_b16 v[68:69], v19 offset:8192
    ds_read_b64_tr_b16 v[70:71], v19 offset:9216
    v_mfma_f32_16x16x32_bf16 v[76:79], v[44:47], v[24:27], 0
    v_mfma_f32_16x16x32_bf16 v[84:87], v[44:47], v[28:31], 0
    v_mfma_f32_16x16x32_bf16 v[92:95], v[44:47], v[32:35], 0
    v_mfma_f32_16x16x32_bf16 v[100:103], v[44:47], v[36:39], 0
    s_waitcnt vmcnt(6) lgkmcnt(0)
    s_barrier
    v_mfma_f32_16x16x32_bf16 v[72:75], v[64:67], v[48:51], v[72:75]
    ds_read_b128 v[24:27], v16 offset:16384
    ds_read_b128 v[28:31], v16 offset:18432
    v_mfma_f32_16x16x32_bf16 v[80:83], v[64:67], v[52:55], v[80:83]
    ds_read_b128 v[32:35], v16 offset:20480
    ds_read_b128 v[36:39], v16 offset:22528
    v_mfma_f32_16x16x32_bf16 v[88:91], v[64:67], v[56:59], v[88:91]
    ds_read_b64_tr_b16 v[40:41], v18 offset:16384
    ds_read_b64_tr_b16 v[42:43], v18 offset:17408
    v_mfma_f32_16x16x32_bf16 v[96:99], v[64:67], v[60:63], v[96:99]
    ds_read_b64_tr_b16 v[44:45], v19 offset:16384
    ds_read_b64_tr_b16 v[46:47], v19 offset:17408
    v_mfma_f32_16x16x32_bf16 v[76:79], v[68:71], v[48:51], v[76:79]
    s_add_u32 m0, s21, 0
    s_nop 0
    global_load_lds_dwordx4 v12, s[28:29]
    s_add_u32 m0, s20, 0
    s_nop 0
    global_load_lds_dwordx4 v10, s[24:25]
    v_mfma_f32_16x16x32_bf16 v[84:87], v[68:71], v[52:55], v[84:87]
    v_mfma_f32_16x16x32_bf16 v[92:95], v[68:71], v[56:59], v[92:95]
    v_mfma_f32_16x16x32_bf16 v[100:103], v[68:71], v[60:63], v[100:103]
    s_mov_b32 s32, 5
LA_lb1:
    s_waitcnt lgkmcnt(0)
    v_mfma_f32_16x16x32_bf16 v[72:75], v[40:43], v[24:27], v[72:75]
    ds_read_b128 v[48:51], v17 offset:16384
    ds_read_b128 v[52:55], v17 offset:18432
    v_mfma_f32_16x16x32_bf16 v[80:83], v[40:43], v[28:31], v[80:83]
    ds_read_b128 v[56:59], v17 offset:20480
    ds_read_b128 v[60:63], v17 offset:22528
    v_mfma_f32_16x16x32_bf16 v[88:91], v[40:43], v[32:35], v[88:91]
    ds_read_b64_tr_b16 v[64:65], v18 offset:24576
    ds_read_b64_tr_b16 v[66:67], v18 offset:25600
    v_mfma_f32_16x16x32_bf16 v[96:99], v[40:43], v[36:39], v[96:99]
    ds_read_b64_tr_b16 v[68:69], v19 offset:24576
    ds_read_b64_tr_b16 v[70:71], v19 offset:25600
    v_mfma_f32_16x16x32_bf16 v[76:79], v[44:47], v[24:27], v[76:79]
    s_add_u32 m0, s21, 1024
    s_nop 0
    global_load_lds_dwordx4 v13, s[28:29]
    s_add_u32 s28, s28, 131072
    s_addc_u32 s29, s29, 0
    s_add_u32 m0, s20, 1024
    s_nop 0
    global_load_lds_dwordx4 v11, s[24:25]
    s_add_u32 s24, s24, 128
    s_addc_u32 s25, s25, 0
    v_mfma_f32_16x16x32_bf16 v[84:87], v[44:47], v[28:31], v[84:87]
    v_mfma_f32_16x16x32_bf16 v[92:95], v[44:47], v[32:35], v[92:95]
    v_mfma_f32_16x16x32_bf16 v[100:103], v[44:47], v[36:39], v[100:103]
    s_waitcnt vmcnt(4) lgkmcnt(0)
    s_barrier
    v_mfma_f32_16x16x32_bf16 v[72:75], v[64:67], v[48:51], v[72:75]
    ds_read_b128 v[24:27], v16 offset:32768
    ds_read_b128 v[28:31], v16 offset:34816
    v_mfma_f32_16x16x32_bf16 v[80:83], v[64:67], v[52:55], v[80:83]
    ds_read_b128 v[32:35], v16 offset:36864
    ds_read_b128 v[36:39], v16 offset:38912
    v_mfma_f32_16x16x32_bf16 v[88:91], v[64:67], v[56:59], v[88:91]
    ds_read_b64_tr_b16 v[40:41], v18 offset:32768
    ds_read_b64_tr_b16 v[42:43], v18 offset:33792
    v_mfma_f32_16x16x32_bf16 v[96:99], v[64:67], v[60:63], v[96:99]
    ds_read_b64_tr_b16 v[44:45], v19 offset:32768
    ds_read_b64_tr_b16 v[46:47], v19 offset:33792
    v_mfma_f32_16x16x32_bf16 v[76:79], v[68:71], v[48:51], v[76:79]
    s_add_u32 m0, s21, 16384
    s_nop 0
    global_load_lds_dwordx4 v12, s[28:29]
    s_add_u32 m0, s20, 16384
    s_nop 0
    global_load_lds_dwordx4 v10, s[24:25]
    v_mfma_f32_16x16x32_bf16 v[84:87], v[68:71], v[52:55], v[84:87]
    v_mfma_f32_16x16x32_bf16 v[92:95], v[68:71], v[56:59], v[92:95]
    v_mfma_f32_16x16x32_bf16 v[100:103], v[68:71], v[60:63], v[100:103]
    s_waitcnt lgkmcnt(0)
    v_mfma_f32_16x16x32_bf16 v[72:75], v[40:43], v[24:27], v[72:75]
    ds_read_b128 v[48:51], v17 offset:32768
    ds_read_b128 v[52:55], v17 offset:34816
    v_mfma_f32_16x16x32_bf16 v[80:83], v[40:43], v[28:31], v[80:83]
    ds_read_b128 v[56:59], v17 offset:36864
    ds_read_b128 v[60:63], v17 offset:38912
    v_mfma_f32_16x16x32_bf16 v[88:91], v[40:43], v[32:35], v[88:91]
    ds_read_b64_tr_b16 v[64:65], v18 offset:40960
    ds_read_b64_tr_b16 v[66:67], v18 offset:41984
    v_mfma_f32_16x16x32_bf16 v[96:99], v[40:43], v[36:39], v[96:99]
    ds_read_b64_tr_b16 v[68:69], v19 offset:40960
    ds_read_b64_tr_b16 v[70:71], v19 offset:41984
    v_mfma_f32_16x16x32_bf16 v[76:79], v[44:47], v[24:27], v[76:79]
    s_add_u32 m0, s21, 17408
    s_nop 0
    global_load_lds_dwordx4 v13, s[28:29]
    s_add_u32 s28, s28, 131072
    s_addc_u32 s29, s29, 0
    s_add_u32 m0, s20, 17408
    s_nop 0
    global_load_lds_dwordx4 v11, s[24:25]
    s_add_u32 s24, s24, 128
    s_addc_u32 s25, s25, 0
    v_mfma_f32_16x16x32_bf16 v[84:87], v[44:47], v[28:31], v[84:87]
    v_mfma_f32_16x16x32_bf16 v[92:95], v[44:47], v[32:35], v[92:95]
    v_mfma_f32_16x16x32_bf16 v[100:103], v[44:47], v[36:39], v[100:103]
    s_waitcnt vmcnt(4) lgkmcnt(0)
    s_barrier
    v_mfma_f32_16x16x32_bf16 v[72:75], v[64:67], v[48:51], v[72:75]
    ds_read_b128 v[24:27], v16 offset:0
    ds_read_b128 v[28:31], v16 offset:2048
    v_mfma_f32_16x16x32_bf16 v[80:83], v[64:67], v[52:55], v[80:83]
    ds_read_b128 v[32:35], v16 offset:4096
    ds_read_b128 v[36:39], v16 offset:6144
    v_mfma_f32_16x16x32_bf16 v[88:91], v[64:67], v[56:59], v[88:91]
    ds_read_b64_tr_b16 v[40:41], v18 offset:0
    ds_read_b64_tr_b16 v[42:43], v18 offset:1024
    v_mfma_f32_16x16x32_bf16 v[96:99], v[64:67], v[60:63], v[96:99]
    ds_read_b64_tr_b16 v[44:45], v19 offset:0
    ds_read_b64_tr_b16 v[46:47], v19 offset:1024
    v_mfma_f32_16x16x32_bf16 v[76:79], v[68:71], v[48:51], v[76:79]
    s_add_u32 m0, s21, 32768
    s_nop 0
    global_load_lds_dwordx4 v12, s[28:29]
    s_add_u32 m0, s20, 32768
    s_nop 0
    global_load_lds_dwordx4 v10, s[24:25]
    v_mfma_f32_16x16x32_bf16 v[84:87], v[68:71], v[52:55], v[84:87]
    v_mfma_f32_16x16x32_bf16 v[92:95], v[68:71], v[56:59], v[92:95]
    v_mfma_f32_16x16x32_bf16 v[100:103], v[68:71], v[60:63], v[100:103]
    s_waitcnt lgkmcnt(0)
    v_mfma_f32_16x16x32_bf16 v[72:75], v[40:43], v[24:27], v[72:75]
    ds_read_b128 v[48:51], v17 offset:0
    ds_read_b128 v[52:55], v17 offset:2048
    v_mfma_f32_16x16x32_bf16 v[80:83], v[40:43], v[28:31], v[80:83]
    ds_read_b128 v[56:59], v17 offset:4096
    ds_read_b128 v[60:63], v17 offset:6144
    v_mfma_f32_16x16x32_bf16 v[88:91], v[40:43], v[32:35], v[88:91]
    ds_read_b64_tr_b16 v[64:65], v18 offset:8192
    ds_read_b64_tr_b16 v[66:67], v18 offset:9216
    v_mfma_f32_16x16x32_bf16 v[96:99], v[40:43], v[36:39], v[96:99]
    ds_read_b64_tr_b16 v[68:69], v19 offset:8192
    ds_read_b64_tr_b16 v[70:71], v19 offset:9216
    v_mfma_f32_16x16x32_bf16 v[76:79], v[44:47], v[24:27], v[76:79]
    s_add_u32 m0, s21, 33792
    s_nop 0
    global_load_lds_dwordx4 v13, s[28:29]
    s_add_u32 s28, s28, 131072
    s_addc_u32 s29, s29, 0
    s_add_u32 m0, s20, 33792
    s_nop 0
    global_load_lds_dwordx4 v11, s[24:25]
    s_add_u32 s24, s24, 128
    s_addc_u32 s25, s25, 0
    v_mfma_f32_16x16x32_bf16 v[84:87], v[44:47], v[28:31], v[84:87]
    v_mfma_f32_16x16x32_bf16 v[92:95], v[44:47], v[32:35], v[92:95]
    v_mfma_f32_16x16x32_bf16 v[100:103], v[44:47], v[36:39], v[100:103]
    s_waitcnt vmcnt(4) lgkmcnt(0)
    s_barrier
    v_mfma_f32_16x16x32_bf16 v[72:75], v[64:67], v[48:51], v[72:75]
    ds_read_b128 v[24:27], v16 offset:16384
    ds_read_b128 v[28:31], v16 offset:18432
    v_mfma_f32_16x16x32_bf16 v[80:83], v[64:67], v[52:55], v[80:83]
    ds_read_b128 v[32:35], v16 offset:20480
    ds_read_b128 v[36:39], v16 offset:22528
    v_mfma_f32_16x16x32_bf16 v[88:91], v[64:67], v[56:59], v[88:91]
    ds_read_b64_tr_b16 v[40:41], v18 offset:16384
    ds_read_b64_tr_b16 v[42:43], v18 offset:17408
    v_mfma_f32_16x16x32_bf16 v[96:99], v[64:67], v[60:63], v[96:99]
    ds_read_b64_tr_b16 v[44:45], v19 offset:16384
    ds_read_b64_tr_b16 v[46:47], v19 offset:17408
    v_mfma_f32_16x16x32_bf16 v[76:79], v[68:71], v[48:51], v[76:79]
    s_add_u32 m0, s21, 0
    s_nop 0
    global_load_lds_dwordx4 v12, s[28:29]
    s_add_u32 m0, s20, 0
    s_nop 0
    global_load_lds_dwordx4 v10, s[24:25]
    v_mfma_f32_16x16x32_bf16 v[84:87], v[68:71], v[52:55], v[84:87]
    v_mfma_f32_16x16x32_bf16 v[92:95], v[68:71], v[56:59], v[92:95]
    v_mfma_f32_16x16x32_bf16 v[100:103], v[68:71], v[60:63], v[100:103]
    s_sub_u32 s32, s32, 1
    s_cmp_lg_u32 s32, 0
    s_cbranch_scc1 LA_lb1
    s_waitcnt lgkmcnt(0)
    v_mfma_f32_16x16x32_bf16 v[72:75], v[40:43], v[24:27], v[72:75]
    ds_read_b128 v[48:51], v17 offset:16384
    ds_read_b128 v[52:55], v17 offset:18432
    v_mfma_f32_16x16x32_bf16 v[80:83], v[40:43], v[28:31], v[80:83]
    ds_read_b128 v[56:59], v17 offset:20480
    ds_read_b128 v[60:63], v17 offset:22528
    v_mfma_f32_16x16x32_bf16 v[88:91], v[40:43], v[32:35], v[88:91]
    ds_read_b64_tr_b16 v[64:65], v18 offset:24576
    ds_read_b64_tr_b16 v[66:67], v18 offset:25600
    v_mfma_f32_16x16x32_bf16 v[96:99], v[40:43], v[36:39], v[96:99]
    ds_read_b64_tr_b16 v[68:69], v19 offset:24576
    ds_read_b64_tr_b16 v[70:71], v19 offset:25600
    v_mfma_f32_16x16x32_bf16 v[76:79], v[44:47], v[24:27], v[76:79]
    s_add_u32 m0, s21, 1024
    s_nop 0
    global_load_lds_dwordx4 v13, s[28:29]
    s_add_u32 s28, s28, 131072
    s_addc_u32 s29, s29, 0
    s_add_u32 m0, s20, 1024
    s_nop 0
    global_load_lds_dwordx4 v11, s[24:25]
    s_add_u32 s24, s24, 128
    s_addc_u32 s25, s25, 0
    v_mfma_f32_16x16x32_bf16 v[84:87], v[44:47], v[28:31], v[84:87]
    v_mfma_f32_16x16x32_bf16 v[92:95], v[44:47], v[32:35], v[92:95]
    v_mfma_f32_16x16x32_bf16 v[100:103], v[44:47], v[36:39], v[100:103]
    s_waitcnt vmcnt(4) lgkmcnt(0)
    s_barrier
    v_mfma_f32_16x16x32_bf16 v[72:75], v[64:67], v[48:51], v[72:75]
    ds_read_b128 v[24:27], v16 offset:32768
    ds_read_b128 v[28:31], v16 offset:34816
    v_mfma_f32_16x16x32_bf16 v[80:83], v[64:67], v[52:55], v[80:83]
    ds_read_b128 v[32:35], v16 offset:36864
    ds_read_b128 v[36:39], v16 offset:38912
    v_mfma_f32_16x16x32_bf16 v[88:91], v[64:67], v[56:59], v[88:91]
    ds_read_b64_tr_b16 v[40:41], v18 offset:32768
    ds_read_b64_tr_b16 v[42:43], v18 offset:33792
    v_mfma_f32_16x16x32_bf16 v[96:99], v[64:67], v[60:63], v[96:99]
    ds_read_b64_tr_b16 v[44:45], v19 offset:32768
    ds_read_b64_tr_b16 v[46:47], v19 offset:33792
    v_mfma_f32_16x16x32_bf16 v[76:79], v[68:71], v[48:51], v[76:79]
    s_add_u32 m0, s21, 16384
    s_nop 0
    global_load_lds_dwordx4 v12, s[28:29]
    s_add_u32 m0, s20, 16384
    s_nop 0
    global_load_lds_dwordx4 v10, s[24:25]
    v_mfma_f32_16x16x32_bf16 v[84:87], v[68:71], v[52:55], v[84:87]
    v_mfma_f32_16x16x32_bf16 v[92:95], v[68:71], v[56:59], v[92:95]
    v_mfma_f32_16x16x32_bf16 v[100:103], v[68:71], v[60:63], v[100:103]
    s_waitcnt lgkmcnt(0)
    v_mfma_f32_16x16x32_bf16 v[72:75], v[40:43], v[24:27], v[72:75]
    ds_read_b128 v[48:51], v17 offset:32768
    ds_read_b128 v[52:55], v17 offset:34816
    v_mfma_f32_16x16x32_bf16 v[80:83], v[40:43], v[28:31], v[80:83]
    ds_read_b128 v[56:59], v17 offset:36864
    ds_read_b128 v[60:63], v17 offset:38912
    v_mfma_f32_16x16x32_bf16 v[88:91], v[40:43], v[32:35], v[88:91]
    ds_read_b64_tr_b16 v[64:65], v18 offset:40960
    ds_read_b64_tr_b16 v[66:67], v18 offset:41984
    v_mfma_f32_16x16x32_bf16 v[96:99], v[40:43], v[36:39], v[96:99]
    ds_read_b64_tr_b16 v[68:69], v19 offset:40960
    ds_read_b64_tr_b16 v[70:71], v19 offset:41984
    v_mfma_f32_16x16x32_bf16 v[76:79], v[44:47], v[24:27], v[76:79]
    s_add_u32 m0, s21, 17408
    s_nop 0
    global_load_lds_dwordx4 v13, s[28:29]
    s_add_u32 s28, s28, 131072
    s_addc_u32 s29, s29, 0
    s_add_u32 m0, s20, 17408
    s_nop 0
    global_load_lds_dwordx4 v11, s[24:25]
    s_add_u32 s24, s24, 128
    s_addc_u32 s25, s25, 0
    v_mfma_f32_16x16x32_bf16 v[84:87], v[44:47], v[28:31], v[84:87]
    v_mfma_f32_16x16x32_bf16 v[92:95], v[44:47], v[32:35], v[92:95]
    v_mfma_f32_16x16x32_bf16 v[100:103], v[44:47], v[36:39], v[100:103]
    s_waitcnt vmcnt(4) lgkmcnt(0)
    s_barrier
    s_cmp_lg_u32 s14, 0
    s_cbranch_scc1 LA_s1
    s_lshl_b32 s33, s60, 8
    s_add_u32 s33, s33, 46137472
    v_mov_b32 v7, s33
    v_mov_b32 v8, 1
    v_cmp_eq_u32 vcc, 0, v0
    s_and_saveexec_b64 s[38:39], vcc
    global_atomic_add v7, v8, s[12:13] sc1
    s_mov_b64 exec, s[38:39]
LA_s1:
    v_mfma_f32_16x16x32_bf16 v[72:75], v[64:67], v[48:51], v[72:75]
    ds_read_b128 v[24:27], v16 offset:0
    ds_read_b128 v[28:31], v16 offset:2048
    v_mfma_f32_16x16x32_bf16 v[80:83], v[64:67], v[52:55], v[80:83]
    ds_read_b128 v[32:35], v16 offset:4096
    ds_read_b128 v[36:39], v16 offset:6144
    v_mfma_f32_16x16x32_bf16 v[88:91], v[64:67], v[56:59], v[88:91]
    ds_read_b64_tr_b16 v[40:41], v18 offset:0
    ds_read_b64_tr_b16 v[42:43], v18 offset:1024
    v_mfma_f32_16x16x32_bf16 v[96:99], v[64:67], v[60:63], v[96:99]
    ds_read_b64_tr_b16 v[44:45], v19 offset:0
    ds_read_b64_tr_b16 v[46:47], v19 offset:1024
    v_mfma_f32_16x16x32_bf16 v[76:79], v[68:71], v[48:51], v[76:79]
    s_add_u32 m0, s21, 32768
    s_nop 0
    global_load_lds_dwordx4 v12, s[28:29]
    s_add_u32 m0, s20, 32768
    s_nop 0
    global_load_lds_dwordx4 v10, s[24:25]
    v_mfma_f32_16x16x32_bf16 v[84:87], v[68:71], v[52:55], v[84:87]
    s_add_u32 m0, s21, 33792
    s_nop 0
    global_load_lds_dwordx4 v13, s[28:29]
    s_add_u32 s28, s28, 131072
    s_addc_u32 s29, s29, 0
    s_add_u32 m0, s20, 33792
    s_nop 0
    global_load_lds_dwordx4 v11, s[24:25]
    s_add_u32 s24, s24, 128
    s_addc_u32 s25, s25, 0
    v_mfma_f32_16x16x32_bf16 v[92:95], v[68:71], v[56:59], v[92:95]
    v_mfma_f32_16x16x32_bf16 v[100:103], v[68:71], v[60:63], v[100:103]
    s_waitcnt lgkmcnt(0)
    v_mfma_f32_16x16x32_bf16 v[72:75], v[40:43], v[24:27], v[72:75]
    ds_read_b128 v[48:51], v17 offset:0
    ds_read_b128 v[52:55], v17 offset:2048
    v_mfma_f32_16x16x32_bf16 v[80:83], v[40:43], v[28:31], v[80:83]
    ds_read_b128 v[56:59], v17 offset:4096
    ds_read_b128 v[60:63], v17 offset:6144
    v_mfma_f32_16x16x32_bf16 v[88:91], v[40:43], v[32:35], v[88:91]
    ds_read_b64_tr_b16 v[64:65], v18 offset:8192
    ds_read_b64_tr_b16 v[66:67], v18 offset:9216
    v_mfma_f32_16x16x32_bf16 v[96:99], v[40:43], v[36:39], v[96:99]
    ds_read_b64_tr_b16 v[68:69], v19 offset:8192
    ds_read_b64_tr_b16 v[70:71], v19 offset:9216
    v_mfma_f32_16x16x32_bf16 v[76:79], v[44:47], v[24:27], v[76:79]
    s_add_u32 m0, s21, 65536
    s_nop 0
    global_load_lds_dwordx4 v12, s[28:29]
    s_add_u32 m0, s20, 98304
    s_nop 0
    global_load_lds_dwordx4 v10, s[24:25]
    v_mfma_f32_16x16x32_bf16 v[84:87], v[44:47], v[28:31], v[84:87]
    s_add_u32 m0, s21, 66560
    s_nop 0
    global_load_lds_dwordx4 v13, s[28:29]
    s_add_u32 s28, s28, 131072
    s_addc_u32 s29, s29, 0
    s_add_u32 m0, s20, 99328
    s_nop 0
    global_load_lds_dwordx4 v11, s[24:25]
    s_add_u32 s24, s24, 128
    s_addc_u32 s25, s25, 0
    v_mfma_f32_16x16x32_bf16 v[92:95], v[44:47], v[32:35], v[92:95]
    v_mfma_f32_16x16x32_bf16 v[100:103], v[44:47], v[36:39], v[100:103]
    s_waitcnt vmcnt(8) lgkmcnt(0)
    s_barrier
    v_mfma_f32_16x16x32_bf16 v[72:75], v[64:67], v[48:51], v[72:75]
    ds_read_b128 v[24:27], v16 offset:16384
    ds_read_b128 v[28:31], v16 offset:18432
    v_mfma_f32_16x16x32_bf16 v[80:83], v[64:67], v[52:55], v[80:83]
    ds_read_b128 v[32:35], v16 offset:20480
    ds_read_b128 v[36:39], v16 offset:22528
    v_mfma_f32_16x16x32_bf16 v[88:91], v[64:67], v[56:59], v[88:91]
    ds_read_b64_tr_b16 v[40:41], v18 offset:16384
    ds_read_b64_tr_b16 v[42:43], v18 offset:17408
    v_mfma_f32_16x16x32_bf16 v[96:99], v[64:67], v[60:63], v[96:99]
    ds_read_b64_tr_b16 v[44:45], v19 offset:16384
    ds_read_b64_tr_b16 v[46:47], v19 offset:17408
    v_mfma_f32_16x16x32_bf16 v[76:79], v[68:71], v[48:51], v[76:79]
    v_mfma_f32_16x16x32_bf16 v[84:87], v[68:71], v[52:55], v[84:87]
    v_mfma_f32_16x16x32_bf16 v[92:95], v[68:71], v[56:59], v[92:95]
    v_mfma_f32_16x16x32_bf16 v[100:103], v[68:71], v[60:63], v[100:103]
    s_waitcnt lgkmcnt(0)
    v_mfma_f32_16x16x32_bf16 v[72:75], v[40:43], v[24:27], v[72:75]
    ds_read_b128 v[48:51], v17 offset:16384
    ds_read_b128 v[52:55], v17 offset:18432
    v_mfma_f32_16x16x32_bf16 v[80:83], v[40:43], v[28:31], v[80:83]
    ds_read_b128 v[56:59], v17 offset:20480
    ds_read_b128 v[60:63], v17 offset:22528
    v_mfma_f32_16x16x32_bf16 v[88:91], v[40:43], v[32:35], v[88:91]
    ds_read_b64_tr_b16 v[64:65], v18 offset:24576
    ds_read_b64_tr_b16 v[66:67], v18 offset:25600
    v_mfma_f32_16x16x32_bf16 v[96:99], v[40:43], v[36:39], v[96:99]
    ds_read_b64_tr_b16 v[68:69], v19 offset:24576
    ds_read_b64_tr_b16 v[70:71], v19 offset:25600
    v_mfma_f32_16x16x32_bf16 v[76:79], v[44:47], v[24:27], v[76:79]
    v_mfma_f32_16x16x32_bf16 v[84:87], v[44:47], v[28:31], v[84:87]
    v_mfma_f32_16x16x32_bf16 v[92:95], v[44:47], v[32:35], v[92:95]
    v_mfma_f32_16x16x32_bf16 v[100:103], v[44:47], v[36:39], v[100:103]
    s_cmp_lg_u32 s14, 0
    s_cbranch_scc1 LA_w1
    s_lshr_b32 s33, s16, 1
    s_lshl_b32 s33, s33, 8
    s_add_u32 s33, s33, 46137472
    v_mov_b32 v7, s33
LA_w1p:
    global_load_dword v8, v7, s[12:13] sc1
    s_waitcnt vmcnt(0)
    v_cmp_gt_u32 vcc, 32, v8
    s_cbranch_vccz LA_w1
    s_sleep 1
    s_branch LA_w1p
LA_w1:
    s_waitcnt vmcnt(4) lgkmcnt(0)
    s_barrier
    v_mfma_f32_16x16x32_bf16 v[72:75], v[64:67], v[48:51], v[72:75]
    ds_read_b128 v[24:27], v16 offset:32768
    ds_read_b128 v[28:31], v16 offset:34816
    v_mfma_f32_16x16x32_bf16 v[80:83], v[64:67], v[52:55], v[80:83]
    ds_read_b128 v[32:35], v16 offset:36864
    ds_read_b128 v[36:39], v16 offset:38912
    v_mfma_f32_16x16x32_bf16 v[88:91], v[64:67], v[56:59], v[88:91]
    ds_read_b64_tr_b16 v[40:41], v18 offset:32768
    ds_read_b64_tr_b16 v[42:43], v18 offset:33792
    v_mfma_f32_16x16x32_bf16 v[96:99], v[64:67], v[60:63], v[96:99]
    ds_read_b64_tr_b16 v[44:45], v19 offset:32768
    ds_read_b64_tr_b16 v[46:47], v19 offset:33792
    v_mfma_f32_16x16x32_bf16 v[76:79], v[68:71], v[48:51], v[76:79]
    s_add_u32 m0, s21, 98304
    s_nop 0
    global_load_lds_dwordx4 v12, s[26:27]
    s_add_u32 m0, s21, 99328
    s_nop 0
    global_load_lds_dwordx4 v13, s[26:27]
    s_add_u32 s26, s26, 131072
    s_addc_u32 s27, s27, 0
    v_mfma_f32_16x16x32_bf16 v[84:87], v[68:71], v[52:55], v[84:87]
    s_add_u32 m0, s31, 131072
    s_nop 0
    global_load_lds_dwordx4 v14, s[22:23] sc1
    s_add_u32 s22, s22, 128
    s_addc_u32 s23, s23, 0
    s_add_u32 m0, s21, 0
    s_nop 0
    global_load_lds_dwordx4 v12, s[28:29]
    v_mfma_f32_16x16x32_bf16 v[92:95], v[68:71], v[56:59], v[92:95]
    s_add_u32 m0, s20, 0
    s_nop 0
    global_load_lds_dwordx4 v10, s[24:25]
    v_mfma_f32_16x16x32_bf16 v[100:103], v[68:71], v[60:63], v[100:103]
    s_waitcnt lgkmcnt(0)
    v_mfma_f32_16x16x32_bf16 v[72:75], v[40:43], v[24:27], v[72:75]
    ds_read_b128 v[48:51], v17 offset:32768
    ds_read_b128 v[52:55], v17 offset:34816
    v_mfma_f32_16x16x32_bf16 v[80:83], v[40:43], v[28:31], v[80:83]
    ds_read_b128 v[56:59], v17 offset:36864
    ds_read_b128 v[60:63], v17 offset:38912
    v_mfma_f32_16x16x32_bf16 v[88:91], v[40:43], v[32:35], v[88:91]
    ds_read_b64_tr_b16 v[64:65], v18 offset:40960
    ds_read_b64_tr_b16 v[66:67], v18 offset:41984
    v_mfma_f32_16x16x32_bf16 v[96:99], v[40:43], v[36:39], v[96:99]
    ds_read_b64_tr_b16 v[68:69], v19 offset:40960
    ds_read_b64_tr_b16 v[70:71], v19 offset:41984
    v_mfma_f32_16x16x32_bf16 v[76:79], v[44:47], v[24:27], v[76:79]
    s_add_u32 m0, s21, 1024
    s_nop 0
    global_load_lds_dwordx4 v13, s[28:29]
    s_add_u32 s28, s28, 131072
    s_addc_u32 s29, s29, 0
    s_add_u32 m0, s20, 1024
    s_nop 0
    global_load_lds_dwordx4 v11, s[24:25]
    s_add_u32 s24, s24, 128
    s_addc_u32 s25, s25, 0
    v_mfma_f32_16x16x32_bf16 v[84:87], v[44:47], v[28:31], v[84:87]
    s_add_u32 m0, s21, 16384
    s_nop 0
    global_load_lds_dwordx4 v12, s[26:27]
    s_add_u32 m0, s21, 17408
    s_nop 0
    global_load_lds_dwordx4 v13, s[26:27]
    s_add_u32 s26, s26, 131072
    s_addc_u32 s27, s27, 0
    v_mfma_f32_16x16x32_bf16 v[92:95], v[44:47], v[32:35], v[92:95]
    s_add_u32 m0, s31, 16384
    s_nop 0
    global_load_lds_dwordx4 v14, s[22:23] sc1
    s_add_u32 s22, s22, 128
    s_addc_u32 s23, s23, 0
    v_mfma_f32_16x16x32_bf16 v[100:103], v[44:47], v[36:39], v[100:103]
    s_waitcnt vmcnt(10) lgkmcnt(0)
    s_barrier
    v_mfma_f32_16x16x32_bf16 v[72:75], v[64:67], v[48:51], v[72:75]
    ds_read_b128 v[24:27], v120 offset:0
    ds_read_b128 v[28:31], v120 offset:2048
    v_mfma_f32_16x16x32_bf16 v[80:83], v[64:67], v[52:55], v[80:83]
    ds_read_b128 v[32:35], v120 offset:4096
    ds_read_b128 v[36:39], v120 offset:6144
    v_mfma_f32_16x16x32_bf16 v[88:91], v[64:67], v[56:59], v[88:91]
    ds_read_b64_tr_b16 v[40:41], v122 offset:0
    ds_read_b64_tr_b16 v[42:43], v122 offset:1024
    v_mfma_f32_16x16x32_bf16 v[96:99], v[64:67], v[60:63], v[96:99]
    ds_read_b64_tr_b16 v[44:45], v123 offset:0
    ds_read_b64_tr_b16 v[46:47], v123 offset:1024
    v_mfma_f32_16x16x32_bf16 v[76:79], v[68:71], v[48:51], v[76:79]
    s_add_u32 m0, s21, 32768
    s_nop 0
    global_load_lds_dwordx4 v12, s[28:29]
    s_add_u32 m0, s20, 32768
    s_nop 0
    global_load_lds_dwordx4 v10, s[24:25]
    v_mfma_f32_16x16x32_bf16 v[84:87], v[68:71], v[52:55], v[84:87]
    v_mfma_f32_16x16x32_bf16 v[92:95], v[68:71], v[56:59], v[92:95]
    v_mfma_f32_16x16x32_bf16 v[100:103], v[68:71], v[60:63], v[100:103]
    s_waitcnt lgkmcnt(0)
    v_mfma_f32_16x16x32_bf16 v[72:75], v[40:43], v[24:27], v[72:75]
    ds_read_b128 v[48:51], v121 offset:0
    ds_read_b128 v[52:55], v121 offset:2048
    v_mfma_f32_16x16x32_bf16 v[80:83], v[40:43], v[28:31], v[80:83]
    ds_read_b128 v[56:59], v121 offset:4096
    ds_read_b128 v[60:63], v121 offset:6144
    v_mfma_f32_16x16x32_bf16 v[88:91], v[40:43], v[32:35], v[88:91]
    ds_read_b64_tr_b16 v[64:65], v122 offset:8192
    ds_read_b64_tr_b16 v[66:67], v122 offset:9216
    v_mfma_f32_16x16x32_bf16 v[96:99], v[40:43], v[36:39], v[96:99]
    ds_read_b64_tr_b16 v[68:69], v123 offset:8192
    ds_read_b64_tr_b16 v[70:71], v123 offset:9216
    v_mfma_f32_16x16x32_bf16 v[76:79], v[44:47], v[24:27], v[76:79]
    s_add_u32 m0, s21, 33792
    s_nop 0
    global_load_lds_dwordx4 v13, s[28:29]
    s_add_u32 s28, s28, 131072
    s_addc_u32 s29, s29, 0
    s_add_u32 m0, s20, 33792
    s_nop 0
    global_load_lds_dwordx4 v11, s[24:25]
    s_add_u32 s24, s24, 128
    s_addc_u32 s25, s25, 0
    v_mfma_f32_16x16x32_bf16 v[84:87], v[44:47], v[28:31], v[84:87]
    v_mfma_f32_16x16x32_bf16 v[92:95], v[44:47], v[32:35], v[92:95]
    v_mfma_f32_16x16x32_bf16 v[100:103], v[44:47], v[36:39], v[100:103]
    s_waitcnt vmcnt(11) lgkmcnt(0)
    s_barrier
    v_mfma_f32_16x16x32_bf16 v[72:75], v[64:67], v[48:51], v[72:75]
    ds_read_b128 v[32:35], v120 offset:36864
    ds_read_b128 v[36:39], v120 offset:38912
    v_mfma_f32_16x16x32_bf16 v[80:83], v[64:67], v[52:55], v[80:83]
    ds_read_b64_tr_b16 v[40:41], v122 offset:32768
    ds_read_b64_tr_b16 v[42:43], v122 offset:33792
    v_mfma_f32_16x16x32_bf16 v[88:91], v[64:67], v[56:59], v[88:91]
    ds_read_b64_tr_b16 v[44:45], v123 offset:32768
    ds_read_b64_tr_b16 v[46:47], v123 offset:33792
    v_mfma_f32_16x16x32_bf16 v[96:99], v[64:67], v[60:63], v[96:99]
    s_add_u32 m0, s21, 65536
    s_nop 0
    global_load_lds_dwordx4 v12, s[26:27]
    s_add_u32 m0, s21, 66560
    s_nop 0
    global_load_lds_dwordx4 v13, s[26:27]
    s_add_u32 s26, s26, 131072
    s_addc_u32 s27, s27, 0
    v_mfma_f32_16x16x32_bf16 v[76:79], v[68:71], v[48:51], v[76:79]
    v_mfma_f32_16x16x32_bf16 v[84:87], v[68:71], v[52:55], v[84:87]
    v_mfma_f32_16x16x32_bf16 v[92:95], v[68:71], v[56:59], v[92:95]
    v_mfma_f32_16x16x32_bf16 v[100:103], v[68:71], v[60:63], v[100:103]
    s_waitcnt lgkmcnt(0)
    v_mfma_f32_16x16x32_bf16 v[104:107], v[40:43], v[32:35], 0
    ds_read_b128 v[56:59], v121 offset:36864
    ds_read_b128 v[60:63], v121 offset:38912
    ds_read_b64_tr_b16 v[64:65], v122 offset:40960
    v_mfma_f32_16x16x32_bf16 v[112:115], v[40:43], v[36:39], 0
    ds_read_b64_tr_b16 v[66:67], v122 offset:41984
    ds_read_b64_tr_b16 v[68:69], v123 offset:40960
    ds_read_b64_tr_b16 v[70:71], v123 offset:41984
    v_mfma_f32_16x16x32_bf16 v[108:111], v[44:47], v[32:35], 0
    s_add_u32 m0, s31, 98304
    s_nop 0
    global_load_lds_dwordx4 v14, s[22:23] sc1
    s_add_u32 s22, s22, 128
    s_addc_u32 s23, s23, 0
    v_mfma_f32_16x16x32_bf16 v[116:119], v[44:47], v[36:39], 0
    s_waitcnt vmcnt(10) lgkmcnt(0)
    s_barrier
    v_mfma_f32_16x16x32_bf16 v[104:107], v[64:67], v[56:59], v[104:107]
    ds_read_b128 v[24:27], v16 offset:0
    ds_read_b128 v[28:31], v16 offset:2048
    ds_read_b128 v[32:35], v16 offset:4096
    v_mfma_f32_16x16x32_bf16 v[112:115], v[64:67], v[60:63], v[112:115]
    ds_read_b128 v[36:39], v16 offset:6144
    ds_read_b64_tr_b16 v[40:41], v18 offset:0
    ds_read_b64_tr_b16 v[42:43], v18 offset:1024
    v_mfma_f32_16x16x32_bf16 v[108:111], v[68:71], v[56:59], v[108:111]
    ds_read_b64_tr_b16 v[44:45], v19 offset:0
    ds_read_b64_tr_b16 v[46:47], v19 offset:1024
    s_add_u32 m0, s21, 98304
    s_nop 0
    global_load_lds_dwordx4 v12, s[28:29]
    v_mfma_f32_16x16x32_bf16 v[116:119], v[68:71], v[60:63], v[116:119]
    s_add_u32 m0, s20, 131072
    s_nop 0
    global_load_lds_dwordx4 v10, s[24:25]
    s_waitcnt lgkmcnt(0)
    v_mfma_f32_16x16x32_bf16 v[72:75], v[40:43], v[24:27], v[72:75]
    ds_read_b128 v[48:51], v17 offset:0
    ds_read_b128 v[52:55], v17 offset:2048
    v_mfma_f32_16x16x32_bf16 v[80:83], v[40:43], v[28:31], v[80:83]
    ds_read_b128 v[56:59], v17 offset:4096
    ds_read_b128 v[60:63], v17 offset:6144
    v_mfma_f32_16x16x32_bf16 v[88:91], v[40:43], v[32:35], v[88:91]
    ds_read_b64_tr_b16 v[64:65], v18 offset:8192
    ds_read_b64_tr_b16 v[66:67], v18 offset:9216
    v_mfma_f32_16x16x32_bf16 v[96:99], v[40:43], v[36:39], v[96:99]
    ds_read_b64_tr_b16 v[68:69], v19 offset:8192
    ds_read_b64_tr_b16 v[70:71], v19 offset:9216
    v_mfma_f32_16x16x32_bf16 v[76:79], v[44:47], v[24:27], v[76:79]
    s_add_u32 m0, s21, 99328
    s_nop 0
    global_load_lds_dwordx4 v13, s[28:29]
    s_add_u32 s28, s28, 131072
    s_addc_u32 s29, s29, 0
    s_add_u32 m0, s20, 132096
    s_nop 0
    global_load_lds_dwordx4 v11, s[24:25]
    s_add_u32 s24, s24, 128
    s_addc_u32 s25, s25, 0
    v_mfma_f32_16x16x32_bf16 v[84:87], v[44:47], v[28:31], v[84:87]
    v_mfma_f32_16x16x32_bf16 v[92:95], v[44:47], v[32:35], v[92:95]
    v_mfma_f32_16x16x32_bf16 v[100:103], v[44:47], v[36:39], v[100:103]
    s_waitcnt vmcnt(11) lgkmcnt(0)
    s_barrier
    v_mfma_f32_16x16x32_bf16 v[72:75], v[64:67], v[48:51], v[72:75]
    ds_read_b128 v[32:35], v16 offset:20480
    ds_read_b128 v[36:39], v16 offset:22528
    v_mfma_f32_16x16x32_bf16 v[80:83], v[64:67], v[52:55], v[80:83]
    ds_read_b64_tr_b16 v[40:41], v18 offset:16384
    ds_read_b64_tr_b16 v[42:43], v18 offset:17408
    v_mfma_f32_16x16x32_bf16 v[88:91], v[64:67], v[56:59], v[88:91]
    ds_read_b64_tr_b16 v[44:45], v19 offset:16384
    ds_read_b64_tr_b16 v[46:47], v19 offset:17408
    v_mfma_f32_16x16x32_bf16 v[96:99], v[64:67], v[60:63], v[96:99]
    s_add_u32 m0, s21, 0
    s_nop 0
    global_load_lds_dwordx4 v12, s[26:27]
    s_add_u32 m0, s21, 1024
    s_nop 0
    global_load_lds_dwordx4 v13, s[26:27]
    s_add_u32 s26, s26, 131072
    s_addc_u32 s27, s27, 0
    v_mfma_f32_16x16x32_bf16 v[76:79], v[68:71], v[48:51], v[76:79]
    v_mfma_f32_16x16x32_bf16 v[84:87], v[68:71], v[52:55], v[84:87]
    v_mfma_f32_16x16x32_bf16 v[92:95], v[68:71], v[56:59], v[92:95]
    v_mfma_f32_16x16x32_bf16 v[100:103], v[68:71], v[60:63], v[100:103]
    s_waitcnt lgkmcnt(0)
    v_mfma_f32_16x16x32_bf16 v[104:107], v[40:43], v[32:35], v[104:107]
    ds_read_b128 v[56:59], v17 offset:20480
    ds_read_b128 v[60:63], v17 offset:22528
    ds_read_b64_tr_b16 v[64:65], v18 offset:24576
    v_mfma_f32_16x16x32_bf16 v[112:115], v[40:43], v[36:39], v[112:115]
    ds_read_b64_tr_b16 v[66:67], v18 offset:25600
    ds_read_b64_tr_b16 v[68:69], v19 offset:24576
    ds_read_b64_tr_b16 v[70:71], v19 offset:25600
    v_mfma_f32_16x16x32_bf16 v[108:111], v[44:47], v[32:35], v[108:111]
    s_add_u32 m0, s31, 0
    s_nop 0
    global_load_lds_dwordx4 v14, s[22:23] sc1
    s_add_u32 s22, s22, 128
    s_addc_u32 s23, s23, 0
    v_mfma_f32_16x16x32_bf16 v[116:119], v[44:47], v[36:39], v[116:119]
    s_waitcnt vmcnt(10) lgkmcnt(0)
    s_barrier
    v_mfma_f32_16x16x32_bf16 v[104:107], v[64:67], v[56:59], v[104:107]
    ds_read_b128 v[24:27], v16 offset:32768
    ds_read_b128 v[28:31], v16 offset:34816
    ds_read_b128 v[32:35], v16 offset:36864
    v_mfma_f32_16x16x32_bf16 v[112:115], v[64:67], v[60:63], v[112:115]
    ds_read_b128 v[36:39], v16 offset:38912
    ds_read_b64_tr_b16 v[40:41], v18 offset:32768
    ds_read_b64_tr_b16 v[42:43], v18 offset:33792
    v_mfma_f32_16x16x32_bf16 v[108:111], v[68:71], v[56:59], v[108:111]
    ds_read_b64_tr_b16 v[44:45], v19 offset:32768
    ds_read_b64_tr_b16 v[46:47], v19 offset:33792
    s_add_u32 m0, s21, 16384
    s_nop 0
    global_load_lds_dwordx4 v12, s[28:29]
    v_mfma_f32_16x16x32_bf16 v[116:119], v[68:71], v[60:63], v[116:119]
    s_add_u32 m0, s20, 16384
    s_nop 0
    global_load_lds_dwordx4 v10, s[24:25]
    s_waitcnt lgkmcnt(0)
    v_mfma_f32_16x16x32_bf16 v[72:75], v[40:43], v[24:27], v[72:75]
    ds_read_b128 v[48:51], v17 offset:32768
    ds_read_b128 v[52:55], v17 offset:34816
    v_mfma_f32_16x16x32_bf16 v[80:83], v[40:43], v[28:31], v[80:83]
    ds_read_b128 v[56:59], v17 offset:36864
    ds_read_b128 v[60:63], v17 offset:38912
    v_mfma_f32_16x16x32_bf16 v[88:91], v[40:43], v[32:35], v[88:91]
    ds_read_b64_tr_b16 v[64:65], v18 offset:40960
    ds_read_b64_tr_b16 v[66:67], v18 offset:41984
    v_mfma_f32_16x16x32_bf16 v[96:99], v[40:43], v[36:39], v[96:99]
    ds_read_b64_tr_b16 v[68:69], v19 offset:40960
    ds_read_b64_tr_b16 v[70:71], v19 offset:41984
    v_mfma_f32_16x16x32_bf16 v[76:79], v[44:47], v[24:27], v[76:79]
    s_add_u32 m0, s21, 17408
    s_nop 0
    global_load_lds_dwordx4 v13, s[28:29]
    s_add_u32 s28, s28, 131072
    s_addc_u32 s29, s29, 0
    s_add_u32 m0, s20, 17408
    s_nop 0
    global_load_lds_dwordx4 v11, s[24:25]
    s_add_u32 s24, s24, 128
    s_addc_u32 s25, s25, 0
    v_mfma_f32_16x16x32_bf16 v[84:87], v[44:47], v[28:31], v[84:87]
    v_mfma_f32_16x16x32_bf16 v[92:95], v[44:47], v[32:35], v[92:95]
    v_mfma_f32_16x16x32_bf16 v[100:103], v[44:47], v[36:39], v[100:103]
    s_waitcnt vmcnt(11) lgkmcnt(0)
    s_barrier
    v_mfma_f32_16x16x32_bf16 v[72:75], v[64:67], v[48:51], v[72:75]
    ds_read_b128 v[32:35], v120 offset:4096
    ds_read_b128 v[36:39], v120 offset:6144
    v_mfma_f32_16x16x32_bf16 v[80:83], v[64:67], v[52:55], v[80:83]
    ds_read_b64_tr_b16 v[40:41], v122 offset:0
    ds_read_b64_tr_b16 v[42:43], v122 offset:1024
    v_mfma_f32_16x16x32_bf16 v[88:91], v[64:67], v[56:59], v[88:91]
    ds_read_b64_tr_b16 v[44:45], v123 offset:0
    ds_read_b64_tr_b16 v[46:47], v123 offset:1024
    v_mfma_f32_16x16x32_bf16 v[96:99], v[64:67], v[60:63], v[96:99]
    s_add_u32 m0, s21, 32768
    s_nop 0
    global_load_lds_dwordx4 v12, s[26:27]
    s_add_u32 m0, s21, 33792
    s_nop 0
    global_load_lds_dwordx4 v13, s[26:27]
    s_add_u32 s26, s26, 131072
    s_addc_u32 s27, s27, 0
    v_mfma_f32_16x16x32_bf16 v[76:79], v[68:71], v[48:51], v[76:79]
    v_mfma_f32_16x16x32_bf16 v[84:87], v[68:71], v[52:55], v[84:87]
    v_mfma_f32_16x16x32_bf16 v[92:95], v[68:71], v[56:59], v[92:95]
    v_mfma_f32_16x16x32_bf16 v[100:103], v[68:71], v[60:63], v[100:103]
    s_waitcnt lgkmcnt(0)
    v_mfma_f32_16x16x32_bf16 v[104:107], v[40:43], v[32:35], v[104:107]
    ds_read_b128 v[56:59], v121 offset:4096
    ds_read_b128 v[60:63], v121 offset:6144
    ds_read_b64_tr_b16 v[64:65], v122 offset:8192
    v_mfma_f32_16x16x32_bf16 v[112:115], v[40:43], v[36:39], v[112:115]
    ds_read_b64_tr_b16 v[66:67], v122 offset:9216
    ds_read_b64_tr_b16 v[68:69], v123 offset:8192
    ds_read_b64_tr_b16 v[70:71], v123 offset:9216
    v_mfma_f32_16x16x32_bf16 v[108:111], v[44:47], v[32:35], v[108:111]
    s_add_u32 m0, s31, 32768
    s_nop 0
    global_load_lds_dwordx4 v14, s[22:23] sc1
    s_add_u32 s22, s22, 128
    s_addc_u32 s23, s23, 0
    v_mfma_f32_16x16x32_bf16 v[116:119], v[44:47], v[36:39], v[116:119]
    s_waitcnt vmcnt(10) lgkmcnt(0)
    s_barrier
    v_mfma_f32_16x16x32_bf16 v[104:107], v[64:67], v[56:59], v[104:107]
    ds_read_b128 v[24:27], v120 offset:32768
    ds_read_b128 v[28:31], v120 offset:34816
    ds_read_b128 v[32:35], v120 offset:36864
    v_mfma_f32_16x16x32_bf16 v[112:115], v[64:67], v[60:63], v[112:115]
    ds_read_b128 v[36:39], v120 offset:38912
    ds_read_b64_tr_b16 v[40:41], v122 offset:32768
    ds_read_b64_tr_b16 v[42:43], v122 offset:33792
    v_mfma_f32_16x16x32_bf16 v[108:111], v[68:71], v[56:59], v[108:111]
    ds_read_b64_tr_b16 v[44:45], v123 offset:32768
    ds_read_b64_tr_b16 v[46:47], v123 offset:33792
    s_add_u32 m0, s21, 65536
    s_nop 0
    global_load_lds_dwordx4 v12, s[28:29]
    v_mfma_f32_16x16x32_bf16 v[116:119], v[68:71], v[60:63], v[116:119]
    s_add_u32 m0, s20, 98304
    s_nop 0
    global_load_lds_dwordx4 v10, s[24:25]
    s_waitcnt lgkmcnt(0)
    v_mfma_f32_16x16x32_bf16 v[72:75], v[40:43], v[24:27], v[72:75]
    ds_read_b128 v[48:51], v121 offset:32768
    ds_read_b128 v[52:55], v121 offset:34816
    v_mfma_f32_16x16x32_bf16 v[80:83], v[40:43], v[28:31], v[80:83]
    ds_read_b128 v[56:59], v121 offset:36864
    ds_read_b128 v[60:63], v121 offset:38912
    v_mfma_f32_16x16x32_bf16 v[88:91], v[40:43], v[32:35], v[88:91]
    ds_read_b64_tr_b16 v[64:65], v122 offset:40960
    ds_read_b64_tr_b16 v[66:67], v122 offset:41984
    v_mfma_f32_16x16x32_bf16 v[96:99], v[40:43], v[36:39], v[96:99]
    ds_read_b64_tr_b16 v[68:69], v123 offset:40960
    ds_read_b64_tr_b16 v[70:71], v123 offset:41984
    v_mfma_f32_16x16x32_bf16 v[76:79], v[44:47], v[24:27], v[76:79]
    s_add_u32 m0, s21, 66560
    s_nop 0
    global_load_lds_dwordx4 v13, s[28:29]
    s_add_u32 s28, s28, 131072
    s_addc_u32 s29, s29, 0
    s_add_u32 m0, s20, 99328
    s_nop 0
    global_load_lds_dwordx4 v11, s[24:25]
    s_add_u32 s24, s24, 128
    s_addc_u32 s25, s25, 0
    v_mfma_f32_16x16x32_bf16 v[84:87], v[44:47], v[28:31], v[84:87]
    v_mfma_f32_16x16x32_bf16 v[92:95], v[44:47], v[32:35], v[92:95]
    v_mfma_f32_16x16x32_bf16 v[100:103], v[44:47], v[36:39], v[100:103]
    s_waitcnt vmcnt(11) lgkmcnt(0)
    s_barrier
    v_mfma_f32_16x16x32_bf16 v[72:75], v[64:67], v[48:51], v[72:75]
    ds_read_b128 v[32:35], v16 offset:4096
    ds_read_b128 v[36:39], v16 offset:6144
    v_mfma_f32_16x16x32_bf16 v[80:83], v[64:67], v[52:55], v[80:83]
    ds_read_b64_tr_b16 v[40:41], v18 offset:0
    ds_read_b64_tr_b16 v[42:43], v18 offset:1024
    v_mfma_f32_16x16x32_bf16 v[88:91], v[64:67], v[56:59], v[88:91]
    ds_read_b64_tr_b16 v[44:45], v19 offset:0
    ds_read_b64_tr_b16 v[46:47], v19 offset:1024
    v_mfma_f32_16x16x32_bf16 v[96:99], v[64:67], v[60:63], v[96:99]
    s_add_u32 m0, s21, 98304
    s_nop 0
    global_load_lds_dwordx4 v12, s[26:27]
    s_add_u32 m0, s21, 99328
    s_nop 0
    global_load_lds_dwordx4 v13, s[26:27]
    s_add_u32 s26, s26, 131072
    s_addc_u32 s27, s27, 0
    v_mfma_f32_16x16x32_bf16 v[76:79], v[68:71], v[48:51], v[76:79]
    v_mfma_f32_16x16x32_bf16 v[84:87], v[68:71], v[52:55], v[84:87]
    v_mfma_f32_16x16x32_bf16 v[92:95], v[68:71], v[56:59], v[92:95]
    v_mfma_f32_16x16x32_bf16 v[100:103], v[68:71], v[60:63], v[100:103]
    s_waitcnt lgkmcnt(0)
    v_mfma_f32_16x16x32_bf16 v[104:107], v[40:43], v[32:35], v[104:107]
    ds_read_b128 v[56:59], v17 offset:4096
    ds_read_b128 v[60:63], v17 offset:6144
    ds_read_b64_tr_b16 v[64:65], v18 offset:8192
    v_mfma_f32_16x16x32_bf16 v[112:115], v[40:43], v[36:39], v[112:115]
    ds_read_b64_tr_b16 v[66:67], v18 offset:9216
    ds_read_b64_tr_b16 v[68:69], v19 offset:8192
    ds_read_b64_tr_b16 v[70:71], v19 offset:9216
    v_mfma_f32_16x16x32_bf16 v[108:111], v[44:47], v[32:35], v[108:111]
    s_add_u32 m0, s31, 131072
    s_nop 0
    global_load_lds_dwordx4 v14, s[22:23] sc1
    s_add_u32 s22, s22, 128
    s_addc_u32 s23, s23, 0
    v_mfma_f32_16x16x32_bf16 v[116:119], v[44:47], v[36:39], v[116:119]
    s_waitcnt vmcnt(10) lgkmcnt(0)
    s_barrier
    v_mfma_f32_16x16x32_bf16 v[104:107], v[64:67], v[56:59], v[104:107]
    ds_read_b128 v[24:27], v16 offset:16384
    ds_read_b128 v[28:31], v16 offset:18432
    ds_read_b128 v[32:35], v16 offset:20480
    v_mfma_f32_16x16x32_bf16 v[112:115], v[64:67], v[60:63], v[112:115]
    ds_read_b128 v[36:39], v16 offset:22528
    ds_read_b64_tr_b16 v[40:41], v18 offset:16384
    ds_read_b64_tr_b16 v[42:43], v18 offset:17408
    v_mfma_f32_16x16x32_bf16 v[108:111], v[68:71], v[56:59], v[108:111]
    ds_read_b64_tr_b16 v[44:45], v19 offset:16384
    ds_read_b64_tr_b16 v[46:47], v19 offset:17408
    s_add_u32 m0, s21, 0
    s_nop 0
    global_load_lds_dwordx4 v12, s[28:29]
    v_mfma_f32_16x16x32_bf16 v[116:119], v[68:71], v[60:63], v[116:119]
    s_add_u32 m0, s20, 0
    s_nop 0
    global_load_lds_dwordx4 v10, s[24:25]
    s_waitcnt lgkmcnt(0)
    v_mfma_f32_16x16x32_bf16 v[72:75], v[40:43], v[24:27], v[72:75]
    ds_read_b128 v[48:51], v17 offset:16384
    ds_read_b128 v[52:55], v17 offset:18432
    v_mfma_f32_16x16x32_bf16 v[80:83], v[40:43], v[28:31], v[80:83]
    ds_read_b128 v[56:59], v17 offset:20480
    ds_read_b128 v[60:63], v17 offset:22528
    v_mfma_f32_16x16x32_bf16 v[88:91], v[40:43], v[32:35], v[88:91]
    ds_read_b64_tr_b16 v[64:65], v18 offset:24576
    ds_read_b64_tr_b16 v[66:67], v18 offset:25600
    v_mfma_f32_16x16x32_bf16 v[96:99], v[40:43], v[36:39], v[96:99]
    ds_read_b64_tr_b16 v[68:69], v19 offset:24576
    ds_read_b64_tr_b16 v[70:71], v19 offset:25600
    v_mfma_f32_16x16x32_bf16 v[76:79], v[44:47], v[24:27], v[76:79]
    s_add_u32 m0, s21, 1024
    s_nop 0
    global_load_lds_dwordx4 v13, s[28:29]
    s_add_u32 s28, s28, 131072
    s_addc_u32 s29, s29, 0
    s_add_u32 m0, s20, 1024
    s_nop 0
    global_load_lds_dwordx4 v11, s[24:25]
    s_add_u32 s24, s24, 128
    s_addc_u32 s25, s25, 0
    v_mfma_f32_16x16x32_bf16 v[84:87], v[44:47], v[28:31], v[84:87]
    v_mfma_f32_16x16x32_bf16 v[92:95], v[44:47], v[32:35], v[92:95]
    v_mfma_f32_16x16x32_bf16 v[100:103], v[44:47], v[36:39], v[100:103]
    s_waitcnt vmcnt(11) lgkmcnt(0)
    s_barrier
    v_mfma_f32_16x16x32_bf16 v[72:75], v[64:67], v[48:51], v[72:75]
    ds_read_b128 v[32:35], v16 offset:36864
    ds_read_b128 v[36:39], v16 offset:38912
    v_mfma_f32_16x16x32_bf16 v[80:83], v[64:67], v[52:55], v[80:83]
    ds_read_b64_tr_b16 v[40:41], v18 offset:32768
    ds_read_b64_tr_b16 v[42:43], v18 offset:33792
    v_mfma_f32_16x16x32_bf16 v[88:91], v[64:67], v[56:59], v[88:91]
    ds_read_b64_tr_b16 v[44:45], v19 offset:32768
    ds_read_b64_tr_b16 v[46:47], v19 offset:33792
    v_mfma_f32_16x16x32_bf16 v[96:99], v[64:67], v[60:63], v[96:99]
    s_add_u32 m0, s21, 16384
    s_nop 0
    global_load_lds_dwordx4 v12, s[26:27]
    s_add_u32 m0, s21, 17408
    s_nop 0
    global_load_lds_dwordx4 v13, s[26:27]
    s_add_u32 s26, s26, 131072
    s_addc_u32 s27, s27, 0
    v_mfma_f32_16x16x32_bf16 v[76:79], v[68:71], v[48:51], v[76:79]
    v_mfma_f32_16x16x32_bf16 v[84:87], v[68:71], v[52:55], v[84:87]
    v_mfma_f32_16x16x32_bf16 v[92:95], v[68:71], v[56:59], v[92:95]
    v_mfma_f32_16x16x32_bf16 v[100:103], v[68:71], v[60:63], v[100:103]
    s_waitcnt lgkmcnt(0)
    v_mfma_f32_16x16x32_bf16 v[104:107], v[40:43], v[32:35], v[104:107]
    ds_read_b128 v[56:59], v17 offset:36864
    ds_read_b128 v[60:63], v17 offset:38912
    ds_read_b64_tr_b16 v[64:65], v18 offset:40960
    v_mfma_f32_16x16x32_bf16 v[112:115], v[40:43], v[36:39], v[112:115]
    ds_read_b64_tr_b16 v[66:67], v18 offset:41984
    ds_read_b64_tr_b16 v[68:69], v19 offset:40960
    ds_read_b64_tr_b16 v[70:71], v19 offset:41984
    v_mfma_f32_16x16x32_bf16 v[108:111], v[44:47], v[32:35], v[108:111]
    s_add_u32 m0, s31, 16384
    s_nop 0
    global_load_lds_dwordx4 v14, s[22:23] sc1
    s_add_u32 s22, s22, 128
    s_addc_u32 s23, s23, 0
    v_mfma_f32_16x16x32_bf16 v[116:119], v[44:47], v[36:39], v[116:119]
    s_waitcnt vmcnt(10) lgkmcnt(0)
    s_barrier
    v_mfma_f32_16x16x32_bf16 v[104:107], v[64:67], v[56:59], v[104:107]
    ds_read_b128 v[24:27], v120 offset:0
    ds_read_b128 v[28:31], v120 offset:2048
    ds_read_b128 v[32:35], v120 offset:4096
    v_mfma_f32_16x16x32_bf16 v[112:115], v[64:67], v[60:63], v[112:115]
    ds_read_b128 v[36:39], v120 offset:6144
    ds_read_b64_tr_b16 v[40:41], v122 offset:0
    ds_read_b64_tr_b16 v[42:43], v122 offset:1024
    v_mfma_f32_16x16x32_bf16 v[108:111], v[68:71], v[56:59], v[108:111]
    ds_read_b64_tr_b16 v[44:45], v123 offset:0
    ds_read_b64_tr_b16 v[46:47], v123 offset:1024
    s_add_u32 m0, s21, 32768
    s_nop 0
    global_load_lds_dwordx4 v12, s[26:27]
    v_mfma_f32_16x16x32_bf16 v[116:119], v[68:71], v[60:63], v[116:119]
    s_add_u32 m0, s21, 33792
    s_nop 0
    global_load_lds_dwordx4 v13, s[26:27]
    s_add_u32 s26, s26, 131072
    s_addc_u32 s27, s27, 0
    s_waitcnt lgkmcnt(0)
    v_mfma_f32_16x16x32_bf16 v[72:75], v[40:43], v[24:27], v[72:75]
    ds_read_b128 v[48:51], v121 offset:0
    ds_read_b128 v[52:55], v121 offset:2048
    v_mfma_f32_16x16x32_bf16 v[80:83], v[40:43], v[28:31], v[80:83]
    ds_read_b128 v[56:59], v121 offset:4096
    ds_read_b128 v[60:63], v121 offset:6144
    v_mfma_f32_16x16x32_bf16 v[88:91], v[40:43], v[32:35], v[88:91]
    ds_read_b64_tr_b16 v[64:65], v122 offset:8192
    ds_read_b64_tr_b16 v[66:67], v122 offset:9216
    v_mfma_f32_16x16x32_bf16 v[96:99], v[40:43], v[36:39], v[96:99]
    ds_read_b64_tr_b16 v[68:69], v123 offset:8192
    ds_read_b64_tr_b16 v[70:71], v123 offset:9216
    v_mfma_f32_16x16x32_bf16 v[76:79], v[44:47], v[24:27], v[76:79]
    s_add_u32 m0, s31, 32768
    s_nop 0
    global_load_lds_dwordx4 v14, s[22:23] sc1
    s_add_u32 s22, s22, 128
    s_addc_u32 s23, s23, 0
    v_mfma_f32_16x16x32_bf16 v[84:87], v[44:47], v[28:31], v[84:87]
    v_mfma_f32_16x16x32_bf16 v[92:95], v[44:47], v[32:35], v[92:95]
    v_mfma_f32_16x16x32_bf16 v[100:103], v[44:47], v[36:39], v[100:103]
    s_waitcnt vmcnt(10) lgkmcnt(0)
    s_barrier
    v_mfma_f32_16x16x32_bf16 v[72:75], v[64:67], v[48:51], v[72:75]
    ds_read_b128 v[32:35], v120 offset:36864
    ds_read_b128 v[36:39], v120 offset:38912
    v_mfma_f32_16x16x32_bf16 v[80:83], v[64:67], v[52:55], v[80:83]
    ds_read_b64_tr_b16 v[40:41], v122 offset:32768
    ds_read_b64_tr_b16 v[42:43], v122 offset:33792
    v_mfma_f32_16x16x32_bf16 v[88:91], v[64:67], v[56:59], v[88:91]
    ds_read_b64_tr_b16 v[44:45], v123 offset:32768
    ds_read_b64_tr_b16 v[46:47], v123 offset:33792
    v_mfma_f32_16x16x32_bf16 v[96:99], v[64:67], v[60:63], v[96:99]
    s_add_u32 m0, s21, 65536
    s_nop 0
    global_load_lds_dwordx4 v12, s[26:27]
    s_add_u32 m0, s21, 66560
    s_nop 0
    global_load_lds_dwordx4 v13, s[26:27]
    s_add_u32 s26, s26, 131072
    s_addc_u32 s27, s27, 0
    v_mfma_f32_16x16x32_bf16 v[76:79], v[68:71], v[48:51], v[76:79]
    v_mfma_f32_16x16x32_bf16 v[84:87], v[68:71], v[52:55], v[84:87]
    v_mfma_f32_16x16x32_bf16 v[92:95], v[68:71], v[56:59], v[92:95]
    v_mfma_f32_16x16x32_bf16 v[100:103], v[68:71], v[60:63], v[100:103]
    s_waitcnt lgkmcnt(0)
    v_mfma_f32_16x16x32_bf16 v[104:107], v[40:43], v[32:35], v[104:107]
    ds_read_b128 v[56:59], v121 offset:36864
    ds_read_b128 v[60:63], v121 offset:38912
    ds_read_b64_tr_b16 v[64:65], v122 offset:40960
    v_mfma_f32_16x16x32_bf16 v[112:115], v[40:43], v[36:39], v[112:115]
    ds_read_b64_tr_b16 v[66:67], v122 offset:41984
    ds_read_b64_tr_b16 v[68:69], v123 offset:40960
    ds_read_b64_tr_b16 v[70:71], v123 offset:41984
    v_mfma_f32_16x16x32_bf16 v[108:111], v[44:47], v[32:35], v[108:111]
    s_add_u32 m0, s31, 98304
    s_nop 0
    global_load_lds_dwordx4 v14, s[22:23] sc1
    s_add_u32 s22, s22, 128
    s_addc_u32 s23, s23, 0
    v_mfma_f32_16x16x32_bf16 v[116:119], v[44:47], v[36:39], v[116:119]
    s_waitcnt vmcnt(9) lgkmcnt(0)
    s_barrier
    v_mfma_f32_16x16x32_bf16 v[104:107], v[64:67], v[56:59], v[104:107]
    ds_read_b128 v[24:27], v16 offset:0
    ds_read_b128 v[28:31], v16 offset:2048
    ds_read_b128 v[32:35], v16 offset:4096
    v_mfma_f32_16x16x32_bf16 v[112:115], v[64:67], v[60:63], v[112:115]
    ds_read_b128 v[36:39], v16 offset:6144
    ds_read_b64_tr_b16 v[40:41], v18 offset:0
    ds_read_b64_tr_b16 v[42:43], v18 offset:1024
    v_mfma_f32_16x16x32_bf16 v[108:111], v[68:71], v[56:59], v[108:111]
    ds_read_b64_tr_b16 v[44:45], v19 offset:0
    ds_read_b64_tr_b16 v[46:47], v19 offset:1024
    s_add_u32 m0, s21, 98304
    s_nop 0
    global_load_lds_dwordx4 v12, s[26:27]
    v_mfma_f32_16x16x32_bf16 v[116:119], v[68:71], v[60:63], v[116:119]
    s_add_u32 m0, s21, 99328
    s_nop 0
    global_load_lds_dwordx4 v13, s[26:27]
    s_add_u32 s26, s26, 131072
    s_addc_u32 s27, s27, 0
    s_waitcnt lgkmcnt(0)
    v_mfma_f32_16x16x32_bf16 v[72:75], v[40:43], v[24:27], v[72:75]
    ds_read_b128 v[48:51], v17 offset:0
    ds_read_b128 v[52:55], v17 offset:2048
    v_mfma_f32_16x16x32_bf16 v[80:83], v[40:43], v[28:31], v[80:83]
    ds_read_b128 v[56:59], v17 offset:4096
    ds_read_b128 v[60:63], v17 offset:6144
    v_mfma_f32_16x16x32_bf16 v[88:91], v[40:43], v[32:35], v[88:91]
    ds_read_b64_tr_b16 v[64:65], v18 offset:8192
    ds_read_b64_tr_b16 v[66:67], v18 offset:9216
    v_mfma_f32_16x16x32_bf16 v[96:99], v[40:43], v[36:39], v[96:99]
    ds_read_b64_tr_b16 v[68:69], v19 offset:8192
    ds_read_b64_tr_b16 v[70:71], v19 offset:9216
    v_mfma_f32_16x16x32_bf16 v[76:79], v[44:47], v[24:27], v[76:79]
    s_add_u32 m0, s31, 131072
    s_nop 0
    global_load_lds_dwordx4 v14, s[22:23] sc1
    s_add_u32 s22, s22, 128
    s_addc_u32 s23, s23, 0
    v_mfma_f32_16x16x32_bf16 v[84:87], v[44:47], v[28:31], v[84:87]
    v_mfma_f32_16x16x32_bf16 v[92:95], v[44:47], v[32:35], v[92:95]
    v_mfma_f32_16x16x32_bf16 v[100:103], v[44:47], v[36:39], v[100:103]
    s_waitcnt vmcnt(9) lgkmcnt(0)
    s_barrier
    v_mfma_f32_16x16x32_bf16 v[72:75], v[64:67], v[48:51], v[72:75]
    ds_read_b128 v[32:35], v16 offset:20480
    ds_read_b128 v[36:39], v16 offset:22528
    v_mfma_f32_16x16x32_bf16 v[80:83], v[64:67], v[52:55], v[80:83]
    ds_read_b64_tr_b16 v[40:41], v18 offset:16384
    ds_read_b64_tr_b16 v[42:43], v18 offset:17408
    v_mfma_f32_16x16x32_bf16 v[88:91], v[64:67], v[56:59], v[88:91]
    ds_read_b64_tr_b16 v[44:45], v19 offset:16384
    ds_read_b64_tr_b16 v[46:47], v19 offset:17408
    v_mfma_f32_16x16x32_bf16 v[96:99], v[64:67], v[60:63], v[96:99]
    s_add_u32 m0, s21, 0
    s_nop 0
    global_load_lds_dwordx4 v12, s[26:27]
    s_add_u32 m0, s21, 1024
    s_nop 0
    global_load_lds_dwordx4 v13, s[26:27]
    s_add_u32 s26, s26, 131072
    s_addc_u32 s27, s27, 0
    v_mfma_f32_16x16x32_bf16 v[76:79], v[68:71], v[48:51], v[76:79]
    v_mfma_f32_16x16x32_bf16 v[84:87], v[68:71], v[52:55], v[84:87]
    v_mfma_f32_16x16x32_bf16 v[92:95], v[68:71], v[56:59], v[92:95]
    v_mfma_f32_16x16x32_bf16 v[100:103], v[68:71], v[60:63], v[100:103]
    s_waitcnt lgkmcnt(0)
    v_mfma_f32_16x16x32_bf16 v[104:107], v[40:43], v[32:35], v[104:107]
    ds_read_b128 v[56:59], v17 offset:20480
    ds_read_b128 v[60:63], v17 offset:22528
    ds_read_b64_tr_b16 v[64:65], v18 offset:24576
    v_mfma_f32_16x16x32_bf16 v[112:115], v[40:43], v[36:39], v[112:115]
    ds_read_b64_tr_b16 v[66:67], v18 offset:25600
    ds_read_b64_tr_b16 v[68:69], v19 offset:24576
    ds_read_b64_tr_b16 v[70:71], v19 offset:25600
    v_mfma_f32_16x16x32_bf16 v[108:111], v[44:47], v[32:35], v[108:111]
    s_nop 7
    s_lshl_b32 s33, s2, 16
    s_lshl_b32 s34, s14, 13
    s_add_u32 s33, s33, s34
    s_add_u32 s33, s33, 50331648
    v_lshlrev_b32 v4, 4, v0
    v_add_u32 v5, s33, v4
    s_xor_b32 s33, s33, 524288
    v_add_u32 v6, s33, v4
    global_store_dwordx4 v5, v[72:75], s[12:13] offset:0 sc1
    global_store_dwordx4 v5, v[76:79], s[12:13] offset:1024 sc1
    v_mfma_f32_16x16x32_bf16 v[116:119], v[44:47], v[36:39], v[116:119]
    global_store_dwordx4 v5, v[80:83], s[12:13] offset:2048 sc1
    global_store_dwordx4 v5, v[84:87], s[12:13] offset:3072 sc1
    s_add_u32 m0, s31, 0
    s_nop 0
    global_load_lds_dwordx4 v14, s[22:23] sc1
    s_add_u32 s22, s22, 128
    s_addc_u32 s23, s23, 0
    s_waitcnt vmcnt(13) lgkmcnt(0)
    s_barrier
    v_mfma_f32_16x16x32_bf16 v[104:107], v[64:67], v[56:59], v[104:107]
    ds_read_b128 v[32:35], v16 offset:36864
    ds_read_b128 v[36:39], v16 offset:38912
    ds_read_b64_tr_b16 v[40:41], v18 offset:32768
    v_mfma_f32_16x16x32_bf16 v[112:115], v[64:67], v[60:63], v[112:115]
    ds_read_b64_tr_b16 v[42:43], v18 offset:33792
    ds_read_b64_tr_b16 v[44:45], v19 offset:32768
    ds_read_b64_tr_b16 v[46:47], v19 offset:33792
    v_mfma_f32_16x16x32_bf16 v[108:111], v[68:71], v[56:59], v[108:111]
    s_add_u32 m0, s21, 16384
    s_nop 0
    global_load_lds_dwordx4 v12, s[26:27]
    s_add_u32 m0, s21, 17408
    s_nop 0
    global_load_lds_dwordx4 v13, s[26:27]
    s_add_u32 s26, s26, 131072
    s_addc_u32 s27, s27, 0
    v_mfma_f32_16x16x32_bf16 v[116:119], v[68:71], v[60:63], v[116:119]
    s_waitcnt lgkmcnt(0)
    v_mfma_f32_16x16x32_bf16 v[104:107], v[40:43], v[32:35], v[104:107]
    ds_read_b128 v[56:59], v17 offset:36864
    ds_read_b128 v[60:63], v17 offset:38912
    ds_read_b64_tr_b16 v[64:65], v18 offset:40960
    v_mfma_f32_16x16x32_bf16 v[112:115], v[40:43], v[36:39], v[112:115]
    ds_read_b64_tr_b16 v[66:67], v18 offset:41984
    ds_read_b64_tr_b16 v[68:69], v19 offset:40960
    ds_read_b64_tr_b16 v[70:71], v19 offset:41984
    v_mfma_f32_16x16x32_bf16 v[108:111], v[44:47], v[32:35], v[108:111]
    s_add_u32 m0, s31, 16384
    s_nop 0
    global_load_lds_dwordx4 v14, s[22:23] sc1
    s_add_u32 s22, s22, 128
    s_addc_u32 s23, s23, 0
    v_mfma_f32_16x16x32_bf16 v[116:119], v[44:47], v[36:39], v[116:119]
    s_waitcnt vmcnt(13) lgkmcnt(0)
    s_barrier
    v_mfma_f32_16x16x32_bf16 v[104:107], v[64:67], v[56:59], v[104:107]
    ds_read_b128 v[32:35], v120 offset:4096
    ds_read_b128 v[36:39], v120 offset:6144
    ds_read_b64_tr_b16 v[40:41], v122 offset:0
    v_mfma_f32_16x16x32_bf16 v[112:115], v[64:67], v[60:63], v[112:115]
    ds_read_b64_tr_b16 v[42:43], v122 offset:1024
    ds_read_b64_tr_b16 v[44:45], v123 offset:0
    ds_read_b64_tr_b16 v[46:47], v123 offset:1024
    v_mfma_f32_16x16x32_bf16 v[108:111], v[68:71], v[56:59], v[108:111]
    s_add_u32 m0, s21, 32768
    s_nop 0
    global_load_lds_dwordx4 v12, s[26:27]
    s_add_u32 m0, s21, 33792
    s_nop 0
    global_load_lds_dwordx4 v13, s[26:27]
    s_add_u32 s26, s26, 131072
    s_addc_u32 s27, s27, 0
    v_mfma_f32_16x16x32_bf16 v[116:119], v[68:71], v[60:63], v[116:119]
    s_waitcnt lgkmcnt(0)
    v_mfma_f32_16x16x32_bf16 v[104:107], v[40:43], v[32:35], v[104:107]
    ds_read_b128 v[56:59], v121 offset:4096
    ds_read_b128 v[60:63], v121 offset:6144
    ds_read_b64_tr_b16 v[64:65], v122 offset:8192
    v_mfma_f32_16x16x32_bf16 v[112:115], v[40:43], v[36:39], v[112:115]
    ds_read_b64_tr_b16 v[66:67], v122 offset:9216
    ds_read_b64_tr_b16 v[68:69], v123 offset:8192
    ds_read_b64_tr_b16 v[70:71], v123 offset:9216
    v_mfma_f32_16x16x32_bf16 v[108:111], v[44:47], v[32:35], v[108:111]
    s_add_u32 m0, s31, 32768
    s_nop 0
    global_load_lds_dwordx4 v14, s[22:23] sc1
    s_add_u32 s22, s22, 128
    s_addc_u32 s23, s23, 0
    v_mfma_f32_16x16x32_bf16 v[116:119], v[44:47], v[36:39], v[116:119]
    s_waitcnt vmcnt(7) lgkmcnt(0)
    s_barrier
    s_cmp_lg_u32 s14, 0
    s_cbranch_scc1 LA_f1
    s_lshl_b32 s33, s2, 8
    s_add_u32 s33, s33, 46137344
    v_mov_b32 v7, s33
    v_mov_b32 v8, 1
    v_cmp_eq_u32 vcc, 0, v0
    s_and_saveexec_b64 s[38:39], vcc
    global_store_dword v7, v8, s[12:13] sc1
    s_mov_b64 exec, s[38:39]
LA_f1:
    v_mfma_f32_16x16x32_bf16 v[104:107], v[64:67], v[56:59], v[104:107]
    ds_read_b128 v[32:35], v120 offset:36864
    ds_read_b128 v[36:39], v120 offset:38912
    ds_read_b64_tr_b16 v[40:41], v122 offset:32768
    v_mfma_f32_16x16x32_bf16 v[112:115], v[64:67], v[60:63], v[112:115]
    ds_read_b64_tr_b16 v[42:43], v122 offset:33792
    ds_read_b64_tr_b16 v[44:45], v123 offset:32768
    ds_read_b64_tr_b16 v[46:47], v123 offset:33792
    v_mfma_f32_16x16x32_bf16 v[108:111], v[68:71], v[56:59], v[108:111]
    s_add_u32 m0, s21, 65536
    s_nop 0
    global_load_lds_dwordx4 v12, s[26:27]
    s_add_u32 m0, s21, 66560
    s_nop 0
    global_load_lds_dwordx4 v13, s[26:27]
    s_add_u32 s26, s26, 131072
    s_addc_u32 s27, s27, 0
    v_mfma_f32_16x16x32_bf16 v[116:119], v[68:71], v[60:63], v[116:119]
    s_waitcnt lgkmcnt(0)
    v_mfma_f32_16x16x32_bf16 v[104:107], v[40:43], v[32:35], v[104:107]
    ds_read_b128 v[56:59], v121 offset:36864
    ds_read_b128 v[60:63], v121 offset:38912
    ds_read_b64_tr_b16 v[64:65], v122 offset:40960
    v_mfma_f32_16x16x32_bf16 v[112:115], v[40:43], v[36:39], v[112:115]
    ds_read_b64_tr_b16 v[66:67], v122 offset:41984
    ds_read_b64_tr_b16 v[68:69], v123 offset:40960
    ds_read_b64_tr_b16 v[70:71], v123 offset:41984
    v_mfma_f32_16x16x32_bf16 v[108:111], v[44:47], v[32:35], v[108:111]
    s_add_u32 m0, s31, 98304
    s_nop 0
    global_load_lds_dwordx4 v14, s[22:23] sc1
    s_add_u32 s22, s22, 128
    s_addc_u32 s23, s23, 0
    v_mfma_f32_16x16x32_bf16 v[116:119], v[44:47], v[36:39], v[116:119]
    s_waitcnt vmcnt(9) lgkmcnt(0)
    s_barrier
    v_mfma_f32_16x16x32_bf16 v[104:107], v[64:67], v[56:59], v[104:107]
    ds_read_b128 v[32:35], v16 offset:4096
    ds_read_b128 v[36:39], v16 offset:6144
    ds_read_b64_tr_b16 v[40:41], v18 offset:0
    v_mfma_f32_16x16x32_bf16 v[112:115], v[64:67], v[60:63], v[112:115]
    ds_read_b64_tr_b16 v[42:43], v18 offset:1024
    ds_read_b64_tr_b16 v[44:45], v19 offset:0
    ds_read_b64_tr_b16 v[46:47], v19 offset:1024
    v_mfma_f32_16x16x32_bf16 v[108:111], v[68:71], v[56:59], v[108:111]
    s_add_u32 m0, s21, 98304
    s_nop 0
    global_load_lds_dwordx4 v12, s[26:27]
    s_add_u32 m0, s21, 99328
    s_nop 0
    global_load_lds_dwordx4 v13, s[26:27]
    s_add_u32 s26, s26, 131072
    s_addc_u32 s27, s27, 0
    v_mfma_f32_16x16x32_bf16 v[116:119], v[68:71], v[60:63], v[116:119]
    s_waitcnt lgkmcnt(0)
    v_mfma_f32_16x16x32_bf16 v[104:107], v[40:43], v[32:35], v[104:107]
    ds_read_b128 v[56:59], v17 offset:4096
    ds_read_b128 v[60:63], v17 offset:6144
    ds_read_b64_tr_b16 v[64:65], v18 offset:8192
    v_mfma_f32_16x16x32_bf16 v[112:115], v[40:43], v[36:39], v[112:115]
    ds_read_b64_tr_b16 v[66:67], v18 offset:9216
    ds_read_b64_tr_b16 v[68:69], v19 offset:8192
    ds_read_b64_tr_b16 v[70:71], v19 offset:9216
    v_mfma_f32_16x16x32_bf16 v[108:111], v[44:47], v[32:35], v[108:111]
    s_add_u32 m0, s31, 131072
    s_nop 0
    global_load_lds_dwordx4 v14, s[22:23] sc1
    s_add_u32 s22, s22, 128
    s_addc_u32 s23, s23, 0
    v_mfma_f32_16x16x32_bf16 v[116:119], v[44:47], v[36:39], v[116:119]
    s_waitcnt vmcnt(9) lgkmcnt(0)
    s_barrier
    v_mfma_f32_16x16x32_bf16 v[104:107], v[64:67], v[56:59], v[104:107]
    ds_read_b128 v[32:35], v16 offset:20480
    ds_read_b128 v[36:39], v16 offset:22528
    ds_read_b64_tr_b16 v[40:41], v18 offset:16384
    v_mfma_f32_16x16x32_bf16 v[112:115], v[64:67], v[60:63], v[112:115]
    ds_read_b64_tr_b16 v[42:43], v18 offset:17408
    ds_read_b64_tr_b16 v[44:45], v19 offset:16384
    ds_read_b64_tr_b16 v[46:47], v19 offset:17408
    v_mfma_f32_16x16x32_bf16 v[108:111], v[68:71], v[56:59], v[108:111]
    s_add_u32 m0, s21, 0
    s_nop 0
    global_load_lds_dwordx4 v12, s[26:27]
    s_add_u32 m0, s21, 1024
    s_nop 0
    global_load_lds_dwordx4 v13, s[26:27]
    s_add_u32 s26, s26, 131072
    s_addc_u32 s27, s27, 0
    v_mfma_f32_16x16x32_bf16 v[116:119], v[68:71], v[60:63], v[116:119]
    s_waitcnt lgkmcnt(0)
    v_mfma_f32_16x16x32_bf16 v[104:107], v[40:43], v[32:35], v[104:107]
    ds_read_b128 v[56:59], v17 offset:20480
    ds_read_b128 v[60:63], v17 offset:22528
    ds_read_b64_tr_b16 v[64:65], v18 offset:24576
    v_mfma_f32_16x16x32_bf16 v[112:115], v[40:43], v[36:39], v[112:115]
    ds_read_b64_tr_b16 v[66:67], v18 offset:25600
    ds_read_b64_tr_b16 v[68:69], v19 offset:24576
    ds_read_b64_tr_b16 v[70:71], v19 offset:25600
    v_mfma_f32_16x16x32_bf16 v[108:111], v[44:47], v[32:35], v[108:111]
    s_add_u32 m0, s31, 0
    s_nop 0
    global_load_lds_dwordx4 v14, s[22:23] sc1
    s_add_u32 s22, s22, 128
    s_addc_u32 s23, s23, 0
    v_mfma_f32_16x16x32_bf16 v[116:119], v[44:47], v[36:39], v[116:119]
    s_waitcnt vmcnt(9) lgkmcnt(0)
    s_barrier
    v_mfma_f32_16x16x32_bf16 v[104:107], v[64:67], v[56:59], v[104:107]
    ds_read_b128 v[32:35], v16 offset:36864
    ds_read_b128 v[36:39], v16 offset:38912
    ds_read_b64_tr_b16 v[40:41], v18 offset:32768
    v_mfma_f32_16x16x32_bf16 v[112:115], v[64:67], v[60:63], v[112:115]
    ds_read_b64_tr_b16 v[42:43], v18 offset:33792
    ds_read_b64_tr_b16 v[44:45], v19 offset:32768
    ds_read_b64_tr_b16 v[46:47], v19 offset:33792
    v_mfma_f32_16x16x32_bf16 v[108:111], v[68:71], v[56:59], v[108:111]
    v_mfma_f32_16x16x32_bf16 v[116:119], v[68:71], v[60:63], v[116:119]
    s_waitcnt lgkmcnt(0)
    v_mfma_f32_16x16x32_bf16 v[104:107], v[40:43], v[32:35], v[104:107]
    ds_read_b128 v[56:59], v17 offset:36864
    ds_read_b128 v[60:63], v17 offset:38912
    ds_read_b64_tr_b16 v[64:65], v18 offset:40960
    v_mfma_f32_16x16x32_bf16 v[112:115], v[40:43], v[36:39], v[112:115]
    ds_read_b64_tr_b16 v[66:67], v18 offset:41984
    ds_read_b64_tr_b16 v[68:69], v19 offset:40960
    ds_read_b64_tr_b16 v[70:71], v19 offset:41984
    v_mfma_f32_16x16x32_bf16 v[108:111], v[44:47], v[32:35], v[108:111]
    v_mfma_f32_16x16x32_bf16 v[116:119], v[44:47], v[36:39], v[116:119]
    s_waitcnt vmcnt(6) lgkmcnt(0)
    s_barrier
    v_mfma_f32_16x16x32_bf16 v[104:107], v[64:67], v[56:59], v[104:107]
    ds_read_b128 v[32:35], v120 offset:4096
    ds_read_b128 v[36:39], v120 offset:6144
    ds_read_b64_tr_b16 v[40:41], v122 offset:0
    v_mfma_f32_16x16x32_bf16 v[112:115], v[64:67], v[60:63], v[112:115]
    ds_read_b64_tr_b16 v[42:43], v122 offset:1024
    ds_read_b64_tr_b16 v[44:45], v123 offset:0
    ds_read_b64_tr_b16 v[46:47], v123 offset:1024
    v_mfma_f32_16x16x32_bf16 v[108:111], v[68:71], v[56:59], v[108:111]
    v_mfma_f32_16x16x32_bf16 v[116:119], v[68:71], v[60:63], v[116:119]
    s_waitcnt lgkmcnt(0)
    v_mfma_f32_16x16x32_bf16 v[104:107], v[40:43], v[32:35], v[104:107]
    ds_read_b128 v[56:59], v121 offset:4096
    ds_read_b128 v[60:63], v121 offset:6144
    ds_read_b64_tr_b16 v[64:65], v122 offset:8192
    v_mfma_f32_16x16x32_bf16 v[112:115], v[40:43], v[36:39], v[112:115]
    ds_read_b64_tr_b16 v[66:67], v122 offset:9216
    ds_read_b64_tr_b16 v[68:69], v123 offset:8192
    ds_read_b64_tr_b16 v[70:71], v123 offset:9216
    v_mfma_f32_16x16x32_bf16 v[108:111], v[44:47], v[32:35], v[108:111]
    v_mfma_f32_16x16x32_bf16 v[116:119], v[44:47], v[36:39], v[116:119]
    s_cmp_lg_u32 s14, 0
    s_cbranch_scc1 LA_x1
    s_xor_b32 s33, s2, 8
    s_lshl_b32 s33, s33, 8
    s_add_u32 s33, s33, 46137344
    v_mov_b32 v7, s33
LA_x1p:
    global_load_dword v8, v7, s[12:13] sc1
    s_waitcnt vmcnt(0)
    v_cmp_eq_u32 vcc, 0, v8
    s_cbranch_vccz LA_x1
    s_sleep 1
    s_branch LA_x1p
LA_x1:
    s_waitcnt vmcnt(3) lgkmcnt(0)
    s_barrier
    v_mfma_f32_16x16x32_bf16 v[104:107], v[64:67], v[56:59], v[104:107]
    ds_read_b128 v[32:35], v120 offset:36864
    ds_read_b128 v[36:39], v120 offset:38912
    ds_read_b64_tr_b16 v[40:41], v122 offset:32768
    v_mfma_f32_16x16x32_bf16 v[112:115], v[64:67], v[60:63], v[112:115]
    ds_read_b64_tr_b16 v[42:43], v122 offset:33792
    ds_read_b64_tr_b16 v[44:45], v123 offset:32768
    ds_read_b64_tr_b16 v[46:47], v123 offset:33792
    v_mfma_f32_16x16x32_bf16 v[108:111], v[68:71], v[56:59], v[108:111]
    v_mfma_f32_16x16x32_bf16 v[116:119], v[68:71], v[60:63], v[116:119]
    s_waitcnt lgkmcnt(0)
    v_mfma_f32_16x16x32_bf16 v[104:107], v[40:43], v[32:35], v[104:107]
    ds_read_b128 v[56:59], v121 offset:36864
    ds_read_b128 v[60:63], v121 offset:38912
    ds_read_b64_tr_b16 v[64:65], v122 offset:40960
    v_mfma_f32_16x16x32_bf16 v[112:115], v[40:43], v[36:39], v[112:115]
    ds_read_b64_tr_b16 v[66:67], v122 offset:41984
    ds_read_b64_tr_b16 v[68:69], v123 offset:40960
    ds_read_b64_tr_b16 v[70:71], v123 offset:41984
    v_mfma_f32_16x16x32_bf16 v[108:111], v[44:47], v[32:35], v[108:111]
    global_load_dwordx4 v[72:75], v6, s[12:13] offset:0 sc1
    global_load_dwordx4 v[76:79], v6, s[12:13] offset:1024 sc1
    global_load_dwordx4 v[80:83], v6, s[12:13] offset:2048 sc1
    v_mfma_f32_16x16x32_bf16 v[116:119], v[44:47], v[36:39], v[116:119]
    global_load_dwordx4 v[84:87], v6, s[12:13] offset:3072 sc1
    s_waitcnt vmcnt(4) lgkmcnt(0)
    s_barrier
    v_mfma_f32_16x16x32_bf16 v[104:107], v[64:67], v[56:59], v[104:107]
    ds_read_b128 v[32:35], v16 offset:4096
    ds_read_b128 v[36:39], v16 offset:6144
    ds_read_b64_tr_b16 v[40:41], v18 offset:0
    v_mfma_f32_16x16x32_bf16 v[112:115], v[64:67], v[60:63], v[112:115]
    ds_read_b64_tr_b16 v[42:43], v18 offset:1024
    ds_read_b64_tr_b16 v[44:45], v19 offset:0
    ds_read_b64_tr_b16 v[46:47], v19 offset:1024
    v_mfma_f32_16x16x32_bf16 v[108:111], v[68:71], v[56:59], v[108:111]
    v_mfma_f32_16x16x32_bf16 v[116:119], v[68:71], v[60:63], v[116:119]
    s_waitcnt lgkmcnt(0)
    v_mfma_f32_16x16x32_bf16 v[104:107], v[40:43], v[32:35], v[104:107]
    ds_read_b128 v[56:59], v17 offset:4096
    ds_read_b128 v[60:63], v17 offset:6144
    ds_read_b64_tr_b16 v[64:65], v18 offset:8192
    v_mfma_f32_16x16x32_bf16 v[112:115], v[40:43], v[36:39], v[112:115]
    ds_read_b64_tr_b16 v[66:67], v18 offset:9216
    ds_read_b64_tr_b16 v[68:69], v19 offset:8192
    ds_read_b64_tr_b16 v[70:71], v19 offset:9216
    v_mfma_f32_16x16x32_bf16 v[108:111], v[44:47], v[32:35], v[108:111]
    v_mfma_f32_16x16x32_bf16 v[116:119], v[44:47], v[36:39], v[116:119]
    s_waitcnt lgkmcnt(0)
    v_mfma_f32_16x16x32_bf16 v[104:107], v[64:67], v[56:59], v[104:107]
    v_mfma_f32_16x16x32_bf16 v[112:115], v[64:67], v[60:63], v[112:115]
    v_mfma_f32_16x16x32_bf16 v[108:111], v[68:71], v[56:59], v[108:111]
    v_mfma_f32_16x16x32_bf16 v[116:119], v[68:71], v[60:63], v[116:119]
    v_add_u32 v8, s30, v2
    v_lshl_add_u32 v7, v8, 11, v1
    s_lshl_b32 s33, s15, 8
    s_lshl_b32 s34, s18, 6
    s_add_u32 s33, s33, s34
    s_add_u32 s8, s8, s33
    s_addc_u32 s9, s9, 0
    v_sub_f32 v22, 1.0, v20
    v_sub_f32 v23, 1.0, v21
    v_cvt_pk_bf16_f32 v22, 0, v22
    v_cvt_pk_bf16_f32 v23, 0, v23
    s_waitcnt vmcnt(0)
    s_nop 4
    v_add_f32 v88, v88, v72
    v_add_f32 v89, v89, v73
    v_add_f32 v90, v90, v74
    v_add_f32 v91, v91, v75
    v_cvt_pk_bf16_f32 v104, 0, v104
    v_cvt_pk_bf16_f32 v88, 0, v88
    v_cvt_pk_bf16_f32 v105, 0, v105
    v_cvt_pk_bf16_f32 v89, 0, v89
    v_cvt_pk_bf16_f32 v106, 0, v106
    v_cvt_pk_bf16_f32 v90, 0, v90
    v_cvt_pk_bf16_f32 v107, 0, v107
    v_cvt_pk_bf16_f32 v91, 0, v91
    v_mul_f32 v104, v104, v20
    v_mul_f32 v88, v88, v22
    v_mul_f32 v105, v105, v20
    v_mul_f32 v89, v89, v22
    v_mul_f32 v106, v106, v20
    v_mul_f32 v90, v90, v22
    v_mul_f32 v107, v107, v20
    v_mul_f32 v91, v91, v22
    v_cvt_pk_bf16_f32 v104, 0, v104
    v_cvt_pk_bf16_f32 v88, 0, v88
    v_cvt_pk_bf16_f32 v105, 0, v105
    v_cvt_pk_bf16_f32 v89, 0, v89
    v_cvt_pk_bf16_f32 v106, 0, v106
    v_cvt_pk_bf16_f32 v90, 0, v90
    v_cvt_pk_bf16_f32 v107, 0, v107
    v_cvt_pk_bf16_f32 v91, 0, v91
    v_add_f32 v104, v104, v88
    v_add_f32 v105, v105, v89
    v_add_f32 v106, v106, v90
    v_add_f32 v107, v107, v91
    v_cvt_pk_bf16_f32 v24, v104, v105
    v_cvt_pk_bf16_f32 v25, v106, v107
    v_add_f32 v92, v92, v76
    v_add_f32 v93, v93, v77
    v_add_f32 v94, v94, v78
    v_add_f32 v95, v95, v79
    v_cvt_pk_bf16_f32 v108, 0, v108
    v_cvt_pk_bf16_f32 v92, 0, v92
    v_cvt_pk_bf16_f32 v109, 0, v109
    v_cvt_pk_bf16_f32 v93, 0, v93
    v_cvt_pk_bf16_f32 v110, 0, v110
    v_cvt_pk_bf16_f32 v94, 0, v94
    v_cvt_pk_bf16_f32 v111, 0, v111
    v_cvt_pk_bf16_f32 v95, 0, v95
    v_mul_f32 v108, v108, v20
    v_mul_f32 v92, v92, v22
    v_mul_f32 v109, v109, v20
    v_mul_f32 v93, v93, v22
    v_mul_f32 v110, v110, v20
    v_mul_f32 v94, v94, v22
    v_mul_f32 v111, v111, v20
    v_mul_f32 v95, v95, v22
    v_cvt_pk_bf16_f32 v108, 0, v108
    v_cvt_pk_bf16_f32 v92, 0, v92
    v_cvt_pk_bf16_f32 v109, 0, v109
    v_cvt_pk_bf16_f32 v93, 0, v93
    v_cvt_pk_bf16_f32 v110, 0, v110
    v_cvt_pk_bf16_f32 v94, 0, v94
    v_cvt_pk_bf16_f32 v111, 0, v111
    v_cvt_pk_bf16_f32 v95, 0, v95
    v_add_f32 v108, v108, v92
    v_add_f32 v109, v109, v93
    v_add_f32 v110, v110, v94
    v_add_f32 v111, v111, v95
    v_cvt_pk_bf16_f32 v26, v108, v109
    v_cvt_pk_bf16_f32 v27, v110, v111
    s_nop 1
    v_permlane16_swap_b32 v24, v26
    v_permlane16_swap_b32 v25, v27
    global_store_dwordx4 v7, v[24:27], s[8:9]
    v_add_f32 v96, v96, v80
    v_add_f32 v97, v97, v81
    v_add_f32 v98, v98, v82
    v_add_f32 v99, v99, v83
    v_cvt_pk_bf16_f32 v112, 0, v112
    v_cvt_pk_bf16_f32 v96, 0, v96
    v_cvt_pk_bf16_f32 v113, 0, v113
    v_cvt_pk_bf16_f32 v97, 0, v97
    v_cvt_pk_bf16_f32 v114, 0, v114
    v_cvt_pk_bf16_f32 v98, 0, v98
    v_cvt_pk_bf16_f32 v115, 0, v115
    v_cvt_pk_bf16_f32 v99, 0, v99
    v_mul_f32 v112, v112, v21
    v_mul_f32 v96, v96, v23
    v_mul_f32 v113, v113, v21
    v_mul_f32 v97, v97, v23
    v_mul_f32 v114, v114, v21
    v_mul_f32 v98, v98, v23
    v_mul_f32 v115, v115, v21
    v_mul_f32 v99, v99, v23
    v_cvt_pk_bf16_f32 v112, 0, v112
    v_cvt_pk_bf16_f32 v96, 0, v96
    v_cvt_pk_bf16_f32 v113, 0, v113
    v_cvt_pk_bf16_f32 v97, 0, v97
    v_cvt_pk_bf16_f32 v114, 0, v114
    v_cvt_pk_bf16_f32 v98, 0, v98
    v_cvt_pk_bf16_f32 v115, 0, v115
    v_cvt_pk_bf16_f32 v99, 0, v99
    v_add_f32 v112, v112, v96
    v_add_f32 v113, v113, v97
    v_add_f32 v114, v114, v98
    v_add_f32 v115, v115, v99
    v_cvt_pk_bf16_f32 v28, v112, v113
    v_cvt_pk_bf16_f32 v29, v114, v115
    v_add_f32 v100, v100, v84
    v_add_f32 v101, v101, v85
    v_add_f32 v102, v102, v86
    v_add_f32 v103, v103, v87
    v_cvt_pk_bf16_f32 v116, 0, v116
    v_cvt_pk_bf16_f32 v100, 0, v100
    v_cvt_pk_bf16_f32 v117, 0, v117
    v_cvt_pk_bf16_f32 v101, 0, v101
    v_cvt_pk_bf16_f32 v118, 0, v118
    v_cvt_pk_bf16_f32 v102, 0, v102
    v_cvt_pk_bf16_f32 v119, 0, v119
    v_cvt_pk_bf16_f32 v103, 0, v103
    v_mul_f32 v116, v116, v21
    v_mul_f32 v100, v100, v23
    v_mul_f32 v117, v117, v21
    v_mul_f32 v101, v101, v23
    v_mul_f32 v118, v118, v21
    v_mul_f32 v102, v102, v23
    v_mul_f32 v119, v119, v21
    v_mul_f32 v103, v103, v23
    v_cvt_pk_bf16_f32 v116, 0, v116
    v_cvt_pk_bf16_f32 v100, 0, v100
    v_cvt_pk_bf16_f32 v117, 0, v117
    v_cvt_pk_bf16_f32 v101, 0, v101
    v_cvt_pk_bf16_f32 v118, 0, v118
    v_cvt_pk_bf16_f32 v102, 0, v102
    v_cvt_pk_bf16_f32 v119, 0, v119
    v_cvt_pk_bf16_f32 v103, 0, v103
    v_add_f32 v116, v116, v100
    v_add_f32 v117, v117, v101
    v_add_f32 v118, v118, v102
    v_add_f32 v119, v119, v103
    v_cvt_pk_bf16_f32 v30, v116, v117
    v_cvt_pk_bf16_f32 v31, v118, v119
    s_nop 1
    v_permlane16_swap_b32 v28, v30
    v_permlane16_swap_b32 v29, v31
    v_add_u32 v7, 32768, v7
    global_store_dwordx4 v7, v[28:31], s[8:9]
    s_endpgm
LA_end:
    s_endpgm
.section .rodata,"a"
.p2align 6
.p2align 6
.amdhsa_kernel gemm1_kernel
  .amdhsa_next_free_vgpr 256
  .amdhsa_next_free_sgpr 102
  .amdhsa_accum_offset 256
  .amdhsa_group_segment_fixed_size 0
  .amdhsa_kernarg_size 88
  .amdhsa_user_sgpr_count 2
  .amdhsa_user_sgpr_kernarg_segment_ptr 1
  .amdhsa_system_sgpr_workgroup_id_x 1
.end_amdhsa_kernel
.p2align 6
.amdhsa_kernel fused_kernel
  .amdhsa_next_free_vgpr 128
  .amdhsa_next_free_sgpr 102
  .amdhsa_accum_offset 128
  .amdhsa_group_segment_fixed_size 0
  .amdhsa_kernarg_size 88
  .amdhsa_user_sgpr_count 2
  .amdhsa_user_sgpr_kernarg_segment_ptr 1
  .amdhsa_system_sgpr_workgroup_id_x 1
.end_amdhsa_kernel
```
